```python
import torch

def _softmax(x, axis=-1):
    return torch.softmax(x, dim=axis)
def _gelu(x):
    return torch.nn.functional.gelu(x, approximate="tanh")
def _silu(x):
    return torch.nn.functional.silu(x)
def _sigmoid(x):
    return torch.sigmoid(x)
def _layernorm(x, axis=-1, eps=1e-5):
    m = x.mean(dim=axis, keepdim=True)
    v = x.var(dim=axis, keepdim=True, unbiased=False)
    return (x - m) / torch.sqrt(v + eps)
def _scatter_add(tgt, idx, src, axis=0):
    return tgt.clone().index_add_(axis, idx, src)
def _segment_sum(src, seg, n):
    out = torch.zeros((n,) + src.shape[1:], dtype=src.dtype)
    return out.index_add_(0, seg, src)
def _pad(x, pw):
    flat = tuple(v for pair in reversed(pw) for v in pair)
    return torch.nn.functional.pad(x, flat)

kernel_name = 'sequential_preLN__spectral_fnet__swiglu_ffn__prompt'

def setup_inputs():

    _w = (lambda a: (lambda t: t.to(torch.bfloat16) if t.is_floating_point() else t)(torch.as_tensor(a)))
    def _A_setup():
        B, S, D = 1, 2048, 1024
        ns = torch.arange(S)[:, None] * torch.arange(S)[None, :]
        nd = torch.arange(D)[:, None] * torch.arange(D)[None, :]
        Ws_re = torch.cos(-2.0 * torch.pi * ns / S).to(float)
        Ws_im = torch.sin(-2.0 * torch.pi * ns / S).to(float)
        Wd_re = torch.cos(-2.0 * torch.pi * nd / D).to(float)
        Wd_im = torch.sin(-2.0 * torch.pi * nd / D).to(float)
        return {
            "x": _w((lambda *s: torch.randn(*s, dtype=torch.bfloat16) * 0.05)(B, S, D)),
            "dft_seq_re": _w(Ws_re),
            "dft_seq_im": _w(Ws_im),
            "dft_hid_re": _w(Wd_re),
            "dft_hid_im": _w(Wd_im),
        }
    _A_in = _A_setup()

    def _B_setup():
        B, S, D, F = 1, 2048, 1024, 3584
        return {
            "x": _w((lambda *s: torch.randn(*s, dtype=torch.bfloat16) * 0.05)(B, S, D)),
            "w_gate": _w((lambda *s: torch.randn(*s, dtype=torch.bfloat16) * 0.2)(D, F)),
            "w_up": _w((lambda *s: torch.randn(*s, dtype=torch.bfloat16) * 0.2)(D, F)),
            "w_down": _w((lambda *s: torch.randn(*s, dtype=torch.bfloat16) * 0.2)(F, D)),
        }
    _B_in = _B_setup()

    return {
        "A_x": _A_in["x"],
        "A_dft_seq_re": _A_in["dft_seq_re"],
        "A_dft_seq_im": _A_in["dft_seq_im"],
        "A_dft_hid_re": _A_in["dft_hid_re"],
        "A_dft_hid_im": _A_in["dft_hid_im"],
        "B_x": _B_in["x"],
        "B_w_gate": _B_in["w_gate"],
        "B_w_up": _B_in["w_up"],
        "B_w_down": _B_in["w_down"],
    }

def reference(A_x, A_dft_seq_re, A_dft_seq_im, A_dft_hid_re, A_dft_hid_im, B_x, B_w_gate, B_w_up, B_w_down):
    def _A_ref(x, dft_seq_re, dft_seq_im, dft_hid_re, dft_hid_im):
        a = torch.einsum("bsd,ed->bse", x, dft_hid_re)
        b = torch.einsum("bsd,ed->bse", x, dft_hid_im)
        y = torch.einsum("ts,bse->bte", dft_seq_re, a) - torch.einsum("ts,bse->bte", dft_seq_im, b)
        return y

    def _B_ref(x, w_gate, w_up, w_down):
        g = _silu(x @ w_gate)
        u = x @ w_up
        return (g * u) @ w_down

    x = A_x
    h = x + _A_ref(_layernorm(x, axis=-1), A_dft_seq_re, A_dft_seq_im, A_dft_hid_re, A_dft_hid_im)
    h2 = h + _B_ref(_layernorm(h, axis=-1), B_w_gate, B_w_up, B_w_down)
    return h2
```

```asm
; @launch kernel=ka_kernel grid=(256,1,1) block=(512,1,1) lds=45056
; @launch kernel=kb_kernel grid=(256,1,1) block=(256,1,1) lds=53248
; @launch kernel=kc_kernel grid=(256,1,1) block=(256,1,1) lds=157776
; @launch kernel=kd_kernel grid=(256,1,1) block=(256,1,1) lds=163840
.amdgcn_target "amdgcn-amd-amdhsa--gfx950"
.text
.globl ka_kernel
.p2align 8
.type ka_kernel,@function
ka_kernel:
    s_cmp_ge_u32 s2, 256
    s_cbranch_scc1 L_ka_kernel_done_1
    s_load_dwordx2 s[8:9], s[0:1], 0
    s_load_dwordx2 s[4:5], s[0:1], 88
    v_and_b32 v92, 63, v0
    v_lshrrev_b32 v102, 6, v0
    v_and_b32 v93, 15, v0
    v_readfirstlane_b32 s28, v102
    v_lshrrev_b32 v94, 4, v92
    s_getpc_b64 s[60:61]
L_ka_pc:
    s_sub_u32 s60, s60, L_ka_pc-ka_kernel
    s_subb_u32 s61, s61, 0
    s_mov_b32 s62, L_code_end-ka_kernel
    s_mov_b32 s63, 0x20000
    s_lshr_b32 s36, s2, 3
    s_lshl_b32 s36, s36, 3
    s_add_u32 s36, s36, s28
    s_lshl_b32 s36, s36, 8
    v_lshrrev_b32 v103, 1, v92
    v_lshl_add_u32 v103, v103, 13, v92
    v_lshlrev_b32 v103, 7, v103
    buffer_load_dword v127, v103, s[60:63], s36 offen
    s_and_b32 s32, s2, 7
    s_lshr_b32 s33, s2, 4
    s_lshl_b32 s33, s33, 3
    s_add_u32 s29, s32, s33
    s_bfe_u32 s30, s2, 0x10003
    v_lshlrev_b32 v102, 2, v93
    v_lshl_add_u32 v102, v94, 9, v102
    s_lshl_b32 s32, s28, 8
    s_add_u32 s32, s32, s29
    s_lshl_b32 s32, s32, 11
    s_add_u32 s33, s32, 0x40000
    v_cvt_f32_u32 v110, v93
    v_cvt_f32_u32 v111, v94
    s_lshl_b32 s36, s30, 4
    v_add_u32 v112, s36, v93
    v_cvt_f32_u32 v112, v112
    s_waitcnt lgkmcnt(0)
    s_mov_b32 s12, s8
    s_mov_b32 s13, s9
    s_mov_b32 s14, 0x400000
    s_mov_b32 s15, 0x20000
    buffer_load_dword v0, v102, s[12:15], s32 offen offset:0
    buffer_load_dword v1, v102, s[12:15], s32 offen offset:64
    buffer_load_dword v2, v102, s[12:15], s32 offen offset:128
    buffer_load_dword v3, v102, s[12:15], s32 offen offset:192
    buffer_load_dword v4, v102, s[12:15], s32 offen offset:256
    buffer_load_dword v5, v102, s[12:15], s32 offen offset:320
    buffer_load_dword v6, v102, s[12:15], s32 offen offset:384
    buffer_load_dword v7, v102, s[12:15], s32 offen offset:448
    buffer_load_dword v8, v102, s[12:15], s33 offen offset:0
    buffer_load_dword v9, v102, s[12:15], s33 offen offset:64
    buffer_load_dword v10, v102, s[12:15], s33 offen offset:128
    buffer_load_dword v11, v102, s[12:15], s33 offen offset:192
    buffer_load_dword v12, v102, s[12:15], s33 offen offset:256
    buffer_load_dword v13, v102, s[12:15], s33 offen offset:320
    buffer_load_dword v14, v102, s[12:15], s33 offen offset:384
    buffer_load_dword v15, v102, s[12:15], s33 offen offset:448
    s_mov_b32 s16, s4
    s_mov_b32 s17, s5
    s_mov_b32 s18, 0x400000
    s_mov_b32 s19, 0x20000
    s_add_u32 s20, s4, 0x400000
    s_addc_u32 s21, s5, 0
    s_mov_b32 s22, 0x14000
    s_mov_b32 s23, 0x20000
    s_add_u32 s24, s4, 0x1840000
    s_addc_u32 s25, s5, 0
    s_mov_b32 s26, 0x2000
    s_mov_b32 s27, 0x20000
    v_lshlrev_b32 v123, 4, v92
    v_add_u32 v123, 33792, v123
    s_cmp_eq_u32 s28, 1
    s_cbranch_scc1 L_ka_kernel_cj_4
    s_cmp_eq_u32 s28, 2
    s_cbranch_scc1 L_ka_kernel_cj_5
    s_cmp_eq_u32 s28, 3
    s_cbranch_scc1 L_ka_kernel_cj_6
    s_cmp_eq_u32 s28, 4
    s_cbranch_scc1 L_ka_kernel_cj_7
    s_cmp_eq_u32 s28, 5
    s_cbranch_scc1 L_ka_kernel_cj_8
    s_cmp_eq_u32 s28, 6
    s_cbranch_scc1 L_ka_kernel_cj_9
    s_cmp_eq_u32 s28, 7
    s_cbranch_scc1 L_ka_kernel_cend_2
L_ka_kernel_cj_3:
    v_mul_f32 v105, 0x3d000000, v112
    v_mul_f32 v104, 0x41000000, v111
    v_add_f32 v106, 0x00000000, v104
    v_mul_f32 v106, v106, v105
    v_cos_f32 v48, v106
    v_sin_f32 v52, v106
    v_add_f32 v106, 0x3f800000, v104
    v_mul_f32 v106, v106, v105
    v_cos_f32 v49, v106
    v_sin_f32 v53, v106
    v_add_f32 v106, 0x40000000, v104
    v_mul_f32 v106, v106, v105
    v_cos_f32 v50, v106
    v_sin_f32 v54, v106
    v_add_f32 v106, 0x40400000, v104
    v_mul_f32 v106, v106, v105
    v_cos_f32 v51, v106
    v_sin_f32 v55, v106
    s_nop 0
    v_cvt_pk_f16_f32 v56, v48, v49
    v_cvt_pk_f16_f32 v58, -v52, -v53
    v_cvt_pk_f16_f32 v57, v50, v51
    v_cvt_pk_f16_f32 v59, -v54, -v55
    ds_write_b64 v123, v[56:57] offset:0
    ds_write_b64 v123, v[58:59] offset:1024
    s_branch L_ka_kernel_cend_2
L_ka_kernel_cj_4:
    v_mul_f32 v105, 0x3d000000, v112
    v_mul_f32 v104, 0x41000000, v111
    v_add_f32 v106, 0x40800000, v104
    v_mul_f32 v106, v106, v105
    v_cos_f32 v48, v106
    v_sin_f32 v52, v106
    v_add_f32 v106, 0x40a00000, v104
    v_mul_f32 v106, v106, v105
    v_cos_f32 v49, v106
    v_sin_f32 v53, v106
    v_add_f32 v106, 0x40c00000, v104
    v_mul_f32 v106, v106, v105
    v_cos_f32 v50, v106
    v_sin_f32 v54, v106
    v_add_f32 v106, 0x40e00000, v104
    v_mul_f32 v106, v106, v105
    v_cos_f32 v51, v106
    v_sin_f32 v55, v106
    s_nop 0
    v_cvt_pk_f16_f32 v56, v48, v49
    v_cvt_pk_f16_f32 v58, -v52, -v53
    v_cvt_pk_f16_f32 v57, v50, v51
    v_cvt_pk_f16_f32 v59, -v54, -v55
    ds_write_b64 v123, v[56:57] offset:8
    ds_write_b64 v123, v[58:59] offset:1032
    s_branch L_ka_kernel_cend_2
L_ka_kernel_cj_5:
    v_mul_f32 v105, 0x3a800000, v112
    v_mul_f32 v104, 0x41000000, v111
    v_add_f32 v106, 0x00000000, v104
    v_mul_f32 v106, v106, v105
    v_cos_f32 v48, v106
    v_sin_f32 v52, v106
    v_add_f32 v106, 0x40000000, v104
    v_mul_f32 v106, v106, v105
    v_cos_f32 v49, v106
    v_sin_f32 v53, v106
    v_add_f32 v106, 0x40800000, v104
    v_mul_f32 v106, v106, v105
    v_cos_f32 v50, v106
    v_sin_f32 v54, v106
    v_add_f32 v106, 0x40c00000, v104
    v_mul_f32 v106, v106, v105
    v_cos_f32 v51, v106
    v_sin_f32 v55, v106
    s_nop 0
    ds_write_b128 v123, v[48:51] offset:7168
    ds_write_b128 v123, v[52:55] offset:9216
    s_branch L_ka_kernel_cend_2
L_ka_kernel_cj_6:
    v_mul_f32 v105, 0x3a800000, v112
    v_mul_f32 v104, 0x41000000, v111
    v_add_f32 v106, 0x3f800000, v104
    v_mul_f32 v106, v106, v105
    v_cos_f32 v48, v106
    v_sin_f32 v52, v106
    v_add_f32 v106, 0x40400000, v104
    v_mul_f32 v106, v106, v105
    v_cos_f32 v49, v106
    v_sin_f32 v53, v106
    v_add_f32 v106, 0x40a00000, v104
    v_mul_f32 v106, v106, v105
    v_cos_f32 v50, v106
    v_sin_f32 v54, v106
    v_add_f32 v106, 0x40e00000, v104
    v_mul_f32 v106, v106, v105
    v_cos_f32 v51, v106
    v_sin_f32 v55, v106
    s_nop 0
    ds_write_b128 v123, v[48:51] offset:8192
    ds_write_b128 v123, v[52:55] offset:10240
    s_branch L_ka_kernel_cend_2
L_ka_kernel_cj_7:
    v_mul_f32 v105, 0x3d000000, v110
    v_mul_f32 v104, 0x41000000, v111
    v_add_f32 v106, 0x00000000, v104
    v_mul_f32 v106, v106, v105
    v_cos_f32 v48, v106
    v_sin_f32 v52, v106
    v_add_f32 v106, 0x40000000, v104
    v_mul_f32 v106, v106, v105
    v_cos_f32 v49, v106
    v_sin_f32 v53, v106
    v_add_f32 v106, 0x40800000, v104
    v_mul_f32 v106, v106, v105
    v_cos_f32 v50, v106
    v_sin_f32 v54, v106
    v_add_f32 v106, 0x40c00000, v104
    v_mul_f32 v106, v106, v105
    v_cos_f32 v51, v106
    v_sin_f32 v55, v106
    s_nop 0
    v_cvt_pk_f16_f32 v56, v48, v49
    v_cvt_pk_f16_f32 v58, v52, v53
    v_cvt_pk_f16_f32 v60, -v52, -v53
    v_cvt_pk_f16_f32 v57, v50, v51
    v_cvt_pk_f16_f32 v59, v54, v55
    v_cvt_pk_f16_f32 v61, -v54, -v55
    ds_write_b64 v123, v[56:57] offset:2048
    ds_write_b64 v123, v[58:59] offset:3072
    ds_write_b64 v123, v[60:61] offset:4096
    s_branch L_ka_kernel_cend_2
L_ka_kernel_cj_8:
    v_mul_f32 v105, 0x3d000000, v110
    v_mul_f32 v104, 0x41000000, v111
    v_add_f32 v106, 0x3f800000, v104
    v_mul_f32 v106, v106, v105
    v_cos_f32 v48, v106
    v_sin_f32 v52, v106
    v_add_f32 v106, 0x40400000, v104
    v_mul_f32 v106, v106, v105
    v_cos_f32 v49, v106
    v_sin_f32 v53, v106
    v_add_f32 v106, 0x40a00000, v104
    v_mul_f32 v106, v106, v105
    v_cos_f32 v50, v106
    v_sin_f32 v54, v106
    v_add_f32 v106, 0x40e00000, v104
    v_mul_f32 v106, v106, v105
    v_cos_f32 v51, v106
    v_sin_f32 v55, v106
    s_nop 0
    v_cvt_pk_f16_f32 v56, v48, v49
    v_cvt_pk_f16_f32 v58, v52, v53
    v_cvt_pk_f16_f32 v60, -v52, -v53
    v_cvt_pk_f16_f32 v57, v50, v51
    v_cvt_pk_f16_f32 v59, v54, v55
    v_cvt_pk_f16_f32 v61, -v54, -v55
    ds_write_b64 v123, v[56:57] offset:2056
    ds_write_b64 v123, v[58:59] offset:3080
    ds_write_b64 v123, v[60:61] offset:4104
    s_branch L_ka_kernel_cend_2
L_ka_kernel_cj_9:
    v_mul_f32 v105, 0x3d800000, v110
    v_mul_f32 v104, 0x40000000, v111
    v_add_f32 v106, 0x00000000, v104
    v_mul_f32 v106, v106, v105
    v_cos_f32 v48, v106
    v_sin_f32 v52, v106
    v_add_f32 v106, 0x3f800000, v104
    v_mul_f32 v106, v106, v105
    v_cos_f32 v49, v106
    v_sin_f32 v53, v106
    v_add_f32 v106, 0x41000000, v104
    v_mul_f32 v106, v106, v105
    v_cos_f32 v50, v106
    v_sin_f32 v54, v106
    v_add_f32 v106, 0x41100000, v104
    v_mul_f32 v106, v106, v105
    v_cos_f32 v51, v106
    v_sin_f32 v55, v106
    s_nop 0
    v_cvt_pk_f16_f32 v56, v48, v52
    v_cvt_pk_f16_f32 v60, v52, -v48
    v_cvt_pk_f16_f32 v57, v49, v53
    v_cvt_pk_f16_f32 v61, v53, -v49
    v_cvt_pk_f16_f32 v58, v50, v54
    v_cvt_pk_f16_f32 v62, v54, -v50
    v_cvt_pk_f16_f32 v59, v51, v55
    v_cvt_pk_f16_f32 v63, v55, -v51
    ds_write_b128 v123, v[56:59] offset:5120
    ds_write_b128 v123, v[60:63] offset:6144
L_ka_kernel_cend_2:
    v_lshlrev_b32 v96, 5, v93
    v_lshl_add_u32 v96, v94, 3, v96
    s_mul_i32 s36, s28, 2176
    v_add_u32 v96, s36, v96
    v_mul_u32_u24 v97, 544, v92
    v_add_u32 v97, s36, v97
    v_lshrrev_b32 v98, 2, v92
    v_mul_u32_u24 v98, 544, v98
    v_and_b32 v105, 3, v92
    v_lshl_add_u32 v98, v105, 3, v98
    s_lshl_b32 s36, s28, 6
    v_add_u32 v99, s36, v98
    v_and_b32 v109, 1, v94
    v_lshrrev_b32 v110, 1, v94
    v_lshl_add_u32 v109, v109, 1, v110
    v_and_b32 v110, 7, v93
    v_xor_b32 v109, v109, v110
    s_lshl_b32 s36, s28, 11
    s_add_u32 s36, s36, 17408
    v_lshlrev_b32 v110, 7, v93
    v_add_u32 v110, s36, v110
    v_lshl_add_u32 v124, v109, 4, v110
    v_xor_b32 v126, 64, v124
    v_lshrrev_b32 v109, 3, v92
    v_and_b32 v110, 7, v92
    v_xor_b32 v111, v110, v109
    v_lshlrev_b32 v125, 7, v109
    v_lshl_add_u32 v125, v111, 4, v125
    v_add_u32 v125, s36, v125
    v_lshlrev_b32 v100, 17, v109
    v_lshl_add_u32 v100, v110, 4, v100
    s_lshl_b32 s44, s28, 14
    s_lshl_b32 s37, s29, 7
    s_add_u32 s44, s44, s37
    s_lshl_b32 s37, s30, 21
    s_add_u32 s44, s44, s37
    s_add_u32 s45, s44, 0x100000
    v_mul_u32_u24 v101, 5120, v93
    s_lshl_b32 s46, s28, 9
    s_lshl_b32 s47, s29, 2
    s_add_u32 s46, s46, s47
    s_add_u32 s47, s47, 0x1000
    s_lshr_b32 s38, s32, 9
    v_cmp_eq_u32 vcc, 0, v92
    s_waitcnt lgkmcnt(0)
    s_barrier
    ds_read_b128 v[48:51], v123 offset:0
    ds_read_b128 v[52:55], v123 offset:1024
    ds_read_b128 v[56:59], v123 offset:2048
    ds_read_b128 v[60:63], v123 offset:3072
    ds_read_b128 v[64:67], v123 offset:4096
    ds_read_b128 v[68:71], v123 offset:5120
    ds_read_b128 v[72:75], v123 offset:6144
    ds_read_b128 v[76:79], v123 offset:7168
    ds_read_b128 v[80:83], v123 offset:8192
    ds_read_b128 v[84:87], v123 offset:9216
    ds_read_b128 v[88:91], v123 offset:10240
    s_waitcnt vmcnt(8)
    v_lshlrev_b32 v16, 16, v0
    v_and_b32 v17, 0xffff0000, v0
    v_lshlrev_b32 v18, 16, v1
    v_and_b32 v19, 0xffff0000, v1
    v_lshlrev_b32 v20, 16, v2
    v_and_b32 v21, 0xffff0000, v2
    v_lshlrev_b32 v22, 16, v3
    v_and_b32 v23, 0xffff0000, v3
    v_lshlrev_b32 v24, 16, v4
    v_and_b32 v25, 0xffff0000, v4
    v_lshlrev_b32 v26, 16, v5
    v_and_b32 v27, 0xffff0000, v5
    v_lshlrev_b32 v28, 16, v6
    v_and_b32 v29, 0xffff0000, v6
    v_lshlrev_b32 v30, 16, v7
    v_and_b32 v31, 0xffff0000, v7
    v_add_f32 v104, v16, v18
    v_add_f32 v105, v17, v19
    v_add_f32 v104, v104, v20
    v_add_f32 v105, v105, v21
    v_add_f32 v104, v104, v22
    v_add_f32 v105, v105, v23
    v_add_f32 v104, v104, v24
    v_add_f32 v105, v105, v25
    v_add_f32 v104, v104, v26
    v_add_f32 v105, v105, v27
    v_add_f32 v104, v104, v28
    v_add_f32 v105, v105, v29
    v_add_f32 v104, v104, v30
    v_add_f32 v105, v105, v31
    s_waitcnt vmcnt(0)
    v_lshlrev_b32 v32, 16, v8
    v_and_b32 v33, 0xffff0000, v8
    v_lshlrev_b32 v34, 16, v9
    v_and_b32 v35, 0xffff0000, v9
    v_lshlrev_b32 v36, 16, v10
    v_and_b32 v37, 0xffff0000, v10
    v_lshlrev_b32 v38, 16, v11
    v_and_b32 v39, 0xffff0000, v11
    v_lshlrev_b32 v40, 16, v12
    v_and_b32 v41, 0xffff0000, v12
    v_lshlrev_b32 v42, 16, v13
    v_and_b32 v43, 0xffff0000, v13
    v_lshlrev_b32 v44, 16, v14
    v_and_b32 v45, 0xffff0000, v14
    v_lshlrev_b32 v46, 16, v15
    v_and_b32 v47, 0xffff0000, v15
    v_add_f32 v106, v32, v34
    v_add_f32 v107, v33, v35
    v_add_f32 v106, v106, v36
    v_add_f32 v107, v107, v37
    v_add_f32 v106, v106, v38
    v_add_f32 v107, v107, v39
    v_add_f32 v106, v106, v40
    v_add_f32 v107, v107, v41
    v_add_f32 v106, v106, v42
    v_add_f32 v107, v107, v43
    v_add_f32 v106, v106, v44
    v_add_f32 v107, v107, v45
    v_add_f32 v106, v106, v46
    v_add_f32 v107, v107, v47
    s_nop 1
    v_permlane32_swap_b32 v104, v105
    v_permlane32_swap_b32 v106, v107
    v_add_f32 v104, v104, v105
    v_add_f32 v106, v106, v107
    s_nop 1
    v_permlane16_swap_b32 v104, v106
    v_add_f32 v104, v104, v106
    s_nop 1
    v_add_f32_dpp v104, v104, v104 quad_perm:[1,0,3,2] row_mask:0xf bank_mask:0xf
    s_nop 1
    v_add_f32_dpp v104, v104, v104 quad_perm:[2,3,0,1] row_mask:0xf bank_mask:0xf
    s_nop 1
    v_add_f32_dpp v104, v104, v104 row_half_mirror row_mask:0xf bank_mask:0xf
    s_nop 1
    v_add_f32_dpp v104, v104, v104 row_mirror row_mask:0xf bank_mask:0xf
    s_nop 0
    v_readlane_b32 s40, v104, 0
    v_readlane_b32 s41, v104, 32
    v_readlane_b32 s42, v104, 16
    v_readlane_b32 s43, v104, 48
    s_nop 1
    v_mov_b32 v114, s40
    v_add_f32 v108, s41, v114
    v_subrev_f32 v112, s41, v114
    v_mul_f32 v108, 0x3a800000, v108
    v_cvt_pk_bf16_f32 v109, v108, v108
    v_lshlrev_b32 v109, 16, v109
    v_mov_b32 v114, s42
    v_add_f32 v110, s43, v114
    v_subrev_f32 v113, s43, v114
    v_mul_f32 v110, 0x3a800000, v110
    v_cvt_pk_bf16_f32 v111, v110, v110
    v_lshlrev_b32 v111, 16, v111
    v_sub_f32 v16, v16, v109
    v_sub_f32 v17, v17, v109
    v_sub_f32 v18, v18, v109
    v_sub_f32 v19, v19, v109
    v_sub_f32 v20, v20, v109
    v_sub_f32 v21, v21, v109
    v_sub_f32 v22, v22, v109
    v_sub_f32 v23, v23, v109
    v_sub_f32 v24, v24, v109
    v_sub_f32 v25, v25, v109
    v_sub_f32 v26, v26, v109
    v_sub_f32 v27, v27, v109
    v_sub_f32 v28, v28, v109
    v_sub_f32 v29, v29, v109
    v_sub_f32 v30, v30, v109
    v_sub_f32 v31, v31, v109
    v_mul_f32 v104, v16, v16
    v_mul_f32 v105, v17, v17
    v_fmac_f32 v104, v18, v18
    v_fmac_f32 v105, v19, v19
    v_fmac_f32 v104, v20, v20
    v_fmac_f32 v105, v21, v21
    v_fmac_f32 v104, v22, v22
    v_fmac_f32 v105, v23, v23
    v_fmac_f32 v104, v24, v24
    v_fmac_f32 v105, v25, v25
    v_fmac_f32 v104, v26, v26
    v_fmac_f32 v105, v27, v27
    v_fmac_f32 v104, v28, v28
    v_fmac_f32 v105, v29, v29
    v_fmac_f32 v104, v30, v30
    v_fmac_f32 v105, v31, v31
    v_sub_f32 v32, v32, v111
    v_sub_f32 v33, v33, v111
    v_sub_f32 v34, v34, v111
    v_sub_f32 v35, v35, v111
    v_sub_f32 v36, v36, v111
    v_sub_f32 v37, v37, v111
    v_sub_f32 v38, v38, v111
    v_sub_f32 v39, v39, v111
    v_sub_f32 v40, v40, v111
    v_sub_f32 v41, v41, v111
    v_sub_f32 v42, v42, v111
    v_sub_f32 v43, v43, v111
    v_sub_f32 v44, v44, v111
    v_sub_f32 v45, v45, v111
    v_sub_f32 v46, v46, v111
    v_sub_f32 v47, v47, v111
    v_mul_f32 v106, v32, v32
    v_mul_f32 v107, v33, v33
    v_fmac_f32 v106, v34, v34
    v_fmac_f32 v107, v35, v35
    v_fmac_f32 v106, v36, v36
    v_fmac_f32 v107, v37, v37
    v_fmac_f32 v106, v38, v38
    v_fmac_f32 v107, v39, v39
    v_fmac_f32 v106, v40, v40
    v_fmac_f32 v107, v41, v41
    v_fmac_f32 v106, v42, v42
    v_fmac_f32 v107, v43, v43
    v_fmac_f32 v106, v44, v44
    v_fmac_f32 v107, v45, v45
    v_fmac_f32 v106, v46, v46
    v_fmac_f32 v107, v47, v47
    s_nop 1
    v_permlane32_swap_b32 v104, v105
    v_permlane32_swap_b32 v106, v107
    v_add_f32 v104, v104, v105
    v_add_f32 v106, v106, v107
    s_nop 1
    v_permlane16_swap_b32 v104, v106
    v_add_f32 v104, v104, v106
    s_nop 1
    v_add_f32_dpp v104, v104, v104 quad_perm:[1,0,3,2] row_mask:0xf bank_mask:0xf
    s_nop 1
    v_add_f32_dpp v104, v104, v104 quad_perm:[2,3,0,1] row_mask:0xf bank_mask:0xf
    s_nop 1
    v_add_f32_dpp v104, v104, v104 row_half_mirror row_mask:0xf bank_mask:0xf
    s_nop 1
    v_add_f32_dpp v104, v104, v104 row_mirror row_mask:0xf bank_mask:0xf
    s_nop 0
    v_readlane_b32 s40, v104, 0
    v_readlane_b32 s41, v104, 32
    v_readlane_b32 s42, v104, 16
    v_readlane_b32 s43, v104, 48
    s_nop 1
    v_mov_b32 v114, s40
    v_mov_b32 v116, s42
    v_add_f32 v114, s41, v114
    v_add_f32 v116, s43, v116
    v_sub_f32 v109, v108, v109
    v_mul_f32 v114, 0x3a800000, v114
    v_fma_f32 v114, -v109, v109, v114
    v_max_f32 v114, 0, v114
    v_sub_f32 v111, v110, v111
    v_mul_f32 v116, 0x3a800000, v116
    v_fma_f32 v116, -v111, v111, v116
    v_max_f32 v116, 0, v116
    v_cvt_pk_bf16_f32 v114, v114, v114
    v_cvt_pk_bf16_f32 v116, v116, v116
    v_lshlrev_b32 v114, 16, v114
    v_lshlrev_b32 v116, 16, v116
    v_add_f32 v114, 0x3727c5ac, v114
    v_add_f32 v116, 0x3727c5ac, v116
    v_cvt_pk_bf16_f32 v114, v114, v114
    v_cvt_pk_bf16_f32 v116, v116, v116
    v_lshlrev_b32 v114, 16, v114
    v_lshlrev_b32 v116, 16, v116
    v_sqrt_f32 v114, v114
    v_sqrt_f32 v116, v116
    s_nop 0
    v_cvt_pk_bf16_f32 v114, v114, v114
    v_cvt_pk_bf16_f32 v116, v116, v116
    v_lshlrev_b32 v114, 16, v114
    v_lshlrev_b32 v116, 16, v116
    v_rcp_f32 v114, v114
    v_rcp_f32 v116, v116
    s_nop 0
    v_mov_b32 v118, 0
    s_mov_b64 exec, 1
    buffer_store_dword v108, v118, s[24:27], s38 offen
    buffer_store_dword v110, v118, s[24:27], s38 offen offset:512
    s_mov_b64 exec, -1
    s_waitcnt lgkmcnt(0)
    v_mul_f32 v16, v16, v114
    v_mul_f32 v17, v17, v114
    v_mul_f32 v18, v18, v114
    v_mul_f32 v19, v19, v114
    v_mul_f32 v20, v20, v114
    v_mul_f32 v21, v21, v114
    v_mul_f32 v22, v22, v114
    v_mul_f32 v23, v23, v114
    v_mul_f32 v24, v24, v114
    v_mul_f32 v25, v25, v114
    v_mul_f32 v26, v26, v114
    v_mul_f32 v27, v27, v114
    v_mul_f32 v28, v28, v114
    v_mul_f32 v29, v29, v114
    v_mul_f32 v30, v30, v114
    v_mul_f32 v31, v31, v114
    v_mul_f32 v112, v112, v114
    v_cvt_pk_f16_f32 v0, v16, v18
    v_cvt_pk_f16_f32 v1, v20, v22
    v_cvt_pk_f16_f32 v2, v24, v26
    v_cvt_pk_f16_f32 v3, v28, v30
    v_cvt_pk_f16_f32 v4, v17, v19
    v_cvt_pk_f16_f32 v5, v21, v23
    v_cvt_pk_f16_f32 v6, v25, v27
    v_cvt_pk_f16_f32 v7, v29, v31
    v_cvt_pk_f16_f32 v112, v112, v16
    v_cndmask_b32 v112, 0, v112, vcc
    v_mfma_f32_16x16x32_f16 v[16:19], v[0:3], v[48:51], 0
    v_mfma_f32_16x16x32_f16 v[24:27], v[0:3], v[52:55], 0
    v_mfma_f32_16x16x32_f16 v[20:23], v[4:7], v[48:51], 0
    v_mfma_f32_16x16x32_f16 v[28:31], v[4:7], v[52:55], 0
    v_mul_f32 v32, v32, v116
    v_mul_f32 v33, v33, v116
    v_mul_f32 v34, v34, v116
    v_mul_f32 v35, v35, v116
    v_mul_f32 v36, v36, v116
    v_mul_f32 v37, v37, v116
    v_mul_f32 v38, v38, v116
    v_mul_f32 v39, v39, v116
    v_mul_f32 v40, v40, v116
    v_mul_f32 v41, v41, v116
    v_mul_f32 v42, v42, v116
    v_mul_f32 v43, v43, v116
    v_mul_f32 v44, v44, v116
    v_mul_f32 v45, v45, v116
    v_mul_f32 v46, v46, v116
    v_mul_f32 v47, v47, v116
    v_mul_f32 v113, v113, v116
    v_cvt_pk_f16_f32 v8, v32, v34
    v_cvt_pk_f16_f32 v9, v36, v38
    v_cvt_pk_f16_f32 v10, v40, v42
    v_cvt_pk_f16_f32 v11, v44, v46
    v_cvt_pk_f16_f32 v12, v33, v35
    v_cvt_pk_f16_f32 v13, v37, v39
    v_cvt_pk_f16_f32 v14, v41, v43
    v_cvt_pk_f16_f32 v15, v45, v47
    v_cvt_pk_f16_f32 v113, v113, v32
    v_cndmask_b32 v113, 0, v113, vcc
    v_mfma_f32_16x16x32_f16 v[32:35], v[8:11], v[48:51], 0
    v_mfma_f32_16x16x32_f16 v[40:43], v[8:11], v[52:55], 0
    v_mfma_f32_16x16x32_f16 v[36:39], v[12:15], v[48:51], 0
    v_mfma_f32_16x16x32_f16 v[44:47], v[12:15], v[52:55], 0
    s_mov_b64 exec, 3
    ds_write_b32 v97, v112 offset:512
    ds_write_b32 v97, v113 offset:1600
    s_mov_b64 exec, -1
    v_mul_f32 v104, v16, v76
    v_mul_f32 v105, v17, v77
    v_fmac_f32 v104, v24, v84
    v_fmac_f32 v105, v25, v85
    v_mul_f32 v24, v24, v76
    v_mul_f32 v25, v25, v77
    v_fma_f32 v24, -v16, v84, v24
    v_fma_f32 v25, -v17, v85, v25
    v_mul_f32 v106, v18, v78
    v_mul_f32 v107, v19, v79
    v_fmac_f32 v106, v26, v86
    v_fmac_f32 v107, v27, v87
    v_mul_f32 v26, v26, v78
    v_mul_f32 v27, v27, v79
    v_fma_f32 v26, -v18, v86, v26
    v_fma_f32 v27, -v19, v87, v27
    v_mul_f32 v108, v20, v80
    v_mul_f32 v109, v21, v81
    v_fmac_f32 v108, v28, v88
    v_fmac_f32 v109, v29, v89
    v_mul_f32 v28, v28, v80
    v_mul_f32 v29, v29, v81
    v_fma_f32 v28, -v20, v88, v28
    v_fma_f32 v29, -v21, v89, v29
    v_mul_f32 v110, v22, v82
    v_mul_f32 v111, v23, v83
    v_fmac_f32 v110, v30, v90
    v_fmac_f32 v111, v31, v91
    v_mul_f32 v30, v30, v82
    v_mul_f32 v31, v31, v83
    v_fma_f32 v30, -v22, v90, v30
    v_fma_f32 v31, -v23, v91, v31
    v_cvt_pk_f16_f32 v0, v104, v105
    v_cvt_pk_f16_f32 v4, v24, v25
    v_cvt_pk_f16_f32 v1, v106, v107
    v_cvt_pk_f16_f32 v5, v26, v27
    v_cvt_pk_f16_f32 v2, v108, v109
    v_cvt_pk_f16_f32 v6, v28, v29
    v_cvt_pk_f16_f32 v3, v110, v111
    v_cvt_pk_f16_f32 v7, v30, v31
    s_nop 1
    v_mfma_f32_16x16x32_f16 v[16:19], v[0:3], v[56:59], 0
    v_mfma_f32_16x16x32_f16 v[20:23], v[4:7], v[56:59], 0
    v_mfma_f32_16x16x32_f16 v[16:19], v[4:7], v[60:63], v[16:19]
    v_mfma_f32_16x16x32_f16 v[20:23], v[0:3], v[64:67], v[20:23]
    v_mul_f32 v104, v32, v76
    v_mul_f32 v105, v33, v77
    v_fmac_f32 v104, v40, v84
    v_fmac_f32 v105, v41, v85
    v_mul_f32 v40, v40, v76
    v_mul_f32 v41, v41, v77
    v_fma_f32 v40, -v32, v84, v40
    v_fma_f32 v41, -v33, v85, v41
    v_mul_f32 v106, v34, v78
    v_mul_f32 v107, v35, v79
    v_fmac_f32 v106, v42, v86
    v_fmac_f32 v107, v43, v87
    v_mul_f32 v42, v42, v78
    v_mul_f32 v43, v43, v79
    v_fma_f32 v42, -v34, v86, v42
    v_fma_f32 v43, -v35, v87, v43
    v_mul_f32 v108, v36, v80
    v_mul_f32 v109, v37, v81
    v_fmac_f32 v108, v44, v88
    v_fmac_f32 v109, v45, v89
    v_mul_f32 v44, v44, v80
    v_mul_f32 v45, v45, v81
    v_fma_f32 v44, -v36, v88, v44
    v_fma_f32 v45, -v37, v89, v45
    v_mul_f32 v110, v38, v82
    v_mul_f32 v111, v39, v83
    v_fmac_f32 v110, v46, v90
    v_fmac_f32 v111, v47, v91
    v_mul_f32 v46, v46, v82
    v_mul_f32 v47, v47, v83
    v_fma_f32 v46, -v38, v90, v46
    v_fma_f32 v47, -v39, v91, v47
    v_cvt_pk_f16_f32 v8, v104, v105
    v_cvt_pk_f16_f32 v12, v40, v41
    v_cvt_pk_f16_f32 v9, v106, v107
    v_cvt_pk_f16_f32 v13, v42, v43
    v_cvt_pk_f16_f32 v10, v108, v109
    v_cvt_pk_f16_f32 v14, v44, v45
    v_cvt_pk_f16_f32 v11, v110, v111
    v_cvt_pk_f16_f32 v15, v46, v47
    s_nop 1
    v_mfma_f32_16x16x32_f16 v[32:35], v[8:11], v[56:59], 0
    v_mfma_f32_16x16x32_f16 v[36:39], v[12:15], v[56:59], 0
    v_mfma_f32_16x16x32_f16 v[32:35], v[12:15], v[60:63], v[32:35]
    v_mfma_f32_16x16x32_f16 v[36:39], v[8:11], v[64:67], v[36:39]
    v_cvt_pk_f16_f32 v24, v16, v17
    v_cvt_pk_f16_f32 v25, v18, v19
    ds_write_b64 v96, v[24:25] offset:0
    v_cvt_pk_f16_f32 v26, v20, v21
    v_cvt_pk_f16_f32 v27, v22, v23
    ds_write_b64 v96, v[26:27] offset:544
    s_nop 3
    v_cvt_pk_f16_f32 v40, v32, v33
    v_cvt_pk_f16_f32 v41, v34, v35
    ds_write_b64 v96, v[40:41] offset:1088
    v_cvt_pk_f16_f32 v42, v36, v37
    v_cvt_pk_f16_f32 v43, v38, v39
    ds_write_b64 v96, v[42:43] offset:1632
    s_waitcnt lgkmcnt(0)
    s_barrier
    ds_read_b64_tr_b16 v[0:1], v99 offset:0
    ds_read_b64_tr_b16 v[2:3], v99 offset:8704
    ds_read_b64_tr_b16 v[4:5], v99 offset:32
    ds_read_b64_tr_b16 v[6:7], v99 offset:8736
    ds_read_b64_tr_b16 v[8:9], v98 offset:512
    ds_read_b64_tr_b16 v[10:11], v98 offset:9216
    s_waitcnt lgkmcnt(4)
    v_mfma_f32_16x16x32_f16 v[16:19], v[0:3], v[68:71], 0
    v_mfma_f32_16x16x32_f16 v[20:23], v[0:3], v[72:75], 0
    s_waitcnt lgkmcnt(2)
    v_mfma_f32_16x16x32_f16 v[24:27], v[4:7], v[68:71], 0
    v_mfma_f32_16x16x32_f16 v[28:31], v[4:7], v[72:75], 0
    s_waitcnt lgkmcnt(0)
    v_mfma_f32_16x16x32_f16 v[32:35], v[8:11], v[68:71], 0
    v_mfma_f32_16x16x32_f16 v[36:39], v[8:11], v[72:75], 0
    s_nop 4
    v_cvt_pk_f16_f32 v104, v16, v17
    v_cvt_pk_f16_f32 v105, v18, v19
    v_cvt_pk_f16_f32 v106, v24, v25
    v_cvt_pk_f16_f32 v107, v26, v27
    v_cvt_pk_f16_f32 v108, v20, v21
    v_cvt_pk_f16_f32 v109, v22, v23
    v_cvt_pk_f16_f32 v110, v28, v29
    v_cvt_pk_f16_f32 v111, v30, v31
    v_cvt_pk_f16_f32 v112, v16, v20
    v_cvt_pk_f16_f32 v113, v32, v36
    v_cvt_pk_f16_f32 v114, v33, v37
    v_permlane16_swap_b32 v104, v106
    v_permlane16_swap_b32 v105, v107
    ds_write_b128 v124, v[104:107]
    v_permlane16_swap_b32 v108, v110
    v_permlane16_swap_b32 v109, v111
    ds_write_b128 v126, v[108:111]
    s_waitcnt lgkmcnt(0)
    ds_read_b128 v[0:3], v125 offset:0
    ds_read_b128 v[4:7], v125 offset:1024
    s_cmp_lg_u32 s30, 0
    s_cbranch_scc1 L_ka_kernel_skip_11
    s_mov_b64 exec, 0xffff
    buffer_store_dword v112, v101, s[20:23], s46 offen
    s_cmp_lg_u32 s28, 0
    s_cbranch_scc1 L_ka_kernel_skip_11
    buffer_store_dword v113, v101, s[20:23], s47 offen
    buffer_store_dword v114, v101, s[20:23], s47 offen offset:512
L_ka_kernel_skip_11:
    s_mov_b64 exec, -1
    s_waitcnt lgkmcnt(1)
    buffer_store_dwordx4 v[0:3], v100, s[16:19], s44 offen sc1
    s_waitcnt lgkmcnt(0)
    buffer_store_dwordx4 v[4:7], v100, s[16:19], s45 offen sc1
L_ka_kernel_fin_10:
L_ka_kernel_done_1:
    s_endpgm
.section .rodata,"a"
.p2align 6
.amdhsa_kernel ka_kernel
  .amdhsa_next_free_vgpr 128
  .amdhsa_next_free_sgpr 102
  .amdhsa_accum_offset 128
  .amdhsa_group_segment_fixed_size 0
  .amdhsa_kernarg_size 96
  .amdhsa_user_sgpr_count 2
  .amdhsa_user_sgpr_kernarg_segment_ptr 1
  .amdhsa_system_sgpr_workgroup_id_x 1
  .amdhsa_float_denorm_mode_32 3
  .amdhsa_float_denorm_mode_16_64 3
.end_amdhsa_kernel
.text
.globl kb_kernel
.p2align 8
.type kb_kernel,@function
kb_kernel:
    s_cmp_ge_u32 s2, 256
    s_cbranch_scc1 L_kb_kernel_done_1
    s_load_dwordx2 s[8:9], s[0:1], 0
    s_load_dwordx2 s[4:5], s[0:1], 88
    s_load_dwordx4 s[92:95], s[0:1], 48
    s_load_dwordx2 s[96:97], s[0:1], 64
    v_and_b32 v134, 63, v0
    v_lshrrev_b32 v152, 6, v0
    v_and_b32 v135, 15, v0
    v_readfirstlane_b32 s28, v152
    v_lshrrev_b32 v136, 4, v134
    s_and_b32 s29, s2, 15
    s_bfe_u32 s30, s2, 0x10004
    s_lshr_b32 s31, s2, 5
    v_bfe_u32 v155, v134, 2, 2
    v_lshl_add_u32 v155, v136, 3, v155
    v_lshlrev_b32 v155, 6, v155
    v_and_b32 v156, 1, v136
    v_lshlrev_b32 v156, 1, v156
    v_and_b32 v157, 3, v134
    v_xor_b32 v157, v157, v156
    v_lshl_add_u32 v155, v157, 4, v155
    v_add_u32 v160, 4096, v155
    v_add_u32 v161, 3328, v155
    v_lshrrev_b32 v152, 3, v134
    v_and_b32 v154, 7, v134
    s_lshl_b32 s32, s29, 3
    s_add_u32 s32, s32, s31
    s_lshl_b32 s32, s32, 14
    s_lshl_b32 s33, s28, 12
    s_add_u32 s32, s32, s33
    s_add_u32 s34, s32, 0x200000
    s_lshl_b32 s35, s30, 2
    s_add_u32 s35, s35, s28
    s_lshl_b32 s36, s35, 8
    s_add_u32 s36, s36, s29
    v_lshlrev_b32 v138, 4, v135
    v_add_u32 v138, s36, v138
    v_sub_u32 v139, 0x800, v138
    v_and_b32 v139, 0x7ff, v139
    v_add_u32 v155, 0, v152
    v_lshrrev_b32 v156, 1, v155
    v_xor_b32 v156, v156, v154
    v_lshlrev_b32 v155, 4, v155
    v_add_u32 v155, s36, v155
    v_lshlrev_b32 v157, 11, v155
    v_lshl_add_u32 v157, v156, 4, v157
    v_add_u32 v164, 4096, v157
    v_sub_u32 v155, 0x800, v155
    v_and_b32 v155, 0x7ff, v155
    v_lshlrev_b32 v157, 11, v155
    v_lshl_add_u32 v157, v156, 4, v157
    v_add_u32 v166, 2048, v157
    v_add_u32 v155, 8, v152
    v_lshrrev_b32 v156, 1, v155
    v_xor_b32 v156, v156, v154
    v_lshlrev_b32 v155, 4, v155
    v_add_u32 v155, s36, v155
    v_lshlrev_b32 v157, 11, v155
    v_lshl_add_u32 v157, v156, 4, v157
    v_add_u32 v165, 3072, v157
    v_sub_u32 v155, 0x800, v155
    v_and_b32 v155, 0x7ff, v155
    v_lshlrev_b32 v157, 11, v155
    v_lshl_add_u32 v157, v156, 4, v157
    v_add_u32 v167, 1024, v157
    s_lshl_b32 s37, s31, 7
    s_sub_u32 s38, 1920, s37
    s_add_u32 s39, s31, 1
    v_mov_b32 v155, s39
    v_cmp_gt_u32 vcc, 32, v134
    s_mul_i32 s39, s29, 5120
    v_and_b32 v156, 31, v134
    v_cndmask_b32 v155, 9, v155, vcc
    v_lshlrev_b32 v155, 9, v155
    v_lshl_add_u32 v168, v156, 4, v155
    v_lshlrev_b32 v169, 2, v138
    v_lshlrev_b32 v170, 2, v139
    v_cvt_f32_u32 v173, v138
    v_mul_f32 v173, 0x3a000000, v173
    v_cvt_f32_u32 v178, v136
    v_mul_f32 v178, v178, v173
    v_mul_f32 v178, 4.0, v178
    v_mul_f32 v179, 0x41800000, v173
    v_fract_f32 v179, v179
    v_fract_f32 v172, v178
    v_add_f32 v178, v172, v179
    v_cos_f32 v174, v172
    v_sin_f32 v176, -v172
    v_add_f32 v172, v172, v173
    v_cos_f32 v175, v172
    v_sin_f32 v177, -v172
    v_add_f32 v172, v172, v173
    v_cvt_pk_f16_f32 v0, v174, v176
    v_cvt_pk_f16_f32 v1, v175, v177
    v_cos_f32 v174, v172
    v_sin_f32 v176, -v172
    v_add_f32 v172, v172, v173
    v_cos_f32 v175, v172
    v_sin_f32 v177, -v172
    v_cvt_pk_f16_f32 v2, v174, v176
    v_cvt_pk_f16_f32 v3, v175, v177
    v_fract_f32 v172, v178
    s_waitcnt lgkmcnt(0)
    s_sub_u32 s16, s4, 0x1000
    s_subb_u32 s17, s5, 0
    s_mov_b32 s18, 0x401000
    s_mov_b32 s19, 0x20000
    s_add_u32 m0, s33, 0
    s_nop 0
    buffer_load_dwordx4 v160, s[16:19], s32 offen offset:0 lds
    buffer_load_dwordx4 v161, s[16:19], s32 offen offset:1024 lds
    buffer_load_dwordx4 v160, s[16:19], s32 offen offset:2048 lds
    buffer_load_dwordx4 v161, s[16:19], s32 offen offset:3072 lds
    s_add_u32 m0, s33, 16384
    s_nop 0
    buffer_load_dwordx4 v160, s[16:19], s34 offen offset:0 lds
    buffer_load_dwordx4 v161, s[16:19], s34 offen offset:1024 lds
    buffer_load_dwordx4 v160, s[16:19], s34 offen offset:2048 lds
    buffer_load_dwordx4 v161, s[16:19], s34 offen offset:3072 lds
    s_add_u32 s20, s4, 0x400000
    s_addc_u32 s21, s5, 0
    s_mov_b32 s22, 0x14000
    s_mov_b32 s23, 0x20000
    s_lshl_b32 s35, s28, 10
    s_add_u32 m0, s35, 49152
    s_nop 0
    buffer_load_dwordx4 v168, s[20:23], s39 offen lds
    v_add_f32 v178, v172, v179
    v_cos_f32 v174, v172
    v_sin_f32 v176, -v172
    v_add_f32 v172, v172, v173
    v_cos_f32 v175, v172
    v_sin_f32 v177, -v172
    v_add_f32 v172, v172, v173
    v_cvt_pk_f16_f32 v4, v174, v176
    v_cvt_pk_f16_f32 v5, v175, v177
    v_cos_f32 v174, v172
    v_sin_f32 v176, -v172
    v_add_f32 v172, v172, v173
    v_cos_f32 v175, v172
    s_sub_u32 s12, s8, 0x1000
    s_subb_u32 s13, s9, 0
    s_mov_b32 s14, 0x401000
    s_mov_b32 s15, 0x20000
    s_lshl_b32 s35, s28, 12
    s_add_u32 m0, s35, 32768
    s_nop 0
    buffer_load_dwordx4 v164, s[12:15], s37 offen offset:0 lds
    v_sin_f32 v177, -v172
    v_cvt_pk_f16_f32 v6, v174, v176
    v_cvt_pk_f16_f32 v7, v175, v177
    v_fract_f32 v172, v178
    v_add_f32 v178, v172, v179
    v_cos_f32 v174, v172
    v_sin_f32 v176, -v172
    v_add_f32 v172, v172, v173
    v_cos_f32 v175, v172
    v_sin_f32 v177, -v172
    v_add_f32 v172, v172, v173
    v_cvt_pk_f16_f32 v8, v174, v176
    v_cvt_pk_f16_f32 v9, v175, v177
    v_cos_f32 v174, v172
    buffer_load_dwordx4 v165, s[12:15], s37 offen offset:1024 lds
    v_sin_f32 v176, -v172
    v_add_f32 v172, v172, v173
    v_cos_f32 v175, v172
    v_sin_f32 v177, -v172
    v_cvt_pk_f16_f32 v10, v174, v176
    v_cvt_pk_f16_f32 v11, v175, v177
    v_fract_f32 v172, v178
    v_add_f32 v178, v172, v179
    v_cos_f32 v174, v172
    v_sin_f32 v176, -v172
    v_add_f32 v172, v172, v173
    v_cos_f32 v175, v172
    v_sin_f32 v177, -v172
    v_add_f32 v172, v172, v173
    buffer_load_dwordx4 v166, s[12:15], s38 offen offset:2048 lds
    v_cvt_pk_f16_f32 v12, v174, v176
    v_cvt_pk_f16_f32 v13, v175, v177
    v_cos_f32 v174, v172
    v_sin_f32 v176, -v172
    v_add_f32 v172, v172, v173
    v_cos_f32 v175, v172
    v_sin_f32 v177, -v172
    v_cvt_pk_f16_f32 v14, v174, v176
    v_cvt_pk_f16_f32 v15, v175, v177
    v_fract_f32 v172, v178
    v_add_f32 v178, v172, v179
    v_cos_f32 v174, v172
    v_sin_f32 v176, -v172
    v_add_f32 v172, v172, v173
    buffer_load_dwordx4 v167, s[12:15], s38 offen offset:3072 lds
    v_cos_f32 v175, v172
    v_sin_f32 v177, -v172
    v_add_f32 v172, v172, v173
    v_cvt_pk_f16_f32 v16, v174, v176
    v_cvt_pk_f16_f32 v17, v175, v177
    v_cos_f32 v174, v172
    v_sin_f32 v176, -v172
    v_add_f32 v172, v172, v173
    v_cos_f32 v175, v172
    v_sin_f32 v177, -v172
    v_cvt_pk_f16_f32 v18, v174, v176
    v_cvt_pk_f16_f32 v19, v175, v177
    v_fract_f32 v172, v178
    v_add_f32 v178, v172, v179
    s_add_u32 s24, s4, 0x1840000
    s_addc_u32 s25, s5, 0
    s_mov_b32 s26, 0x2000
    s_mov_b32 s27, 0x20000
    buffer_load_dword v132, v169, s[24:27], 0 offen
    v_cos_f32 v174, v172
    v_sin_f32 v176, -v172
    v_add_f32 v172, v172, v173
    v_cos_f32 v175, v172
    v_sin_f32 v177, -v172
    v_add_f32 v172, v172, v173
    v_cvt_pk_f16_f32 v20, v174, v176
    v_cvt_pk_f16_f32 v21, v175, v177
    v_cos_f32 v174, v172
    v_sin_f32 v176, -v172
    v_add_f32 v172, v172, v173
    v_cos_f32 v175, v172
    v_sin_f32 v177, -v172
    v_cvt_pk_f16_f32 v22, v174, v176
    buffer_load_dword v133, v170, s[24:27], 0 offen
    v_cvt_pk_f16_f32 v23, v175, v177
    v_fract_f32 v172, v178
    v_add_f32 v178, v172, v179
    v_cos_f32 v174, v172
    v_sin_f32 v176, -v172
    v_add_f32 v172, v172, v173
    v_cos_f32 v175, v172
    v_sin_f32 v177, -v172
    v_add_f32 v172, v172, v173
    v_cvt_pk_f16_f32 v24, v174, v176
    v_cvt_pk_f16_f32 v25, v175, v177
    v_cos_f32 v174, v172
    v_sin_f32 v176, -v172
    v_add_f32 v172, v172, v173
    v_min_u32 v180, 27, v134
    v_mul_u32_u24 v181, 9363, v180
    v_lshrrev_b32 v181, 16, v181
    v_mul_u32_u24 v182, 7, v181
    v_sub_u32 v182, v180, v182
    v_mul_u32_u24 v181, 7168, v181
    v_lshl_add_u32 v181, v182, 7, v181
    s_lshr_b32 s46, s2, 3
    s_mul_i32 s46, s46, 57344
    s_lshr_b32 s47, s28, 1
    s_mul_i32 s47, s47, 28672
    s_add_u32 s46, s46, s47
    s_and_b32 s47, s2, 7
    s_mul_i32 s47, s47, 896
    s_add_u32 s46, s46, s47
    s_bitcmp0_b32 s28, 0
    s_cselect_b32 s60, s92, s94
    s_cselect_b32 s61, s93, s95
    s_mov_b32 s62, 0x700000
    s_mov_b32 s63, 0x20000
    buffer_load_dword v183, v181, s[60:63], s46 offen
    v_cos_f32 v175, v172
    v_sin_f32 v177, -v172
    v_cvt_pk_f16_f32 v26, v174, v176
    v_cvt_pk_f16_f32 v27, v175, v177
    v_fract_f32 v172, v178
    v_cos_f32 v174, v172
    v_sin_f32 v176, -v172
    v_add_f32 v172, v172, v173
    v_cos_f32 v175, v172
    v_sin_f32 v177, -v172
    v_add_f32 v172, v172, v173
    v_cvt_pk_f16_f32 v28, v174, v176
    v_cvt_pk_f16_f32 v29, v175, v177
    v_cos_f32 v174, v172
    v_sin_f32 v176, -v172
    v_add_f32 v172, v172, v173
    v_cos_f32 v175, v172
    v_sin_f32 v177, -v172
    v_cvt_pk_f16_f32 v30, v174, v176
    v_cvt_pk_f16_f32 v31, v175, v177
    v_lshrrev_b32 v152, 2, v134
    v_and_b32 v154, 3, v134
    v_lshlrev_b32 v154, 3, v154
    v_lshl_add_u32 v154, v152, 6, v154
    v_and_b32 v153, 1, v136
    v_lshl_add_u32 v140, v153, 5, v154
    v_xor_b32 v141, 32, v140
    v_and_b32 v152, 1, v135
    v_lshlrev_b32 v152, 9, v152
    v_lshl_add_u32 v152, v136, 4, v152
    s_lshl_b32 s35, s28, 10
    s_add_u32 s35, s35, 49152
    v_add_u32 v151, s35, v152
    v_and_b32 v152, 1, v136
    v_lshrrev_b32 v153, 1, v136
    v_lshl_add_u32 v137, v152, 1, v153
    v_lshrrev_b32 v156, 1, v135
    v_xor_b32 v156, v156, v137
    s_lshl_b32 s35, s28, 12
    s_add_u32 s35, s35, 32768
    v_lshlrev_b32 v157, 7, v135
    v_add_u32 v157, s35, v157
    v_xor_b32 v158, 0, v156
    v_lshl_add_u32 v160, v158, 4, v157
    v_xor_b32 v158, 4, v156
    v_lshl_add_u32 v161, v158, 4, v157
    v_xor_b32 v158, 7, v156
    v_lshl_add_u32 v162, v158, 4, v157
    v_xor_b32 v158, 3, v156
    v_lshl_add_u32 v163, v158, 4, v157
    v_bfe_u32 v156, v138, 1, 3
    v_lshlrev_b32 v144, 19, v156
    v_and_b32 v156, 1, v138
    v_lshl_add_u32 v144, v156, 13, v144
    v_lshrrev_b32 v156, 8, v138
    v_lshl_add_u32 v144, v156, 10, v144
    v_bfe_u32 v156, v138, 4, 4
    v_lshl_add_u32 v144, v156, 4, v144
    v_lshl_add_u32 v144, v137, 8, v144
    v_sub_u32 v157, 3, v137
    v_bfe_u32 v156, v139, 1, 3
    v_lshlrev_b32 v145, 19, v156
    v_and_b32 v156, 1, v139
    v_lshl_add_u32 v145, v156, 13, v145
    v_lshrrev_b32 v156, 8, v139
    v_lshl_add_u32 v145, v156, 10, v145
    v_bfe_u32 v156, v139, 4, 4
    v_lshl_add_u32 v145, v156, 4, v145
    v_lshl_add_u32 v145, v157, 8, v145
    s_lshl_b32 s40, s31, 15
    s_add_u32 s41, s40, 0x4000
    s_sub_u32 s42, 0x7c000, s40
    s_sub_u32 s43, s42, 0x4000
    v_cmp_gt_u32 vcc, 32, v134
    v_lshrrev_b32 v157, 5, v134
    s_nop 0
    v_cndmask_b32 v156, v139, v138, vcc
    v_and_b32 v146, 15, v156
    v_lshlrev_b32 v146, 13, v146
    v_lshrrev_b32 v156, 4, v156
    v_lshl_add_u32 v146, v156, 6, v146
    v_lshl_add_u32 v146, v157, 5, v146
    s_lshl_b32 s44, s31, 2
    v_lshlrev_b32 v148, 2, v135
    v_lshlrev_b32 v156, 1, v136
    v_mov_b32 v157, 0x1e
    v_lshrrev_b32 v156, v156, v157
    v_and_b32 v156, 3, v156
    v_lshl_add_u32 v147, v156, 6, v148
    v_cmp_gt_u32 vcc, 16, v134
    s_add_u32 s48, s4, 0x1000000
    s_addc_u32 s49, s5, 0
    s_mov_b32 s50, 0x400000
    s_mov_b32 s51, 0x20000
    s_add_u32 s52, s4, 0x1850000
    s_addc_u32 s53, s5, 0
    s_mov_b32 s54, 0x4000
    s_mov_b32 s55, 0x20000
    s_add_u32 s56, s4, 0x1800000
    s_addc_u32 s57, s5, 0
    s_mov_b32 s58, 0x20000
    s_mov_b32 s59, 0x20000
    s_waitcnt vmcnt(7)
    s_barrier
    ds_read_b128 v[32:35], v151 offset:0
    ds_read_b64_tr_b16 v[184:185], v140 offset:0
    ds_read_b64_tr_b16 v[186:187], v140 offset:1024
    ds_read_b64_tr_b16 v[188:189], v141 offset:0
    ds_read_b64_tr_b16 v[190:191], v141 offset:1024
    ds_read_b64_tr_b16 v[192:193], v140 offset:16384
    ds_read_b64_tr_b16 v[194:195], v140 offset:17408
    ds_read_b64_tr_b16 v[196:197], v141 offset:16384
    ds_read_b64_tr_b16 v[198:199], v141 offset:17408
    ds_read_b128 v[36:39], v151 offset:64
    ds_read_b64_tr_b16 v[200:201], v140 offset:2048
    ds_read_b64_tr_b16 v[202:203], v140 offset:3072
    s_waitcnt lgkmcnt(11)
    v_mfma_f32_16x16x32_f16 v[112:115], v[32:35], v[0:3], 0
    ds_read_b64_tr_b16 v[204:205], v141 offset:2048
    ds_read_b64_tr_b16 v[206:207], v141 offset:3072
    s_waitcnt lgkmcnt(11)
    v_mfma_f32_16x16x32_f16 v[96:99], v[184:187], v[0:3], 0
    ds_read_b64_tr_b16 v[208:209], v140 offset:18432
    ds_read_b64_tr_b16 v[210:211], v140 offset:19456
    s_waitcnt lgkmcnt(11)
    v_mfma_f32_16x16x32_f16 v[100:103], v[188:191], v[0:3], 0
    ds_read_b64_tr_b16 v[212:213], v141 offset:18432
    ds_read_b64_tr_b16 v[214:215], v141 offset:19456
    s_waitcnt lgkmcnt(11)
    v_mfma_f32_16x16x32_f16 v[104:107], v[192:195], v[0:3], 0
    ds_read_b128 v[40:43], v151 offset:128
    s_waitcnt lgkmcnt(10)
    v_mfma_f32_16x16x32_f16 v[108:111], v[196:199], v[0:3], 0
    ds_read_b64_tr_b16 v[216:217], v140 offset:4096
    ds_read_b64_tr_b16 v[218:219], v140 offset:5120
    s_waitcnt lgkmcnt(11)
    v_mfma_f32_16x16x32_f16 v[112:115], v[36:39], v[4:7], v[112:115]
    ds_read_b64_tr_b16 v[220:221], v141 offset:4096
    ds_read_b64_tr_b16 v[222:223], v141 offset:5120
    s_waitcnt lgkmcnt(11)
    v_mfma_f32_16x16x32_f16 v[96:99], v[200:203], v[4:7], v[96:99]
    ds_read_b64_tr_b16 v[224:225], v140 offset:20480
    ds_read_b64_tr_b16 v[226:227], v140 offset:21504
    s_waitcnt lgkmcnt(11)
    v_mfma_f32_16x16x32_f16 v[100:103], v[204:207], v[4:7], v[100:103]
    ds_read_b64_tr_b16 v[228:229], v141 offset:20480
    ds_read_b64_tr_b16 v[230:231], v141 offset:21504
    s_waitcnt lgkmcnt(11)
    v_mfma_f32_16x16x32_f16 v[104:107], v[208:211], v[4:7], v[104:107]
    ds_read_b128 v[44:47], v151 offset:192
    s_waitcnt lgkmcnt(10)
    v_mfma_f32_16x16x32_f16 v[108:111], v[212:215], v[4:7], v[108:111]
    ds_read_b64_tr_b16 v[184:185], v140 offset:6144
    ds_read_b64_tr_b16 v[186:187], v140 offset:7168
    s_waitcnt lgkmcnt(11)
    v_mfma_f32_16x16x32_f16 v[112:115], v[40:43], v[8:11], v[112:115]
    ds_read_b64_tr_b16 v[188:189], v141 offset:6144
    ds_read_b64_tr_b16 v[190:191], v141 offset:7168
    s_waitcnt lgkmcnt(11)
    v_mfma_f32_16x16x32_f16 v[96:99], v[216:219], v[8:11], v[96:99]
    ds_read_b64_tr_b16 v[192:193], v140 offset:22528
    ds_read_b64_tr_b16 v[194:195], v140 offset:23552
    s_waitcnt lgkmcnt(11)
    v_mfma_f32_16x16x32_f16 v[100:103], v[220:223], v[8:11], v[100:103]
    ds_read_b64_tr_b16 v[196:197], v141 offset:22528
    ds_read_b64_tr_b16 v[198:199], v141 offset:23552
    s_waitcnt lgkmcnt(11)
    v_mfma_f32_16x16x32_f16 v[104:107], v[224:227], v[8:11], v[104:107]
    ds_read_b128 v[48:51], v151 offset:256
    s_waitcnt lgkmcnt(10)
    v_mfma_f32_16x16x32_f16 v[108:111], v[228:231], v[8:11], v[108:111]
    ds_read_b64_tr_b16 v[200:201], v140 offset:8192
    ds_read_b64_tr_b16 v[202:203], v140 offset:9216
    s_waitcnt lgkmcnt(11)
    v_mfma_f32_16x16x32_f16 v[112:115], v[44:47], v[12:15], v[112:115]
    ds_read_b64_tr_b16 v[204:205], v141 offset:8192
    ds_read_b64_tr_b16 v[206:207], v141 offset:9216
    s_waitcnt lgkmcnt(11)
    v_mfma_f32_16x16x32_f16 v[96:99], v[184:187], v[12:15], v[96:99]
    ds_read_b64_tr_b16 v[208:209], v140 offset:24576
    ds_read_b64_tr_b16 v[210:211], v140 offset:25600
    s_waitcnt lgkmcnt(11)
    v_mfma_f32_16x16x32_f16 v[100:103], v[188:191], v[12:15], v[100:103]
    ds_read_b64_tr_b16 v[212:213], v141 offset:24576
    ds_read_b64_tr_b16 v[214:215], v141 offset:25600
    s_waitcnt lgkmcnt(11)
    v_mfma_f32_16x16x32_f16 v[104:107], v[192:195], v[12:15], v[104:107]
    ds_read_b128 v[52:55], v151 offset:320
    s_waitcnt lgkmcnt(10)
    v_mfma_f32_16x16x32_f16 v[108:111], v[196:199], v[12:15], v[108:111]
    ds_read_b64_tr_b16 v[216:217], v140 offset:10240
    ds_read_b64_tr_b16 v[218:219], v140 offset:11264
    s_waitcnt lgkmcnt(11)
    v_mfma_f32_16x16x32_f16 v[112:115], v[48:51], v[16:19], v[112:115]
    ds_read_b64_tr_b16 v[220:221], v141 offset:10240
    ds_read_b64_tr_b16 v[222:223], v141 offset:11264
    s_waitcnt lgkmcnt(11)
    v_mfma_f32_16x16x32_f16 v[96:99], v[200:203], v[16:19], v[96:99]
    ds_read_b64_tr_b16 v[224:225], v140 offset:26624
    ds_read_b64_tr_b16 v[226:227], v140 offset:27648
    s_waitcnt lgkmcnt(11)
    v_mfma_f32_16x16x32_f16 v[100:103], v[204:207], v[16:19], v[100:103]
    ds_read_b64_tr_b16 v[228:229], v141 offset:26624
    ds_read_b64_tr_b16 v[230:231], v141 offset:27648
    s_waitcnt lgkmcnt(11)
    v_mfma_f32_16x16x32_f16 v[104:107], v[208:211], v[16:19], v[104:107]
    ds_read_b128 v[56:59], v151 offset:384
    s_waitcnt lgkmcnt(10)
    v_mfma_f32_16x16x32_f16 v[108:111], v[212:215], v[16:19], v[108:111]
    ds_read_b64_tr_b16 v[184:185], v140 offset:12288
    ds_read_b64_tr_b16 v[186:187], v140 offset:13312
    s_waitcnt lgkmcnt(11)
    v_mfma_f32_16x16x32_f16 v[112:115], v[52:55], v[20:23], v[112:115]
    ds_read_b64_tr_b16 v[188:189], v141 offset:12288
    ds_read_b64_tr_b16 v[190:191], v141 offset:13312
    s_waitcnt lgkmcnt(11)
    v_mfma_f32_16x16x32_f16 v[96:99], v[216:219], v[20:23], v[96:99]
    ds_read_b64_tr_b16 v[192:193], v140 offset:28672
    ds_read_b64_tr_b16 v[194:195], v140 offset:29696
    s_waitcnt lgkmcnt(11)
    v_mfma_f32_16x16x32_f16 v[100:103], v[220:223], v[20:23], v[100:103]
    ds_read_b64_tr_b16 v[196:197], v141 offset:28672
    ds_read_b64_tr_b16 v[198:199], v141 offset:29696
    s_waitcnt lgkmcnt(11)
    v_mfma_f32_16x16x32_f16 v[104:107], v[224:227], v[20:23], v[104:107]
    ds_read_b128 v[60:63], v151 offset:448
    s_waitcnt lgkmcnt(10)
    v_mfma_f32_16x16x32_f16 v[108:111], v[228:231], v[20:23], v[108:111]
    ds_read_b64_tr_b16 v[200:201], v140 offset:14336
    ds_read_b64_tr_b16 v[202:203], v140 offset:15360
    s_waitcnt lgkmcnt(11)
    v_mfma_f32_16x16x32_f16 v[112:115], v[56:59], v[24:27], v[112:115]
    ds_read_b64_tr_b16 v[204:205], v141 offset:14336
    ds_read_b64_tr_b16 v[206:207], v141 offset:15360
    s_waitcnt lgkmcnt(11)
    v_mfma_f32_16x16x32_f16 v[96:99], v[184:187], v[24:27], v[96:99]
    ds_read_b64_tr_b16 v[208:209], v140 offset:30720
    ds_read_b64_tr_b16 v[210:211], v140 offset:31744
    s_waitcnt lgkmcnt(11)
    v_mfma_f32_16x16x32_f16 v[100:103], v[188:191], v[24:27], v[100:103]
    ds_read_b64_tr_b16 v[212:213], v141 offset:30720
    ds_read_b64_tr_b16 v[214:215], v141 offset:31744
    s_waitcnt lgkmcnt(11)
    v_mfma_f32_16x16x32_f16 v[104:107], v[192:195], v[24:27], v[104:107]
    s_waitcnt vmcnt(3)
    ds_read_b128 v[116:119], v160 offset:0
    ds_read_b128 v[120:123], v161 offset:0
    ds_read_b128 v[124:127], v162 offset:2048
    ds_read_b128 v[128:131], v163 offset:2048
    s_waitcnt lgkmcnt(13)
    v_mfma_f32_16x16x32_f16 v[108:111], v[196:199], v[24:27], v[108:111]
    s_waitcnt lgkmcnt(12)
    v_mfma_f32_16x16x32_f16 v[112:115], v[60:63], v[28:31], v[112:115]
    s_waitcnt lgkmcnt(10)
    v_mfma_f32_16x16x32_f16 v[96:99], v[200:203], v[28:31], v[96:99]
    s_waitcnt lgkmcnt(8)
    v_mfma_f32_16x16x32_f16 v[100:103], v[204:207], v[28:31], v[100:103]
    s_waitcnt lgkmcnt(6)
    v_mfma_f32_16x16x32_f16 v[104:107], v[208:211], v[28:31], v[104:107]
    s_waitcnt lgkmcnt(4)
    v_mfma_f32_16x16x32_f16 v[108:111], v[212:215], v[28:31], v[108:111]
    s_waitcnt lgkmcnt(0)
    v_lshlrev_b32 v32, 16, v116
    v_and_b32 v33, 0xffff0000, v116
    v_lshlrev_b32 v34, 16, v117
    v_and_b32 v35, 0xffff0000, v117
    v_lshlrev_b32 v36, 16, v118
    v_and_b32 v37, 0xffff0000, v118
    v_lshlrev_b32 v38, 16, v119
    v_and_b32 v39, 0xffff0000, v119
    v_lshlrev_b32 v40, 16, v120
    v_and_b32 v41, 0xffff0000, v120
    v_lshlrev_b32 v42, 16, v121
    v_and_b32 v43, 0xffff0000, v121
    v_lshlrev_b32 v44, 16, v122
    v_and_b32 v45, 0xffff0000, v122
    v_lshlrev_b32 v46, 16, v123
    v_and_b32 v47, 0xffff0000, v123
    v_lshlrev_b32 v48, 16, v124
    v_and_b32 v49, 0xffff0000, v124
    v_lshlrev_b32 v50, 16, v125
    v_and_b32 v51, 0xffff0000, v125
    v_lshlrev_b32 v52, 16, v126
    v_and_b32 v53, 0xffff0000, v126
    v_lshlrev_b32 v54, 16, v127
    v_and_b32 v55, 0xffff0000, v127
    v_lshlrev_b32 v56, 16, v128
    v_and_b32 v57, 0xffff0000, v128
    v_lshlrev_b32 v58, 16, v129
    v_and_b32 v59, 0xffff0000, v129
    v_lshlrev_b32 v60, 16, v130
    v_and_b32 v61, 0xffff0000, v130
    v_lshlrev_b32 v62, 16, v131
    v_and_b32 v63, 0xffff0000, v131
    v_permlane16_swap_b32 v96, v104
    v_permlane16_swap_b32 v97, v105
    v_permlane16_swap_b32 v98, v106
    v_permlane16_swap_b32 v99, v107
    v_permlane16_swap_b32 v100, v108
    v_permlane16_swap_b32 v101, v109
    v_permlane16_swap_b32 v102, v110
    v_permlane16_swap_b32 v103, v111
    v_cndmask_b32 v152, v96, v100, vcc
    v_cndmask_b32 v153, v100, v112, vcc
    ds_bpermute_b32 v154, v148, v113
    ds_bpermute_b32 v152, v147, v152
    ds_bpermute_b32 v153, v147, v153
    v_add_f32 v32, v32, v96
    v_add_f32 v33, v33, v97
    v_add_f32 v34, v34, v98
    v_add_f32 v35, v35, v99
    v_add_f32 v36, v36, v104
    v_add_f32 v37, v37, v105
    v_add_f32 v38, v38, v106
    v_add_f32 v39, v39, v107
    v_add_f32 v40, v40, v100
    v_add_f32 v41, v41, v101
    v_add_f32 v42, v42, v102
    v_add_f32 v43, v43, v103
    v_add_f32 v44, v44, v108
    v_add_f32 v45, v45, v109
    v_add_f32 v46, v46, v110
    v_add_f32 v47, v47, v111
    s_waitcnt vmcnt(1) lgkmcnt(0)
    v_add_f32 v156, v132, v154
    v_add_f32 v158, v133, v154
    v_add_f32 v48, v48, v152
    v_add_f32 v49, v49, v107
    v_add_f32 v50, v50, v106
    v_add_f32 v51, v51, v105
    v_add_f32 v52, v52, v104
    v_add_f32 v53, v53, v99
    v_add_f32 v54, v54, v98
    v_add_f32 v55, v55, v97
    v_add_f32 v56, v56, v153
    v_add_f32 v57, v57, v111
    v_add_f32 v58, v58, v110
    v_add_f32 v59, v59, v109
    v_add_f32 v60, v60, v108
    v_add_f32 v61, v61, v103
    v_add_f32 v62, v62, v102
    v_add_f32 v63, v63, v101
    v_cvt_pk_bf16_f32 v152, v156, v158
    v_lshlrev_b32 v153, 16, v152
    v_and_b32 v152, 0xffff0000, v152
    v_sub_f32 v157, v156, v153
    v_sub_f32 v159, v158, v152
    v_mov_b32 v156, v153
    v_mov_b32 v158, v152
    v_mul_f32 v157, 4.0, v157
    v_mul_f32 v159, 4.0, v159
    v_sub_f32 v32, v32, v156
    v_sub_f32 v33, v33, v156
    v_sub_f32 v34, v34, v156
    v_sub_f32 v35, v35, v156
    v_sub_f32 v36, v36, v156
    v_sub_f32 v37, v37, v156
    v_sub_f32 v38, v38, v156
    v_sub_f32 v39, v39, v156
    v_cvt_pk_bf16_f32 v0, v32, v33
    v_cvt_pk_bf16_f32 v1, v34, v35
    v_cvt_pk_bf16_f32 v2, v36, v37
    v_cvt_pk_bf16_f32 v3, v38, v39
    buffer_store_dwordx4 v[0:3], v144, s[48:51], s40 offen sc1
    v_sub_f32 v40, v40, v156
    v_sub_f32 v41, v41, v156
    v_sub_f32 v42, v42, v156
    v_sub_f32 v43, v43, v156
    v_sub_f32 v44, v44, v156
    v_sub_f32 v45, v45, v156
    v_sub_f32 v46, v46, v156
    v_sub_f32 v47, v47, v156
    v_cvt_pk_bf16_f32 v4, v40, v41
    v_cvt_pk_bf16_f32 v5, v42, v43
    v_cvt_pk_bf16_f32 v6, v44, v45
    v_cvt_pk_bf16_f32 v7, v46, v47
    buffer_store_dwordx4 v[4:7], v144, s[48:51], s41 offen sc1
    v_sub_f32 v48, v48, v158
    v_sub_f32 v49, v49, v158
    v_sub_f32 v50, v50, v158
    v_sub_f32 v51, v51, v158
    v_sub_f32 v52, v52, v158
    v_sub_f32 v53, v53, v158
    v_sub_f32 v54, v54, v158
    v_sub_f32 v55, v55, v158
    v_cvt_pk_bf16_f32 v8, v48, v49
    v_cvt_pk_bf16_f32 v9, v50, v51
    v_cvt_pk_bf16_f32 v10, v52, v53
    v_cvt_pk_bf16_f32 v11, v54, v55
    buffer_store_dwordx4 v[8:11], v145, s[48:51], s42 offen sc1
    v_sub_f32 v56, v56, v158
    v_sub_f32 v57, v57, v158
    v_sub_f32 v58, v58, v158
    v_sub_f32 v59, v59, v158
    v_sub_f32 v60, v60, v158
    v_sub_f32 v61, v61, v158
    v_sub_f32 v62, v62, v158
    v_sub_f32 v63, v63, v158
    v_cvt_pk_bf16_f32 v12, v56, v57
    v_cvt_pk_bf16_f32 v13, v58, v59
    v_cvt_pk_bf16_f32 v14, v60, v61
    v_cvt_pk_bf16_f32 v15, v62, v63
    buffer_store_dwordx4 v[12:15], v145, s[48:51], s43 offen sc1
    v_mul_f32 v160, v32, v32
    v_mul_f32 v161, v33, v33
    v_fmac_f32 v160, v34, v34
    v_fmac_f32 v161, v35, v35
    v_fmac_f32 v160, v36, v36
    v_fmac_f32 v161, v37, v37
    v_fmac_f32 v160, v38, v38
    v_fmac_f32 v161, v39, v39
    v_fmac_f32 v160, v40, v40
    v_fmac_f32 v161, v41, v41
    v_fmac_f32 v160, v42, v42
    v_fmac_f32 v161, v43, v43
    v_fmac_f32 v160, v44, v44
    v_fmac_f32 v161, v45, v45
    v_fmac_f32 v160, v46, v46
    v_fmac_f32 v161, v47, v47
    v_mul_f32 v162, v48, v48
    v_mul_f32 v163, v49, v49
    v_fmac_f32 v162, v50, v50
    v_fmac_f32 v163, v51, v51
    v_fmac_f32 v162, v52, v52
    v_fmac_f32 v163, v53, v53
    v_fmac_f32 v162, v54, v54
    v_fmac_f32 v163, v55, v55
    v_fmac_f32 v162, v56, v56
    v_fmac_f32 v163, v57, v57
    v_fmac_f32 v162, v58, v58
    v_fmac_f32 v163, v59, v59
    v_fmac_f32 v162, v60, v60
    v_fmac_f32 v163, v61, v61
    v_fmac_f32 v162, v62, v62
    v_fmac_f32 v163, v63, v63
    v_add_f32 v160, v160, v161
    v_add_f32 v162, v162, v163
    v_fma_f32 v160, -v157, v157, v160
    v_fma_f32 v162, -v159, v159, v162
    s_nop 1
    v_permlane32_swap_b32 v160, v162
    v_add_f32 v160, v160, v162
    v_mov_b32 v161, v160
    s_nop 1
    v_permlane16_swap_b32 v160, v161
    v_add_f32 v160, v160, v161
    s_mov_b32 s36, 0xffff
    s_mov_b32 s37, 0xffff
    s_mov_b64 exec, s[36:37]
    buffer_store_dword v160, v146, s[56:59], s44 offen
    s_cmp_lg_u32 s31, 0
    s_cbranch_scc1 L_kb_kernel_nomu_2
    v_lshrrev_b32 v161, 6, v146
    v_lshrrev_b32 v162, 5, v134
    v_lshlrev_b32 v162, 13, v162
    v_lshl_add_u32 v161, v161, 2, v162
    v_cndmask_b32 v162, v158, v156, vcc
    buffer_store_dword v162, v161, s[52:55], 0 offen
L_kb_kernel_nomu_2:
L_kb_kernel_done_1:
    s_endpgm
.section .rodata,"a"
.p2align 6
.amdhsa_kernel kb_kernel
  .amdhsa_next_free_vgpr 232
  .amdhsa_next_free_sgpr 102
  .amdhsa_accum_offset 232
  .amdhsa_group_segment_fixed_size 0
  .amdhsa_kernarg_size 96
  .amdhsa_user_sgpr_count 2
  .amdhsa_user_sgpr_kernarg_segment_ptr 1
  .amdhsa_system_sgpr_workgroup_id_x 1
  .amdhsa_float_denorm_mode_32 3
  .amdhsa_float_denorm_mode_16_64 3
.end_amdhsa_kernel
.text
.globl kc_kernel
.p2align 8
.type kc_kernel,@function
kc_kernel:
    s_cmp_ge_u32 s2, 256
    s_cbranch_scc1 L_kc_kernel_done_1
    s_load_dwordx4 s[8:11], s[0:1], 48
    s_load_dwordx2 s[4:5], s[0:1], 88
    s_load_dwordx2 s[6:7], s[0:1], 64
    v_and_b32 v238, 63, v0
    v_lshrrev_b32 v240, 6, v0
    v_mov_b32 v248, v0
    v_readfirstlane_b32 s28, v240
    s_and_b32 s41, s2, 7
    s_lshr_b32 s42, s2, 3
    s_lshr_b32 s29, s42, 2
    s_and_b32 s42, s42, 3
    s_lshl_b32 s41, s41, 2
    s_add_u32 s30, s41, s42
    s_lshl_b32 s33, s42, 1
    s_add_u32 s33, s33, s29
    s_and_b32 s43, s28, 1
    s_lshr_b32 s44, s28, 1
    v_lshlrev_b32 v240, 4, v238
    s_mul_i32 s36, s28, 4096
    v_add_u32 v233, s36, v240
    s_mul_i32 s46, s30, 224
    s_mul_i32 s45, s44, 28672
    s_add_u32 s46, s46, s45
    v_add_u32 v241, 0, v238
    v_mul_u32_u24 v242, 4682, v241
    v_lshrrev_b32 v242, 16, v242
    v_and_b32 v243, 12, v242
    v_add_u32 v243, v243, v242
    v_mul_u32_u24 v243, 7168, v243
    v_mul_u32_u24 v242, 224, v242
    v_lshl_add_u32 v243, v241, 4, v243
    v_sub_u32 v243, v243, v242
    s_add_u32 s45, s46, 4096
    v_add_u32 v234, s45, v243
    v_add_u32 v241, 64, v238
    v_mul_u32_u24 v242, 4682, v241
    v_lshrrev_b32 v242, 16, v242
    v_and_b32 v243, 12, v242
    v_add_u32 v243, v243, v242
    v_mul_u32_u24 v243, 7168, v243
    v_mul_u32_u24 v242, 224, v242
    v_lshl_add_u32 v243, v241, 4, v243
    v_sub_u32 v243, v243, v242
    s_add_u32 s45, s46, 3072
    v_add_u32 v235, s45, v243
    v_add_u32 v241, 128, v238
    v_mul_u32_u24 v242, 4682, v241
    v_lshrrev_b32 v242, 16, v242
    v_and_b32 v243, 12, v242
    v_add_u32 v243, v243, v242
    v_mul_u32_u24 v243, 7168, v243
    v_mul_u32_u24 v242, 224, v242
    v_lshl_add_u32 v243, v241, 4, v243
    v_sub_u32 v243, v243, v242
    s_add_u32 s45, s46, 2048
    v_add_u32 v236, s45, v243
    v_add_u32 v241, 192, v238
    v_mul_u32_u24 v242, 4682, v241
    v_lshrrev_b32 v242, 16, v242
    v_and_b32 v243, 12, v242
    v_add_u32 v243, v243, v242
    v_mul_u32_u24 v243, 7168, v243
    v_mul_u32_u24 v242, 224, v242
    v_lshl_add_u32 v243, v241, 4, v243
    v_sub_u32 v243, v243, v242
    s_add_u32 s45, s46, 1024
    v_add_u32 v237, s45, v243
    s_mul_i32 s37, s43, 7184
    s_mul_i32 s45, s44, 3584
    s_add_u32 s37, s37, s45
    s_add_u32 s37, s37, 16384
    s_mov_b32 s38, -1
    s_mov_b32 s39, 0
    s_movk_i32 s40, 0x1000
    s_lshl_b32 s41, s29, 19
    s_add_u32 s41, s41, 0x1000000
    s_waitcnt lgkmcnt(0)
    s_add_u32 s12, s4, s41
    s_addc_u32 s13, s5, 0
    s_mov_b32 s14, 0x80000
    s_mov_b32 s15, 0x20000
    s_cmp_eq_u32 s43, 0
    s_cselect_b32 s16, s8, s10
    s_cselect_b32 s17, s9, s11
    s_sub_u32 s16, s16, 0x1000
    s_subb_u32 s17, s17, 0
    s_mov_b32 s18, 0x701000
    s_mov_b32 s19, 0x20000
    s_add_u32 m0, s37, 0
    s_mov_b32 s31, 0x0
    s_mov_b32 s32, 0x0
    buffer_load_dwordx4 v234, s[16:19], s32 offen offset:0 lds
    buffer_load_dwordx4 v235, s[16:19], s32 offen offset:1024 lds
    buffer_load_dwordx4 v236, s[16:19], s32 offen offset:2048 lds
    s_mov_b64 exec, s[38:39]
    buffer_load_dwordx4 v237, s[16:19], s32 offen offset:3072 lds
    s_mov_b64 exec, -1
    s_add_u32 m0, s36, 0
    s_nop 0
    buffer_load_dwordx4 v233, s[12:15], s31 offen offset:0  lds
    buffer_load_dwordx4 v233, s[12:15], s31 offen offset:1024  lds
    buffer_load_dwordx4 v233, s[12:15], s31 offen offset:2048  lds
    buffer_load_dwordx4 v233, s[12:15], s31 offen offset:3072  lds
    s_add_u32 m0, s37, 30736
    s_mov_b32 s31, 0x4000
    s_mov_b32 s32, 0x38000
    buffer_load_dwordx4 v234, s[16:19], s32 offen offset:0 lds
    buffer_load_dwordx4 v235, s[16:19], s32 offen offset:1024 lds
    buffer_load_dwordx4 v236, s[16:19], s32 offen offset:2048 lds
    s_mov_b64 exec, s[38:39]
    buffer_load_dwordx4 v237, s[16:19], s32 offen offset:3072 lds
    s_mov_b64 exec, -1
    s_add_u32 m0, s36, 30736
    s_nop 0
    buffer_load_dwordx4 v233, s[12:15], s31 offen offset:0  lds
    buffer_load_dwordx4 v233, s[12:15], s31 offen offset:1024  lds
    buffer_load_dwordx4 v233, s[12:15], s31 offen offset:2048  lds
    buffer_load_dwordx4 v233, s[12:15], s31 offen offset:3072  lds
    s_and_b32 s33, s33, 7
    s_mov_b32 s60, 0x1010101
    s_mov_b32 s61, 0x1010101
    s_lshl_b64 s[60:61], s[60:61], s33
    s_and_b32 s61, s61, 0xffffff00
    v_mov_b32 v242, s61
    v_lshrrev_b32 v241, v238, v242
    v_and_b32 v241, 1, v241
    v_cmp_eq_u32 vcc, 1, v241
    v_subrev_u32 v243, 6, v238
    v_max_i32 v243, 0, v243
    v_add_u32 v244, 7, v238
    v_min_u32 v244, 32, v244
    v_cndmask_b32 v243, v238, v243, vcc
    v_cndmask_b32 v244, v244, v238, vcc
    v_bfm_b32 v245, v243, 0
    v_and_b32 v245, v245, v242
    v_bcnt_u32_b32 v245, v245, 0
    v_sub_u32 v243, v243, v245
    v_bcnt_u32_b32 v243, v242, v243
    v_lshrrev_b32 v245, 1, v244
    v_sub_u32 v244, v244, v245
    v_lshrrev_b32 v245, v245, v242
    v_lshrrev_b32 v245, v244, v245
    v_bcnt_u32_b32 v245, v245, 0
    v_cmp_gt_u32 vcc, 32, v238
    v_sub_u32 v243, v243, v245
    s_nop 0
    v_cndmask_b32 v243, v238, v243, vcc
    v_lshlrev_b32 v243, 2, v243
    ds_permute_b32 v255, v243, v238
    s_add_u32 s20, s4, 0x2000000
    s_addc_u32 s21, s5, 0
    s_mov_b32 s22, 0xe00000
    s_mov_b32 s23, 0x20000
    s_mov_b32 s52, s6
    s_mov_b32 s53, s7
    s_mov_b32 s54, 0x700000
    s_mov_b32 s55, 0x20000
    s_mul_i32 s45, s44, 8192
    v_add_u32 v224, s45, v240
    v_lshrrev_b32 v241, 2, v238
    v_mul_u32_u24 v241, 224, v241
    s_mul_i32 s45, s43, 112
    s_add_u32 s45, s45, 16384
    v_add_u32 v241, s45, v241
    v_and_b32 v242, 3, v238
    v_lshl_add_u32 v227, v242, 3, v241
    v_lshrrev_b32 v243, 1, v242
    v_lshl_add_u32 v230, v243, 3, v241
    v_and_b32 v243, 1, v242
    v_mul_u32_u24 v243, 7184, v243
    v_add3_u32 v230, v230, v243, 48
    v_add_u32 v230, 48, v230
    v_add_u32 v225, 61472, v224
    v_add_u32 v228, 61472, v227
    v_add_u32 v231, 61472, v230
    v_add_u32 v226, 122944, v224
    v_add_u32 v229, 122944, v227
    v_add_u32 v232, 122944, v230
    s_lshr_b32 s45, s2, 3
    s_lshl_b32 s45, s45, 2
    s_add_u32 s45, s45, s28
    s_lshl_b32 s45, s45, 14
    s_and_b32 s46, s2, 1
    s_mul_i32 s46, s46, 1024
    s_add_u32 s45, s45, s46
    v_lshrrev_b32 v241, 3, v238
    v_lshlrev_b32 v241, 11, v241
    v_and_b32 v242, 7, v238
    v_lshl_add_u32 v241, v242, 7, v241
    v_add_u32 v239, s45, v241
    s_getpc_b64 s[56:57]
L_kc_kernel_pc_2:
    s_sub_u32 s56, s56, L_kc_kernel_pc_2-ka_kernel
    s_subb_u32 s57, s57, 0
    s_mov_b32 s58, L_code_end-ka_kernel
    s_mov_b32 s59, 0x20000
    s_lshr_b32 s45, s2, 3
    s_lshl_b32 s45, s45, 2
    s_add_u32 s45, s45, s28
    s_lshl_b32 s45, s45, 9
    v_lshrrev_b32 v249, 2, v238
    v_lshlrev_b32 v249, 13, v249
    v_add_u32 v249, v249, v238
    v_lshlrev_b32 v249, 7, v249
    v_add_u32 v249, s45, v249
    s_waitcnt vmcnt(8)
    s_barrier
    ds_read_b128 a[0:3], v224 offset:0
    ds_read_b64_tr_b16 a[32:33], v227 offset:0
    ds_read_b64_tr_b16 a[34:35], v227 offset:3584
    ds_read_b64_tr_b16 a[36:37], v227 offset:32
    ds_read_b64_tr_b16 a[38:39], v227 offset:3616
    ds_read_b64_tr_b16 a[40:41], v227 offset:64
    ds_read_b64_tr_b16 a[42:43], v227 offset:3648
    ds_read_b64_tr_b16 a[44:45], v227 offset:7184
    ds_read_b64_tr_b16 a[46:47], v227 offset:10768
    ds_read_b64_tr_b16 a[48:49], v227 offset:7216
    ds_read_b64_tr_b16 a[50:51], v227 offset:10800
    ds_read_b64_tr_b16 a[52:53], v227 offset:7248
    ds_read_b64_tr_b16 a[54:55], v227 offset:10832
    ds_read_b64_tr_b16 a[56:57], v230 offset:0
    ds_read_b64_tr_b16 a[58:59], v230 offset:3584
    ds_read_b128 a[4:7], v224 offset:1024
    ds_read_b128 a[8:11], v224 offset:2048
    ds_read_b128 a[12:15], v224 offset:3072
    ds_read_b128 a[16:19], v224 offset:4096
    ds_read_b128 a[20:23], v224 offset:5120
    ds_read_b128 a[24:27], v224 offset:6144
    ds_read_b128 a[28:31], v224 offset:7168
    s_add_u32 s24, s4, 0x1800000
    s_addc_u32 s25, s5, 0
    s_mov_b32 s26, 0x20000
    s_mov_b32 s27, 0x20000
    s_lshl_b32 s35, s29, 14
    s_lshl_b32 s45, s28, 12
    s_add_u32 s35, s35, s45
    s_waitcnt lgkmcnt(0)
    v_mfma_f32_16x16x32_bf16 v[0:3], a[32:35], a[0:3], 0
    v_mfma_f32_16x16x32_bf16 v[4:7], a[36:39], a[0:3], 0
    v_mfma_f32_16x16x32_bf16 v[8:11], a[40:43], a[0:3], 0
    v_mfma_f32_16x16x32_bf16 v[12:15], a[44:47], a[0:3], 0
    v_mfma_f32_16x16x32_bf16 v[16:19], a[48:51], a[0:3], 0
    v_mfma_f32_16x16x32_bf16 v[20:23], a[52:55], a[0:3], 0
    v_mfma_f32_16x16x32_bf16 v[24:27], a[56:59], a[0:3], 0
    v_mfma_f32_16x16x32_bf16 v[28:31], a[32:35], a[4:7], 0
    v_mfma_f32_16x16x32_bf16 v[32:35], a[36:39], a[4:7], 0
    v_mfma_f32_16x16x32_bf16 v[36:39], a[40:43], a[4:7], 0
    v_mfma_f32_16x16x32_bf16 v[40:43], a[44:47], a[4:7], 0
    v_mfma_f32_16x16x32_bf16 v[44:47], a[48:51], a[4:7], 0
    v_mfma_f32_16x16x32_bf16 v[48:51], a[52:55], a[4:7], 0
    v_mfma_f32_16x16x32_bf16 v[52:55], a[56:59], a[4:7], 0
    v_mfma_f32_16x16x32_bf16 v[56:59], a[32:35], a[8:11], 0
    v_mfma_f32_16x16x32_bf16 v[60:63], a[36:39], a[8:11], 0
    v_mfma_f32_16x16x32_bf16 v[64:67], a[40:43], a[8:11], 0
    v_mfma_f32_16x16x32_bf16 v[68:71], a[44:47], a[8:11], 0
    v_mfma_f32_16x16x32_bf16 v[72:75], a[48:51], a[8:11], 0
    v_mfma_f32_16x16x32_bf16 v[76:79], a[52:55], a[8:11], 0
    s_waitcnt vmcnt(0)
    s_barrier
    v_mfma_f32_16x16x32_bf16 v[80:83], a[56:59], a[8:11], 0
    ds_read_b128 a[60:63], v224 offset:30736
    v_mfma_f32_16x16x32_bf16 v[84:87], a[32:35], a[12:15], 0
    ds_read_b64_tr_b16 a[92:93], v227 offset:30736
    s_add_u32 m0, s37, 61472
    v_readlane_b32 s31, v255, 2
    s_nop 1
    s_mul_i32 s32, s31, 229376
    s_lshl_b32 s31, s31, 14
    buffer_load_dwordx4 v234, s[16:19], s32 offen offset:0 lds
    v_mfma_f32_16x16x32_bf16 v[88:91], a[36:39], a[12:15], 0
    ds_read_b64_tr_b16 a[94:95], v227 offset:34320
    v_mfma_f32_16x16x32_bf16 v[92:95], a[40:43], a[12:15], 0
    buffer_load_dwordx4 v235, s[16:19], s32 offen offset:1024 lds
    v_mfma_f32_16x16x32_bf16 v[96:99], a[44:47], a[12:15], 0
    ds_read_b64_tr_b16 a[96:97], v227 offset:30768
    v_mfma_f32_16x16x32_bf16 v[100:103], a[48:51], a[12:15], 0
    ds_read_b64_tr_b16 a[98:99], v227 offset:34352
    buffer_load_dwordx4 v236, s[16:19], s32 offen offset:2048 lds
    v_mfma_f32_16x16x32_bf16 v[104:107], a[52:55], a[12:15], 0
    v_mfma_f32_16x16x32_bf16 v[108:111], a[56:59], a[12:15], 0
    ds_read_b64_tr_b16 a[100:101], v227 offset:30800
    s_mov_b64 exec, s[38:39]
    buffer_load_dwordx4 v237, s[16:19], s32 offen offset:3072 lds
    s_mov_b64 exec, -1
    v_mfma_f32_16x16x32_bf16 v[112:115], a[32:35], a[16:19], 0
    ds_read_b64_tr_b16 a[102:103], v227 offset:34384
    v_mfma_f32_16x16x32_bf16 v[116:119], a[36:39], a[16:19], 0
    v_mfma_f32_16x16x32_bf16 v[120:123], a[40:43], a[16:19], 0
    ds_read_b64_tr_b16 a[104:105], v227 offset:37920
    s_add_u32 m0, s36, 61472
    s_nop 0
    buffer_load_dwordx4 v233, s[12:15], s31 offen offset:0  lds
    v_mfma_f32_16x16x32_bf16 v[124:127], a[44:47], a[16:19], 0
    ds_read_b64_tr_b16 a[106:107], v227 offset:41504
    v_mfma_f32_16x16x32_bf16 v[128:131], a[48:51], a[16:19], 0
    buffer_load_dwordx4 v233, s[12:15], s31 offen offset:1024  lds
    v_mfma_f32_16x16x32_bf16 v[132:135], a[52:55], a[16:19], 0
    ds_read_b64_tr_b16 a[108:109], v227 offset:37952
    v_mfma_f32_16x16x32_bf16 v[136:139], a[56:59], a[16:19], 0
    ds_read_b64_tr_b16 a[110:111], v227 offset:41536
    buffer_load_dwordx4 v233, s[12:15], s31 offen offset:2048  lds
    v_mfma_f32_16x16x32_bf16 v[140:143], a[32:35], a[20:23], 0
    v_mfma_f32_16x16x32_bf16 v[144:147], a[36:39], a[20:23], 0
    ds_read_b64_tr_b16 a[112:113], v227 offset:37984
    buffer_load_dwordx4 v233, s[12:15], s31 offen offset:3072  lds
    v_mfma_f32_16x16x32_bf16 v[148:151], a[40:43], a[20:23], 0
    ds_read_b64_tr_b16 a[114:115], v227 offset:41568
    v_mfma_f32_16x16x32_bf16 v[152:155], a[44:47], a[20:23], 0
    v_mfma_f32_16x16x32_bf16 v[156:159], a[48:51], a[20:23], 0
    ds_read_b64_tr_b16 a[116:117], v230 offset:30736
    s_add_u32 m0, s37, 92208
    v_readlane_b32 s31, v255, 3
    s_nop 1
    s_mul_i32 s32, s31, 229376
    s_lshl_b32 s31, s31, 14
    buffer_load_dwordx4 v234, s[16:19], s32 offen offset:0 lds
    v_mfma_f32_16x16x32_bf16 v[160:163], a[52:55], a[20:23], 0
    ds_read_b64_tr_b16 a[118:119], v230 offset:34320
    v_mfma_f32_16x16x32_bf16 v[164:167], a[56:59], a[20:23], 0
    buffer_load_dwordx4 v235, s[16:19], s32 offen offset:1024 lds
    v_mfma_f32_16x16x32_bf16 v[168:171], a[32:35], a[24:27], 0
    ds_read_b128 a[64:67], v224 offset:31760
    v_mfma_f32_16x16x32_bf16 v[172:175], a[36:39], a[24:27], 0
    ds_read_b128 a[68:71], v224 offset:32784
    buffer_load_dwordx4 v236, s[16:19], s32 offen offset:2048 lds
    v_mfma_f32_16x16x32_bf16 v[176:179], a[40:43], a[24:27], 0
    v_mfma_f32_16x16x32_bf16 v[180:183], a[44:47], a[24:27], 0
    ds_read_b128 a[72:75], v224 offset:33808
    s_mov_b64 exec, s[38:39]
    buffer_load_dwordx4 v237, s[16:19], s32 offen offset:3072 lds
    s_mov_b64 exec, -1
    v_mfma_f32_16x16x32_bf16 v[184:187], a[48:51], a[24:27], 0
    ds_read_b128 a[76:79], v224 offset:34832
    v_mfma_f32_16x16x32_bf16 v[188:191], a[52:55], a[24:27], 0
    ds_read_b128 a[80:83], v224 offset:35856
    v_mfma_f32_16x16x32_bf16 v[192:195], a[56:59], a[24:27], 0
    s_add_u32 m0, s36, 92208
    s_nop 0
    buffer_load_dwordx4 v233, s[12:15], s31 offen offset:0  lds
    v_mfma_f32_16x16x32_bf16 v[196:199], a[32:35], a[28:31], 0
    ds_read_b128 a[84:87], v224 offset:36880
    v_mfma_f32_16x16x32_bf16 v[200:203], a[36:39], a[28:31], 0
    ds_read_b128 a[88:91], v224 offset:37904
    buffer_load_dwordx4 v233, s[12:15], s31 offen offset:1024  lds
    v_mfma_f32_16x16x32_bf16 v[204:207], a[40:43], a[28:31], 0
    v_mfma_f32_16x16x32_bf16 v[208:211], a[44:47], a[28:31], 0
    buffer_load_dwordx4 v233, s[12:15], s31 offen offset:2048  lds
    v_mfma_f32_16x16x32_bf16 v[212:215], a[48:51], a[28:31], 0
    v_mfma_f32_16x16x32_bf16 v[216:219], a[52:55], a[28:31], 0
    buffer_load_dwordx4 v233, s[12:15], s31 offen offset:3072  lds
    v_mfma_f32_16x16x32_bf16 v[220:223], a[56:59], a[28:31], 0
    s_waitcnt vmcnt(8) lgkmcnt(0)
    s_barrier
    v_mfma_f32_16x16x32_bf16 v[0:3], a[92:95], a[60:63], v[0:3]
    ds_read_b128 a[0:3], v225 offset:0
    v_mfma_f32_16x16x32_bf16 v[4:7], a[96:99], a[60:63], v[4:7]
    s_add_u32 m0, s37, 122944
    v_readlane_b32 s31, v255, 4
    s_nop 1
    s_mul_i32 s32, s31, 229376
    s_lshl_b32 s31, s31, 14
    buffer_load_dwordx4 v234, s[16:19], s32 offen offset:0 lds
    v_mfma_f32_16x16x32_bf16 v[8:11], a[100:103], a[60:63], v[8:11]
    ds_read_b64_tr_b16 a[32:33], v228 offset:0
    v_mfma_f32_16x16x32_bf16 v[12:15], a[104:107], a[60:63], v[12:15]
    v_mfma_f32_16x16x32_bf16 v[16:19], a[108:111], a[60:63], v[16:19]
    ds_read_b64_tr_b16 a[34:35], v228 offset:3584
    v_mfma_f32_16x16x32_bf16 v[20:23], a[112:115], a[60:63], v[20:23]
    buffer_load_dwordx4 v235, s[16:19], s32 offen offset:1024 lds
    v_mfma_f32_16x16x32_bf16 v[24:27], a[116:119], a[60:63], v[24:27]
    ds_read_b64_tr_b16 a[36:37], v228 offset:32
    v_mfma_f32_16x16x32_bf16 v[52:55], a[116:119], a[64:67], v[52:55]
    v_mfma_f32_16x16x32_bf16 v[48:51], a[112:115], a[64:67], v[48:51]
    buffer_load_dwordx4 v236, s[16:19], s32 offen offset:2048 lds
    v_mfma_f32_16x16x32_bf16 v[44:47], a[108:111], a[64:67], v[44:47]
    ds_read_b64_tr_b16 a[38:39], v228 offset:3616
    v_mfma_f32_16x16x32_bf16 v[40:43], a[104:107], a[64:67], v[40:43]
    v_mfma_f32_16x16x32_bf16 v[36:39], a[100:103], a[64:67], v[36:39]
    ds_read_b64_tr_b16 a[40:41], v228 offset:64
    v_mfma_f32_16x16x32_bf16 v[32:35], a[96:99], a[64:67], v[32:35]
    s_mov_b64 exec, s[38:39]
    buffer_load_dwordx4 v237, s[16:19], s32 offen offset:3072 lds
    s_mov_b64 exec, -1
    v_mfma_f32_16x16x32_bf16 v[28:31], a[92:95], a[64:67], v[28:31]
    ds_read_b64_tr_b16 a[42:43], v228 offset:3648
    v_mfma_f32_16x16x32_bf16 v[56:59], a[92:95], a[68:71], v[56:59]
    v_mfma_f32_16x16x32_bf16 v[60:63], a[96:99], a[68:71], v[60:63]
    s_add_u32 m0, s36, 122944
    s_nop 0
    buffer_load_dwordx4 v233, s[12:15], s31 offen offset:0  lds
    v_mfma_f32_16x16x32_bf16 v[64:67], a[100:103], a[68:71], v[64:67]
    ds_read_b64_tr_b16 a[44:45], v228 offset:7184
    v_mfma_f32_16x16x32_bf16 v[68:71], a[104:107], a[68:71], v[68:71]
    v_mfma_f32_16x16x32_bf16 v[72:75], a[108:111], a[68:71], v[72:75]
    ds_read_b64_tr_b16 a[46:47], v228 offset:10768
    v_mfma_f32_16x16x32_bf16 v[76:79], a[112:115], a[68:71], v[76:79]
    buffer_load_dwordx4 v233, s[12:15], s31 offen offset:1024  lds
    v_mfma_f32_16x16x32_bf16 v[80:83], a[116:119], a[68:71], v[80:83]
    ds_read_b64_tr_b16 a[48:49], v228 offset:7216
    v_mfma_f32_16x16x32_bf16 v[108:111], a[116:119], a[72:75], v[108:111]
    v_mfma_f32_16x16x32_bf16 v[104:107], a[112:115], a[72:75], v[104:107]
    ds_read_b64_tr_b16 a[50:51], v228 offset:10800
    buffer_load_dwordx4 v233, s[12:15], s31 offen offset:2048  lds
    v_mfma_f32_16x16x32_bf16 v[100:103], a[108:111], a[72:75], v[100:103]
    v_mfma_f32_16x16x32_bf16 v[96:99], a[104:107], a[72:75], v[96:99]
    v_mfma_f32_16x16x32_bf16 v[92:95], a[100:103], a[72:75], v[92:95]
    ds_read_b64_tr_b16 a[52:53], v228 offset:7248
    v_mfma_f32_16x16x32_bf16 v[88:91], a[96:99], a[72:75], v[88:91]
    buffer_load_dwordx4 v233, s[12:15], s31 offen offset:3072  lds
    v_mfma_f32_16x16x32_bf16 v[84:87], a[92:95], a[72:75], v[84:87]
    ds_read_b64_tr_b16 a[54:55], v228 offset:10832
    v_mfma_f32_16x16x32_bf16 v[112:115], a[92:95], a[76:79], v[112:115]
    v_mfma_f32_16x16x32_bf16 v[116:119], a[96:99], a[76:79], v[116:119]
    ds_read_b64_tr_b16 a[56:57], v231 offset:0
    s_add_u32 m0, s37, 0
    v_readlane_b32 s31, v255, 5
    s_nop 1
    s_mul_i32 s32, s31, 229376
    s_lshl_b32 s31, s31, 14
    buffer_load_dwordx4 v234, s[16:19], s32 offen offset:0 lds
    v_mfma_f32_16x16x32_bf16 v[120:123], a[100:103], a[76:79], v[120:123]
    v_mfma_f32_16x16x32_bf16 v[124:127], a[104:107], a[76:79], v[124:127]
    v_mfma_f32_16x16x32_bf16 v[128:131], a[108:111], a[76:79], v[128:131]
    ds_read_b64_tr_b16 a[58:59], v231 offset:3584
    v_mfma_f32_16x16x32_bf16 v[132:135], a[112:115], a[76:79], v[132:135]
    buffer_load_dwordx4 v235, s[16:19], s32 offen offset:1024 lds
    v_mfma_f32_16x16x32_bf16 v[136:139], a[116:119], a[76:79], v[136:139]
    ds_read_b128 a[4:7], v225 offset:1024
    v_mfma_f32_16x16x32_bf16 v[164:167], a[116:119], a[80:83], v[164:167]
    v_mfma_f32_16x16x32_bf16 v[160:163], a[112:115], a[80:83], v[160:163]
    ds_read_b128 a[8:11], v225 offset:2048
    buffer_load_dwordx4 v236, s[16:19], s32 offen offset:2048 lds
    v_mfma_f32_16x16x32_bf16 v[156:159], a[108:111], a[80:83], v[156:159]
    v_mfma_f32_16x16x32_bf16 v[152:155], a[104:107], a[80:83], v[152:155]
    ds_read_b128 a[12:15], v225 offset:3072
    v_mfma_f32_16x16x32_bf16 v[148:151], a[100:103], a[80:83], v[148:151]
    v_mfma_f32_16x16x32_bf16 v[144:147], a[96:99], a[80:83], v[144:147]
    s_mov_b64 exec, s[38:39]
    buffer_load_dwordx4 v237, s[16:19], s32 offen offset:3072 lds
    s_mov_b64 exec, -1
    v_mfma_f32_16x16x32_bf16 v[140:143], a[92:95], a[80:83], v[140:143]
    ds_read_b128 a[16:19], v225 offset:4096
    v_mfma_f32_16x16x32_bf16 v[168:171], a[92:95], a[84:87], v[168:171]
    v_mfma_f32_16x16x32_bf16 v[172:175], a[96:99], a[84:87], v[172:175]
    ds_read_b128 a[20:23], v225 offset:5120
    s_add_u32 m0, s36, 0
    s_nop 0
    buffer_load_dwordx4 v233, s[12:15], s31 offen offset:0  lds
    v_mfma_f32_16x16x32_bf16 v[176:179], a[100:103], a[84:87], v[176:179]
    v_mfma_f32_16x16x32_bf16 v[180:183], a[104:107], a[84:87], v[180:183]
    ds_read_b128 a[24:27], v225 offset:6144
    v_mfma_f32_16x16x32_bf16 v[184:187], a[108:111], a[84:87], v[184:187]
    v_mfma_f32_16x16x32_bf16 v[188:191], a[112:115], a[84:87], v[188:191]
    buffer_load_dwordx4 v233, s[12:15], s31 offen offset:1024  lds
    v_mfma_f32_16x16x32_bf16 v[192:195], a[116:119], a[84:87], v[192:195]
    ds_read_b128 a[28:31], v225 offset:7168
    v_mfma_f32_16x16x32_bf16 v[220:223], a[116:119], a[88:91], v[220:223]
    v_mfma_f32_16x16x32_bf16 v[216:219], a[112:115], a[88:91], v[216:219]
    buffer_load_dwordx4 v233, s[12:15], s31 offen offset:2048  lds
    v_mfma_f32_16x16x32_bf16 v[212:215], a[108:111], a[88:91], v[212:215]
    v_mfma_f32_16x16x32_bf16 v[208:211], a[104:107], a[88:91], v[208:211]
    v_mfma_f32_16x16x32_bf16 v[204:207], a[100:103], a[88:91], v[204:207]
    v_mfma_f32_16x16x32_bf16 v[200:203], a[96:99], a[88:91], v[200:203]
    buffer_load_dwordx4 v233, s[12:15], s31 offen offset:3072  lds
    v_mfma_f32_16x16x32_bf16 v[196:199], a[92:95], a[88:91], v[196:199]
    s_waitcnt vmcnt(16) lgkmcnt(0)
    s_barrier
    v_mfma_f32_16x16x32_bf16 v[0:3], a[32:35], a[0:3], v[0:3]
    ds_read_b128 a[60:63], v225 offset:30736
    v_mfma_f32_16x16x32_bf16 v[4:7], a[36:39], a[0:3], v[4:7]
    v_mfma_f32_16x16x32_bf16 v[8:11], a[40:43], a[0:3], v[8:11]
    ds_read_b64_tr_b16 a[92:93], v228 offset:30736
    s_add_u32 m0, s37, 30736
    v_readlane_b32 s31, v255, 6
    s_nop 1
    s_mul_i32 s32, s31, 229376
    s_lshl_b32 s31, s31, 14
    buffer_load_dwordx4 v234, s[16:19], s32 offen offset:0 lds
    v_mfma_f32_16x16x32_bf16 v[12:15], a[44:47], a[0:3], v[12:15]
    v_mfma_f32_16x16x32_bf16 v[16:19], a[48:51], a[0:3], v[16:19]
    ds_read_b64_tr_b16 a[94:95], v228 offset:34320
    v_mfma_f32_16x16x32_bf16 v[20:23], a[52:55], a[0:3], v[20:23]
    v_mfma_f32_16x16x32_bf16 v[24:27], a[56:59], a[0:3], v[24:27]
    ds_read_b64_tr_b16 a[96:97], v228 offset:30768
    buffer_load_dwordx4 v235, s[16:19], s32 offen offset:1024 lds
    v_mfma_f32_16x16x32_bf16 v[52:55], a[56:59], a[4:7], v[52:55]
    v_mfma_f32_16x16x32_bf16 v[48:51], a[52:55], a[4:7], v[48:51]
    v_mfma_f32_16x16x32_bf16 v[44:47], a[48:51], a[4:7], v[44:47]
    ds_read_b64_tr_b16 a[98:99], v228 offset:34352
    v_mfma_f32_16x16x32_bf16 v[40:43], a[44:47], a[4:7], v[40:43]
    buffer_load_dwordx4 v236, s[16:19], s32 offen offset:2048 lds
    v_mfma_f32_16x16x32_bf16 v[36:39], a[40:43], a[4:7], v[36:39]
    ds_read_b64_tr_b16 a[100:101], v228 offset:30800
    v_mfma_f32_16x16x32_bf16 v[32:35], a[36:39], a[4:7], v[32:35]
    v_mfma_f32_16x16x32_bf16 v[28:31], a[32:35], a[4:7], v[28:31]
    ds_read_b64_tr_b16 a[102:103], v228 offset:34384
    v_mfma_f32_16x16x32_bf16 v[56:59], a[32:35], a[8:11], v[56:59]
    v_mfma_f32_16x16x32_bf16 v[60:63], a[36:39], a[8:11], v[60:63]
    s_mov_b64 exec, s[38:39]
    buffer_load_dwordx4 v237, s[16:19], s32 offen offset:3072 lds
    s_mov_b64 exec, -1
    v_mfma_f32_16x16x32_bf16 v[64:67], a[40:43], a[8:11], v[64:67]
    ds_read_b64_tr_b16 a[104:105], v228 offset:37920
    v_mfma_f32_16x16x32_bf16 v[68:71], a[44:47], a[8:11], v[68:71]
    v_mfma_f32_16x16x32_bf16 v[72:75], a[48:51], a[8:11], v[72:75]
    ds_read_b64_tr_b16 a[106:107], v228 offset:41504
    v_mfma_f32_16x16x32_bf16 v[76:79], a[52:55], a[8:11], v[76:79]
    s_add_u32 m0, s36, 30736
    s_nop 0
    buffer_load_dwordx4 v233, s[12:15], s31 offen offset:0  lds
    v_mfma_f32_16x16x32_bf16 v[80:83], a[56:59], a[8:11], v[80:83]
    ds_read_b64_tr_b16 a[108:109], v228 offset:37952
    v_mfma_f32_16x16x32_bf16 v[108:111], a[56:59], a[12:15], v[108:111]
    v_mfma_f32_16x16x32_bf16 v[104:107], a[52:55], a[12:15], v[104:107]
    ds_read_b64_tr_b16 a[110:111], v228 offset:41536
    v_mfma_f32_16x16x32_bf16 v[100:103], a[48:51], a[12:15], v[100:103]
    buffer_load_dwordx4 v233, s[12:15], s31 offen offset:1024  lds
    v_mfma_f32_16x16x32_bf16 v[96:99], a[44:47], a[12:15], v[96:99]
    v_mfma_f32_16x16x32_bf16 v[92:95], a[40:43], a[12:15], v[92:95]
    ds_read_b64_tr_b16 a[112:113], v228 offset:37984
    v_mfma_f32_16x16x32_bf16 v[88:91], a[36:39], a[12:15], v[88:91]
    v_mfma_f32_16x16x32_bf16 v[84:87], a[32:35], a[12:15], v[84:87]
    ds_read_b64_tr_b16 a[114:115], v228 offset:41568
    v_mfma_f32_16x16x32_bf16 v[112:115], a[32:35], a[16:19], v[112:115]
    buffer_load_dwordx4 v233, s[12:15], s31 offen offset:2048  lds
    v_mfma_f32_16x16x32_bf16 v[116:119], a[36:39], a[16:19], v[116:119]
    ds_read_b64_tr_b16 a[116:117], v231 offset:30736
    v_mfma_f32_16x16x32_bf16 v[120:123], a[40:43], a[16:19], v[120:123]
    v_mfma_f32_16x16x32_bf16 v[124:127], a[44:47], a[16:19], v[124:127]
    v_mfma_f32_16x16x32_bf16 v[128:131], a[48:51], a[16:19], v[128:131]
    ds_read_b64_tr_b16 a[118:119], v231 offset:34320
    buffer_load_dwordx4 v233, s[12:15], s31 offen offset:3072  lds
    v_mfma_f32_16x16x32_bf16 v[132:135], a[52:55], a[16:19], v[132:135]
    v_mfma_f32_16x16x32_bf16 v[136:139], a[56:59], a[16:19], v[136:139]
    ds_read_b128 a[64:67], v225 offset:31760
    v_mfma_f32_16x16x32_bf16 v[164:167], a[56:59], a[20:23], v[164:167]
    v_mfma_f32_16x16x32_bf16 v[160:163], a[52:55], a[20:23], v[160:163]
    ds_read_b128 a[68:71], v225 offset:32784
    buffer_load_dwordx4 a[120:123], v240, s[24:27], s35 offen offset:0
    v_mfma_f32_16x16x32_bf16 v[156:159], a[48:51], a[20:23], v[156:159]
    v_mfma_f32_16x16x32_bf16 v[152:155], a[44:47], a[20:23], v[152:155]
    ds_read_b128 a[72:75], v225 offset:33808
    v_mfma_f32_16x16x32_bf16 v[148:151], a[40:43], a[20:23], v[148:151]
    v_mfma_f32_16x16x32_bf16 v[144:147], a[36:39], a[20:23], v[144:147]
    buffer_load_dwordx4 a[124:127], v240, s[24:27], s35 offen offset:1024
    v_mfma_f32_16x16x32_bf16 v[140:143], a[32:35], a[20:23], v[140:143]
    ds_read_b128 a[76:79], v225 offset:34832
    v_mfma_f32_16x16x32_bf16 v[168:171], a[32:35], a[24:27], v[168:171]
    v_mfma_f32_16x16x32_bf16 v[172:175], a[36:39], a[24:27], v[172:175]
    ds_read_b128 a[80:83], v225 offset:35856
    v_mfma_f32_16x16x32_bf16 v[176:179], a[40:43], a[24:27], v[176:179]
    v_mfma_f32_16x16x32_bf16 v[180:183], a[44:47], a[24:27], v[180:183]
    ds_read_b128 a[84:87], v225 offset:36880
    buffer_load_dwordx4 a[128:131], v240, s[24:27], s35 offen offset:2048
    v_mfma_f32_16x16x32_bf16 v[184:187], a[48:51], a[24:27], v[184:187]
    v_mfma_f32_16x16x32_bf16 v[188:191], a[52:55], a[24:27], v[188:191]
    v_mfma_f32_16x16x32_bf16 v[192:195], a[56:59], a[24:27], v[192:195]
    ds_read_b128 a[88:91], v225 offset:37904
    v_mfma_f32_16x16x32_bf16 v[220:223], a[56:59], a[28:31], v[220:223]
    buffer_load_dwordx4 a[132:135], v240, s[24:27], s35 offen offset:3072
    v_mfma_f32_16x16x32_bf16 v[216:219], a[52:55], a[28:31], v[216:219]
    v_mfma_f32_16x16x32_bf16 v[212:215], a[48:51], a[28:31], v[212:215]
    v_mfma_f32_16x16x32_bf16 v[208:211], a[44:47], a[28:31], v[208:211]
    v_mfma_f32_16x16x32_bf16 v[204:207], a[40:43], a[28:31], v[204:207]
    buffer_load_dword v247, v249, s[56:59], 0 offen
    v_mfma_f32_16x16x32_bf16 v[200:203], a[36:39], a[28:31], v[200:203]
    v_mfma_f32_16x16x32_bf16 v[196:199], a[32:35], a[28:31], v[196:199]
    s_waitcnt vmcnt(21) lgkmcnt(0)
    s_barrier
    v_mfma_f32_16x16x32_bf16 v[0:3], a[92:95], a[60:63], v[0:3]
    ds_read_b128 a[0:3], v226 offset:0
    v_mfma_f32_16x16x32_bf16 v[4:7], a[96:99], a[60:63], v[4:7]
    ds_read_b64_tr_b16 a[32:33], v229 offset:0
    v_mfma_f32_16x16x32_bf16 v[8:11], a[100:103], a[60:63], v[8:11]
    s_add_u32 m0, s37, 61472
    v_readlane_b32 s31, v255, 7
    s_nop 1
    s_mul_i32 s32, s31, 229376
    s_lshl_b32 s31, s31, 14
    v_mfma_f32_16x16x32_bf16 v[12:15], a[104:107], a[60:63], v[12:15]
    buffer_load_dwordx4 v234, s[16:19], s32 offen offset:0 lds
    v_mfma_f32_16x16x32_bf16 v[16:19], a[108:111], a[60:63], v[16:19]
    v_mfma_f32_16x16x32_bf16 v[20:23], a[112:115], a[60:63], v[20:23]
    ds_read_b64_tr_b16 a[34:35], v229 offset:3584
    v_mfma_f32_16x16x32_bf16 v[24:27], a[116:119], a[60:63], v[24:27]
    ds_read_b64_tr_b16 a[36:37], v229 offset:32
    v_mfma_f32_16x16x32_bf16 v[52:55], a[116:119], a[64:67], v[52:55]
    v_mfma_f32_16x16x32_bf16 v[48:51], a[112:115], a[64:67], v[48:51]
    ds_read_b64_tr_b16 a[38:39], v229 offset:3616
    v_mfma_f32_16x16x32_bf16 v[44:47], a[108:111], a[64:67], v[44:47]
    v_mfma_f32_16x16x32_bf16 v[40:43], a[104:107], a[64:67], v[40:43]
    buffer_load_dwordx4 v235, s[16:19], s32 offen offset:1024 lds
    v_mfma_f32_16x16x32_bf16 v[36:39], a[100:103], a[64:67], v[36:39]
    v_mfma_f32_16x16x32_bf16 v[32:35], a[96:99], a[64:67], v[32:35]
    ds_read_b64_tr_b16 a[40:41], v229 offset:64
    v_mfma_f32_16x16x32_bf16 v[28:31], a[92:95], a[64:67], v[28:31]
    ds_read_b64_tr_b16 a[42:43], v229 offset:3648
    v_mfma_f32_16x16x32_bf16 v[56:59], a[92:95], a[68:71], v[56:59]
    v_mfma_f32_16x16x32_bf16 v[60:63], a[96:99], a[68:71], v[60:63]
    ds_read_b64_tr_b16 a[44:45], v229 offset:7184
    v_mfma_f32_16x16x32_bf16 v[64:67], a[100:103], a[68:71], v[64:67]
    v_mfma_f32_16x16x32_bf16 v[68:71], a[104:107], a[68:71], v[68:71]
    buffer_load_dwordx4 v236, s[16:19], s32 offen offset:2048 lds
    v_mfma_f32_16x16x32_bf16 v[72:75], a[108:111], a[68:71], v[72:75]
    v_mfma_f32_16x16x32_bf16 v[76:79], a[112:115], a[68:71], v[76:79]
    ds_read_b64_tr_b16 a[46:47], v229 offset:10768
    v_mfma_f32_16x16x32_bf16 v[80:83], a[116:119], a[68:71], v[80:83]
    ds_read_b64_tr_b16 a[48:49], v229 offset:7216
    v_mfma_f32_16x16x32_bf16 v[108:111], a[116:119], a[72:75], v[108:111]
    v_mfma_f32_16x16x32_bf16 v[104:107], a[112:115], a[72:75], v[104:107]
    ds_read_b64_tr_b16 a[50:51], v229 offset:10800
    v_mfma_f32_16x16x32_bf16 v[100:103], a[108:111], a[72:75], v[100:103]
    v_mfma_f32_16x16x32_bf16 v[96:99], a[104:107], a[72:75], v[96:99]
    s_mov_b64 exec, s[38:39]
    buffer_load_dwordx4 v237, s[16:19], s32 offen offset:3072 lds
    s_mov_b64 exec, -1
    v_mfma_f32_16x16x32_bf16 v[92:95], a[100:103], a[72:75], v[92:95]
    v_mfma_f32_16x16x32_bf16 v[88:91], a[96:99], a[72:75], v[88:91]
    ds_read_b64_tr_b16 a[52:53], v229 offset:7248
    v_mfma_f32_16x16x32_bf16 v[84:87], a[92:95], a[72:75], v[84:87]
    ds_read_b64_tr_b16 a[54:55], v229 offset:10832
    v_mfma_f32_16x16x32_bf16 v[112:115], a[92:95], a[76:79], v[112:115]
    v_mfma_f32_16x16x32_bf16 v[116:119], a[96:99], a[76:79], v[116:119]
    ds_read_b64_tr_b16 a[56:57], v232 offset:0
    v_mfma_f32_16x16x32_bf16 v[120:123], a[100:103], a[76:79], v[120:123]
    s_add_u32 m0, s36, 61472
    v_mfma_f32_16x16x32_bf16 v[124:127], a[104:107], a[76:79], v[124:127]
    buffer_load_dwordx4 v233, s[12:15], s31 offen offset:0  lds
    v_mfma_f32_16x16x32_bf16 v[128:131], a[108:111], a[76:79], v[128:131]
    v_mfma_f32_16x16x32_bf16 v[132:135], a[112:115], a[76:79], v[132:135]
    ds_read_b64_tr_b16 a[58:59], v232 offset:3584
    v_mfma_f32_16x16x32_bf16 v[136:139], a[116:119], a[76:79], v[136:139]
    ds_read_b128 a[4:7], v226 offset:1024
    v_mfma_f32_16x16x32_bf16 v[164:167], a[116:119], a[80:83], v[164:167]
    ds_read_b128 a[8:11], v226 offset:2048
    v_mfma_f32_16x16x32_bf16 v[160:163], a[112:115], a[80:83], v[160:163]
    v_mfma_f32_16x16x32_bf16 v[156:159], a[108:111], a[80:83], v[156:159]
    v_mfma_f32_16x16x32_bf16 v[152:155], a[104:107], a[80:83], v[152:155]
    buffer_load_dwordx4 v233, s[12:15], s31 offen offset:1024  lds
    v_mfma_f32_16x16x32_bf16 v[148:151], a[100:103], a[80:83], v[148:151]
    v_mfma_f32_16x16x32_bf16 v[144:147], a[96:99], a[80:83], v[144:147]
    ds_read_b128 a[12:15], v226 offset:3072
    v_mfma_f32_16x16x32_bf16 v[140:143], a[92:95], a[80:83], v[140:143]
    ds_read_b128 a[16:19], v226 offset:4096
    v_mfma_f32_16x16x32_bf16 v[168:171], a[92:95], a[84:87], v[168:171]
    ds_read_b128 a[20:23], v226 offset:5120
    v_mfma_f32_16x16x32_bf16 v[172:175], a[96:99], a[84:87], v[172:175]
    v_mfma_f32_16x16x32_bf16 v[176:179], a[100:103], a[84:87], v[176:179]
    v_mfma_f32_16x16x32_bf16 v[180:183], a[104:107], a[84:87], v[180:183]
    buffer_load_dwordx4 v233, s[12:15], s31 offen offset:2048  lds
    v_mfma_f32_16x16x32_bf16 v[184:187], a[108:111], a[84:87], v[184:187]
    v_mfma_f32_16x16x32_bf16 v[188:191], a[112:115], a[84:87], v[188:191]
    ds_read_b128 a[24:27], v226 offset:6144
    v_mfma_f32_16x16x32_bf16 v[192:195], a[116:119], a[84:87], v[192:195]
    ds_read_b128 a[28:31], v226 offset:7168
    v_mfma_f32_16x16x32_bf16 v[220:223], a[116:119], a[88:91], v[220:223]
    v_mfma_f32_16x16x32_bf16 v[216:219], a[112:115], a[88:91], v[216:219]
    v_mfma_f32_16x16x32_bf16 v[212:215], a[108:111], a[88:91], v[212:215]
    v_mfma_f32_16x16x32_bf16 v[208:211], a[104:107], a[88:91], v[208:211]
    buffer_load_dwordx4 v233, s[12:15], s31 offen offset:3072  lds
    v_mfma_f32_16x16x32_bf16 v[204:207], a[100:103], a[88:91], v[204:207]
    v_mfma_f32_16x16x32_bf16 v[200:203], a[96:99], a[88:91], v[200:203]
    v_mfma_f32_16x16x32_bf16 v[196:199], a[92:95], a[88:91], v[196:199]
    s_waitcnt vmcnt(21) lgkmcnt(0)
    s_barrier
    v_mfma_f32_16x16x32_bf16 v[0:3], a[32:35], a[0:3], v[0:3]
    ds_read_b128 a[60:63], v224 offset:0
    v_mfma_f32_16x16x32_bf16 v[4:7], a[36:39], a[0:3], v[4:7]
    ds_read_b64_tr_b16 a[92:93], v227 offset:0
    v_mfma_f32_16x16x32_bf16 v[8:11], a[40:43], a[0:3], v[8:11]
    s_add_u32 m0, s37, 92208
    v_readlane_b32 s31, v255, 8
    s_nop 1
    s_mul_i32 s32, s31, 229376
    s_lshl_b32 s31, s31, 14
    v_mfma_f32_16x16x32_bf16 v[12:15], a[44:47], a[0:3], v[12:15]
    buffer_load_dwordx4 v234, s[16:19], s32 offen offset:0 lds
    v_mfma_f32_16x16x32_bf16 v[16:19], a[48:51], a[0:3], v[16:19]
    v_mfma_f32_16x16x32_bf16 v[20:23], a[52:55], a[0:3], v[20:23]
    ds_read_b64_tr_b16 a[94:95], v227 offset:3584
    v_mfma_f32_16x16x32_bf16 v[24:27], a[56:59], a[0:3], v[24:27]
    ds_read_b64_tr_b16 a[96:97], v227 offset:32
    v_mfma_f32_16x16x32_bf16 v[52:55], a[56:59], a[4:7], v[52:55]
    v_mfma_f32_16x16x32_bf16 v[48:51], a[52:55], a[4:7], v[48:51]
    ds_read_b64_tr_b16 a[98:99], v227 offset:3616
    v_mfma_f32_16x16x32_bf16 v[44:47], a[48:51], a[4:7], v[44:47]
    v_mfma_f32_16x16x32_bf16 v[40:43], a[44:47], a[4:7], v[40:43]
    buffer_load_dwordx4 v235, s[16:19], s32 offen offset:1024 lds
    v_mfma_f32_16x16x32_bf16 v[36:39], a[40:43], a[4:7], v[36:39]
    v_mfma_f32_16x16x32_bf16 v[32:35], a[36:39], a[4:7], v[32:35]
    ds_read_b64_tr_b16 a[100:101], v227 offset:64
    v_mfma_f32_16x16x32_bf16 v[28:31], a[32:35], a[4:7], v[28:31]
    ds_read_b64_tr_b16 a[102:103], v227 offset:3648
    v_mfma_f32_16x16x32_bf16 v[56:59], a[32:35], a[8:11], v[56:59]
    v_mfma_f32_16x16x32_bf16 v[60:63], a[36:39], a[8:11], v[60:63]
    ds_read_b64_tr_b16 a[104:105], v227 offset:7184
    v_mfma_f32_16x16x32_bf16 v[64:67], a[40:43], a[8:11], v[64:67]
    v_mfma_f32_16x16x32_bf16 v[68:71], a[44:47], a[8:11], v[68:71]
    buffer_load_dwordx4 v236, s[16:19], s32 offen offset:2048 lds
    v_mfma_f32_16x16x32_bf16 v[72:75], a[48:51], a[8:11], v[72:75]
    v_mfma_f32_16x16x32_bf16 v[76:79], a[52:55], a[8:11], v[76:79]
    ds_read_b64_tr_b16 a[106:107], v227 offset:10768
    v_mfma_f32_16x16x32_bf16 v[80:83], a[56:59], a[8:11], v[80:83]
    ds_read_b64_tr_b16 a[108:109], v227 offset:7216
    v_mfma_f32_16x16x32_bf16 v[108:111], a[56:59], a[12:15], v[108:111]
    v_mfma_f32_16x16x32_bf16 v[104:107], a[52:55], a[12:15], v[104:107]
    ds_read_b64_tr_b16 a[110:111], v227 offset:10800
    v_mfma_f32_16x16x32_bf16 v[100:103], a[48:51], a[12:15], v[100:103]
    v_mfma_f32_16x16x32_bf16 v[96:99], a[44:47], a[12:15], v[96:99]
    s_mov_b64 exec, s[38:39]
    buffer_load_dwordx4 v237, s[16:19], s32 offen offset:3072 lds
    s_mov_b64 exec, -1
    v_mfma_f32_16x16x32_bf16 v[92:95], a[40:43], a[12:15], v[92:95]
    v_mfma_f32_16x16x32_bf16 v[88:91], a[36:39], a[12:15], v[88:91]
    ds_read_b64_tr_b16 a[112:113], v227 offset:7248
    v_mfma_f32_16x16x32_bf16 v[84:87], a[32:35], a[12:15], v[84:87]
    ds_read_b64_tr_b16 a[114:115], v227 offset:10832
    v_mfma_f32_16x16x32_bf16 v[112:115], a[32:35], a[16:19], v[112:115]
    v_mfma_f32_16x16x32_bf16 v[116:119], a[36:39], a[16:19], v[116:119]
    ds_read_b64_tr_b16 a[116:117], v230 offset:0
    v_mfma_f32_16x16x32_bf16 v[120:123], a[40:43], a[16:19], v[120:123]
    s_add_u32 m0, s36, 92208
    v_mfma_f32_16x16x32_bf16 v[124:127], a[44:47], a[16:19], v[124:127]
    buffer_load_dwordx4 v233, s[12:15], s31 offen offset:0  lds
    v_mfma_f32_16x16x32_bf16 v[128:131], a[48:51], a[16:19], v[128:131]
    v_mfma_f32_16x16x32_bf16 v[132:135], a[52:55], a[16:19], v[132:135]
    ds_read_b64_tr_b16 a[118:119], v230 offset:3584
    v_mfma_f32_16x16x32_bf16 v[136:139], a[56:59], a[16:19], v[136:139]
    ds_read_b128 a[64:67], v224 offset:1024
    v_mfma_f32_16x16x32_bf16 v[164:167], a[56:59], a[20:23], v[164:167]
    ds_read_b128 a[68:71], v224 offset:2048
    v_mfma_f32_16x16x32_bf16 v[160:163], a[52:55], a[20:23], v[160:163]
    v_mfma_f32_16x16x32_bf16 v[156:159], a[48:51], a[20:23], v[156:159]
    v_mfma_f32_16x16x32_bf16 v[152:155], a[44:47], a[20:23], v[152:155]
    buffer_load_dwordx4 v233, s[12:15], s31 offen offset:1024  lds
    v_mfma_f32_16x16x32_bf16 v[148:151], a[40:43], a[20:23], v[148:151]
    v_mfma_f32_16x16x32_bf16 v[144:147], a[36:39], a[20:23], v[144:147]
    ds_read_b128 a[72:75], v224 offset:3072
    v_mfma_f32_16x16x32_bf16 v[140:143], a[32:35], a[20:23], v[140:143]
    ds_read_b128 a[76:79], v224 offset:4096
    v_mfma_f32_16x16x32_bf16 v[168:171], a[32:35], a[24:27], v[168:171]
    ds_read_b128 a[80:83], v224 offset:5120
    v_mfma_f32_16x16x32_bf16 v[172:175], a[36:39], a[24:27], v[172:175]
    v_mfma_f32_16x16x32_bf16 v[176:179], a[40:43], a[24:27], v[176:179]
    v_mfma_f32_16x16x32_bf16 v[180:183], a[44:47], a[24:27], v[180:183]
    buffer_load_dwordx4 v233, s[12:15], s31 offen offset:2048  lds
    v_mfma_f32_16x16x32_bf16 v[184:187], a[48:51], a[24:27], v[184:187]
    v_mfma_f32_16x16x32_bf16 v[188:191], a[52:55], a[24:27], v[188:191]
    ds_read_b128 a[84:87], v224 offset:6144
    v_mfma_f32_16x16x32_bf16 v[192:195], a[56:59], a[24:27], v[192:195]
    ds_read_b128 a[88:91], v224 offset:7168
    v_mfma_f32_16x16x32_bf16 v[220:223], a[56:59], a[28:31], v[220:223]
    v_mfma_f32_16x16x32_bf16 v[216:219], a[52:55], a[28:31], v[216:219]
    v_mfma_f32_16x16x32_bf16 v[212:215], a[48:51], a[28:31], v[212:215]
    v_mfma_f32_16x16x32_bf16 v[208:211], a[44:47], a[28:31], v[208:211]
    buffer_load_dwordx4 v233, s[12:15], s31 offen offset:3072  lds
    v_mfma_f32_16x16x32_bf16 v[204:207], a[40:43], a[28:31], v[204:207]
    v_mfma_f32_16x16x32_bf16 v[200:203], a[36:39], a[28:31], v[200:203]
    v_mfma_f32_16x16x32_bf16 v[196:199], a[32:35], a[28:31], v[196:199]
    s_waitcnt vmcnt(21) lgkmcnt(0)
    s_barrier
    v_mfma_f32_16x16x32_bf16 v[0:3], a[92:95], a[60:63], v[0:3]
    ds_read_b128 a[0:3], v224 offset:30736
    v_mfma_f32_16x16x32_bf16 v[4:7], a[96:99], a[60:63], v[4:7]
    ds_read_b64_tr_b16 a[32:33], v227 offset:30736
    v_mfma_f32_16x16x32_bf16 v[8:11], a[100:103], a[60:63], v[8:11]
    s_add_u32 m0, s37, 122944
    v_readlane_b32 s31, v255, 9
    s_nop 1
    s_mul_i32 s32, s31, 229376
    s_lshl_b32 s31, s31, 14
    v_mfma_f32_16x16x32_bf16 v[12:15], a[104:107], a[60:63], v[12:15]
    buffer_load_dwordx4 v234, s[16:19], s32 offen offset:0 lds
    v_mfma_f32_16x16x32_bf16 v[16:19], a[108:111], a[60:63], v[16:19]
    v_mfma_f32_16x16x32_bf16 v[20:23], a[112:115], a[60:63], v[20:23]
    ds_read_b64_tr_b16 a[34:35], v227 offset:34320
    v_mfma_f32_16x16x32_bf16 v[24:27], a[116:119], a[60:63], v[24:27]
    ds_read_b64_tr_b16 a[36:37], v227 offset:30768
    v_mfma_f32_16x16x32_bf16 v[52:55], a[116:119], a[64:67], v[52:55]
    v_mfma_f32_16x16x32_bf16 v[48:51], a[112:115], a[64:67], v[48:51]
    ds_read_b64_tr_b16 a[38:39], v227 offset:34352
    v_mfma_f32_16x16x32_bf16 v[44:47], a[108:111], a[64:67], v[44:47]
    v_mfma_f32_16x16x32_bf16 v[40:43], a[104:107], a[64:67], v[40:43]
    buffer_load_dwordx4 v235, s[16:19], s32 offen offset:1024 lds
    v_mfma_f32_16x16x32_bf16 v[36:39], a[100:103], a[64:67], v[36:39]
    v_mfma_f32_16x16x32_bf16 v[32:35], a[96:99], a[64:67], v[32:35]
    ds_read_b64_tr_b16 a[40:41], v227 offset:30800
    v_mfma_f32_16x16x32_bf16 v[28:31], a[92:95], a[64:67], v[28:31]
    ds_read_b64_tr_b16 a[42:43], v227 offset:34384
    v_mfma_f32_16x16x32_bf16 v[56:59], a[92:95], a[68:71], v[56:59]
    v_mfma_f32_16x16x32_bf16 v[60:63], a[96:99], a[68:71], v[60:63]
    ds_read_b64_tr_b16 a[44:45], v227 offset:37920
    v_mfma_f32_16x16x32_bf16 v[64:67], a[100:103], a[68:71], v[64:67]
    v_mfma_f32_16x16x32_bf16 v[68:71], a[104:107], a[68:71], v[68:71]
    buffer_load_dwordx4 v236, s[16:19], s32 offen offset:2048 lds
    v_mfma_f32_16x16x32_bf16 v[72:75], a[108:111], a[68:71], v[72:75]
    v_mfma_f32_16x16x32_bf16 v[76:79], a[112:115], a[68:71], v[76:79]
    ds_read_b64_tr_b16 a[46:47], v227 offset:41504
    v_mfma_f32_16x16x32_bf16 v[80:83], a[116:119], a[68:71], v[80:83]
    ds_read_b64_tr_b16 a[48:49], v227 offset:37952
    v_mfma_f32_16x16x32_bf16 v[108:111], a[116:119], a[72:75], v[108:111]
    v_mfma_f32_16x16x32_bf16 v[104:107], a[112:115], a[72:75], v[104:107]
    ds_read_b64_tr_b16 a[50:51], v227 offset:41536
    v_mfma_f32_16x16x32_bf16 v[100:103], a[108:111], a[72:75], v[100:103]
    v_mfma_f32_16x16x32_bf16 v[96:99], a[104:107], a[72:75], v[96:99]
    s_mov_b64 exec, s[38:39]
    buffer_load_dwordx4 v237, s[16:19], s32 offen offset:3072 lds
    s_mov_b64 exec, -1
    v_mfma_f32_16x16x32_bf16 v[92:95], a[100:103], a[72:75], v[92:95]
    v_mfma_f32_16x16x32_bf16 v[88:91], a[96:99], a[72:75], v[88:91]
    ds_read_b64_tr_b16 a[52:53], v227 offset:37984
    v_mfma_f32_16x16x32_bf16 v[84:87], a[92:95], a[72:75], v[84:87]
    ds_read_b64_tr_b16 a[54:55], v227 offset:41568
    v_mfma_f32_16x16x32_bf16 v[112:115], a[92:95], a[76:79], v[112:115]
    v_mfma_f32_16x16x32_bf16 v[116:119], a[96:99], a[76:79], v[116:119]
    ds_read_b64_tr_b16 a[56:57], v230 offset:30736
    v_mfma_f32_16x16x32_bf16 v[120:123], a[100:103], a[76:79], v[120:123]
    s_add_u32 m0, s36, 122944
    v_mfma_f32_16x16x32_bf16 v[124:127], a[104:107], a[76:79], v[124:127]
    buffer_load_dwordx4 v233, s[12:15], s31 offen offset:0  lds
    v_mfma_f32_16x16x32_bf16 v[128:131], a[108:111], a[76:79], v[128:131]
    v_mfma_f32_16x16x32_bf16 v[132:135], a[112:115], a[76:79], v[132:135]
    ds_read_b64_tr_b16 a[58:59], v230 offset:34320
    v_mfma_f32_16x16x32_bf16 v[136:139], a[116:119], a[76:79], v[136:139]
    ds_read_b128 a[4:7], v224 offset:31760
    v_mfma_f32_16x16x32_bf16 v[164:167], a[116:119], a[80:83], v[164:167]
    ds_read_b128 a[8:11], v224 offset:32784
    v_mfma_f32_16x16x32_bf16 v[160:163], a[112:115], a[80:83], v[160:163]
    v_mfma_f32_16x16x32_bf16 v[156:159], a[108:111], a[80:83], v[156:159]
    v_mfma_f32_16x16x32_bf16 v[152:155], a[104:107], a[80:83], v[152:155]
    buffer_load_dwordx4 v233, s[12:15], s31 offen offset:1024  lds
    v_mfma_f32_16x16x32_bf16 v[148:151], a[100:103], a[80:83], v[148:151]
    v_mfma_f32_16x16x32_bf16 v[144:147], a[96:99], a[80:83], v[144:147]
    ds_read_b128 a[12:15], v224 offset:33808
    v_mfma_f32_16x16x32_bf16 v[140:143], a[92:95], a[80:83], v[140:143]
    ds_read_b128 a[16:19], v224 offset:34832
    v_mfma_f32_16x16x32_bf16 v[168:171], a[92:95], a[84:87], v[168:171]
    ds_read_b128 a[20:23], v224 offset:35856
    v_mfma_f32_16x16x32_bf16 v[172:175], a[96:99], a[84:87], v[172:175]
    v_mfma_f32_16x16x32_bf16 v[176:179], a[100:103], a[84:87], v[176:179]
    v_mfma_f32_16x16x32_bf16 v[180:183], a[104:107], a[84:87], v[180:183]
    buffer_load_dwordx4 v233, s[12:15], s31 offen offset:2048  lds
    v_mfma_f32_16x16x32_bf16 v[184:187], a[108:111], a[84:87], v[184:187]
    v_mfma_f32_16x16x32_bf16 v[188:191], a[112:115], a[84:87], v[188:191]
    ds_read_b128 a[24:27], v224 offset:36880
    v_mfma_f32_16x16x32_bf16 v[192:195], a[116:119], a[84:87], v[192:195]
    ds_read_b128 a[28:31], v224 offset:37904
    v_mfma_f32_16x16x32_bf16 v[220:223], a[116:119], a[88:91], v[220:223]
    v_mfma_f32_16x16x32_bf16 v[216:219], a[112:115], a[88:91], v[216:219]
    v_mfma_f32_16x16x32_bf16 v[212:215], a[108:111], a[88:91], v[212:215]
    v_mfma_f32_16x16x32_bf16 v[208:211], a[104:107], a[88:91], v[208:211]
    buffer_load_dwordx4 v233, s[12:15], s31 offen offset:3072  lds
    v_mfma_f32_16x16x32_bf16 v[204:207], a[100:103], a[88:91], v[204:207]
    v_mfma_f32_16x16x32_bf16 v[200:203], a[96:99], a[88:91], v[200:203]
    v_mfma_f32_16x16x32_bf16 v[196:199], a[92:95], a[88:91], v[196:199]
    s_waitcnt vmcnt(16) lgkmcnt(0)
    s_barrier
    v_mfma_f32_16x16x32_bf16 v[0:3], a[32:35], a[0:3], v[0:3]
    v_accvgpr_read_b32 v243, a120
    v_accvgpr_read_b32 v241, a121
    ds_read_b128 a[60:63], v225 offset:0
    v_mfma_f32_16x16x32_bf16 v[4:7], a[36:39], a[0:3], v[4:7]
    v_accvgpr_read_b32 v242, a122
    v_mfma_f32_16x16x32_bf16 v[8:11], a[40:43], a[0:3], v[8:11]
    v_add_f32 v243, v243, v241
    ds_read_b64_tr_b16 a[92:93], v228 offset:0
    v_mfma_f32_16x16x32_bf16 v[12:15], a[44:47], a[0:3], v[12:15]
    v_accvgpr_read_b32 v241, a123
    v_add_f32 v243, v243, v242
    s_add_u32 m0, s37, 0
    v_readlane_b32 s31, v255, 10
    s_nop 1
    s_mul_i32 s32, s31, 229376
    s_lshl_b32 s31, s31, 14
    buffer_load_dwordx4 v234, s[16:19], s32 offen offset:0 lds
    v_mfma_f32_16x16x32_bf16 v[16:19], a[48:51], a[0:3], v[16:19]
    v_add_f32 v243, v243, v241
    ds_read_b64_tr_b16 a[94:95], v228 offset:3584
    v_mfma_f32_16x16x32_bf16 v[20:23], a[52:55], a[0:3], v[20:23]
    v_accvgpr_read_b32 v244, a124
    v_mfma_f32_16x16x32_bf16 v[24:27], a[56:59], a[0:3], v[24:27]
    v_accvgpr_read_b32 v241, a125
    ds_read_b64_tr_b16 a[96:97], v228 offset:32
    v_mfma_f32_16x16x32_bf16 v[52:55], a[56:59], a[4:7], v[52:55]
    v_accvgpr_read_b32 v242, a126
    v_add_f32 v244, v244, v241
    v_mfma_f32_16x16x32_bf16 v[48:51], a[52:55], a[4:7], v[48:51]
    v_accvgpr_read_b32 v241, a127
    v_mfma_f32_16x16x32_bf16 v[44:47], a[48:51], a[4:7], v[44:47]
    v_add_f32 v244, v244, v242
    ds_read_b64_tr_b16 a[98:99], v228 offset:3616
    v_mfma_f32_16x16x32_bf16 v[40:43], a[44:47], a[4:7], v[40:43]
    v_add_f32 v244, v244, v241
    buffer_load_dwordx4 v235, s[16:19], s32 offen offset:1024 lds
    v_mfma_f32_16x16x32_bf16 v[36:39], a[40:43], a[4:7], v[36:39]
    v_accvgpr_read_b32 v245, a128
    v_accvgpr_read_b32 v241, a129
    ds_read_b64_tr_b16 a[100:101], v228 offset:64
    v_mfma_f32_16x16x32_bf16 v[32:35], a[36:39], a[4:7], v[32:35]
    v_accvgpr_read_b32 v242, a130
    v_mfma_f32_16x16x32_bf16 v[28:31], a[32:35], a[4:7], v[28:31]
    v_add_f32 v245, v245, v241
    ds_read_b64_tr_b16 a[102:103], v228 offset:3648
    v_mfma_f32_16x16x32_bf16 v[56:59], a[32:35], a[8:11], v[56:59]
    v_accvgpr_read_b32 v241, a131
    v_mfma_f32_16x16x32_bf16 v[60:63], a[36:39], a[8:11], v[60:63]
    v_add_f32 v245, v245, v242
    v_add_f32 v245, v245, v241
    v_mfma_f32_16x16x32_bf16 v[64:67], a[40:43], a[8:11], v[64:67]
    v_accvgpr_read_b32 v246, a132
    ds_read_b64_tr_b16 a[104:105], v228 offset:7184
    v_mfma_f32_16x16x32_bf16 v[68:71], a[44:47], a[8:11], v[68:71]
    v_accvgpr_read_b32 v241, a133
    buffer_load_dwordx4 v236, s[16:19], s32 offen offset:2048 lds
    v_mfma_f32_16x16x32_bf16 v[72:75], a[48:51], a[8:11], v[72:75]
    v_accvgpr_read_b32 v242, a134
    ds_read_b64_tr_b16 a[106:107], v228 offset:10768
    v_mfma_f32_16x16x32_bf16 v[76:79], a[52:55], a[8:11], v[76:79]
    v_add_f32 v246, v246, v241
    v_accvgpr_read_b32 v241, a135
    v_mfma_f32_16x16x32_bf16 v[80:83], a[56:59], a[8:11], v[80:83]
    v_add_f32 v246, v246, v242
    ds_read_b64_tr_b16 a[108:109], v228 offset:7216
    v_mfma_f32_16x16x32_bf16 v[108:111], a[56:59], a[12:15], v[108:111]
    v_add_f32 v246, v246, v241
    v_mfma_f32_16x16x32_bf16 v[104:107], a[52:55], a[12:15], v[104:107]
    v_and_b32 v241, 3, v238
    ds_read_b64_tr_b16 a[110:111], v228 offset:10800
    v_mfma_f32_16x16x32_bf16 v[100:103], a[48:51], a[12:15], v[100:103]
    s_nop 0
    v_add_f32_dpp v243, v243, v243 quad_perm:[1,0,3,2] row_mask:0xf bank_mask:0xf
    v_mfma_f32_16x16x32_bf16 v[96:99], a[44:47], a[12:15], v[96:99]
    v_add_f32_dpp v244, v244, v244 quad_perm:[1,0,3,2] row_mask:0xf bank_mask:0xf
    s_mov_b64 exec, s[38:39]
    buffer_load_dwordx4 v237, s[16:19], s32 offen offset:3072 lds
    s_mov_b64 exec, -1
    v_mfma_f32_16x16x32_bf16 v[92:95], a[40:43], a[12:15], v[92:95]
    v_add_f32_dpp v245, v245, v245 quad_perm:[1,0,3,2] row_mask:0xf bank_mask:0xf
    ds_read_b64_tr_b16 a[112:113], v228 offset:7248
    v_mfma_f32_16x16x32_bf16 v[88:91], a[36:39], a[12:15], v[88:91]
    v_add_f32_dpp v246, v246, v246 quad_perm:[1,0,3,2] row_mask:0xf bank_mask:0xf
    v_mfma_f32_16x16x32_bf16 v[84:87], a[32:35], a[12:15], v[84:87]
    v_add_f32_dpp v243, v243, v243 quad_perm:[2,3,0,1] row_mask:0xf bank_mask:0xf
    v_add_f32_dpp v244, v244, v244 quad_perm:[2,3,0,1] row_mask:0xf bank_mask:0xf
    ds_read_b64_tr_b16 a[114:115], v228 offset:10832
    v_mfma_f32_16x16x32_bf16 v[112:115], a[32:35], a[16:19], v[112:115]
    v_add_f32_dpp v245, v245, v245 quad_perm:[2,3,0,1] row_mask:0xf bank_mask:0xf
    v_mfma_f32_16x16x32_bf16 v[116:119], a[36:39], a[16:19], v[116:119]
    v_add_f32_dpp v246, v246, v246 quad_perm:[2,3,0,1] row_mask:0xf bank_mask:0xf
    ds_read_b64_tr_b16 a[116:117], v231 offset:0
    v_mfma_f32_16x16x32_bf16 v[120:123], a[40:43], a[16:19], v[120:123]
    v_cmp_eq_u32 vcc, 1, v241
    v_mfma_f32_16x16x32_bf16 v[124:127], a[44:47], a[16:19], v[124:127]
    s_nop 1
    v_cndmask_b32 v243, v243, v244, vcc
    s_add_u32 m0, s36, 0
    s_nop 0
    buffer_load_dwordx4 v233, s[12:15], s31 offen offset:0  lds
    v_mfma_f32_16x16x32_bf16 v[128:131], a[48:51], a[16:19], v[128:131]
    v_cmp_eq_u32 vcc, 2, v241
    ds_read_b64_tr_b16 a[118:119], v231 offset:3584
    v_mfma_f32_16x16x32_bf16 v[132:135], a[52:55], a[16:19], v[132:135]
    s_nop 1
    v_mfma_f32_16x16x32_bf16 v[136:139], a[56:59], a[16:19], v[136:139]
    v_cndmask_b32 v243, v243, v245, vcc
    ds_read_b128 a[64:67], v225 offset:1024
    v_mfma_f32_16x16x32_bf16 v[164:167], a[56:59], a[20:23], v[164:167]
    v_cmp_eq_u32 vcc, 3, v241
    s_nop 1
    v_mfma_f32_16x16x32_bf16 v[160:163], a[52:55], a[20:23], v[160:163]
    v_cndmask_b32 v243, v243, v246, vcc
    ds_read_b128 a[68:71], v225 offset:2048
    v_mfma_f32_16x16x32_bf16 v[156:159], a[48:51], a[20:23], v[156:159]
    v_mul_f32 v243, 0x3a800000, v243
    v_mfma_f32_16x16x32_bf16 v[152:155], a[44:47], a[20:23], v[152:155]
    v_max_f32 v243, 0, v243
    ds_read_b128 a[72:75], v225 offset:3072
    buffer_load_dwordx4 v233, s[12:15], s31 offen offset:1024  lds
    v_mfma_f32_16x16x32_bf16 v[148:151], a[40:43], a[20:23], v[148:151]
    v_cvt_pk_bf16_f32 v243, v243, v243
    v_lshlrev_b32 v243, 16, v243
    v_mfma_f32_16x16x32_bf16 v[144:147], a[36:39], a[20:23], v[144:147]
    v_add_f32 v243, 0x3727c5ac, v243
    v_mfma_f32_16x16x32_bf16 v[140:143], a[32:35], a[20:23], v[140:143]
    v_cvt_pk_bf16_f32 v243, v243, v243
    ds_read_b128 a[76:79], v225 offset:4096
    v_mfma_f32_16x16x32_bf16 v[168:171], a[32:35], a[24:27], v[168:171]
    v_lshlrev_b32 v243, 16, v243
    v_mfma_f32_16x16x32_bf16 v[172:175], a[36:39], a[24:27], v[172:175]
    v_sqrt_f32 v243, v243
    v_lshrrev_b32 v242, 2, v238
    ds_read_b128 a[80:83], v225 offset:5120
    v_mfma_f32_16x16x32_bf16 v[176:179], a[40:43], a[24:27], v[176:179]
    v_cvt_pk_bf16_f32 v243, v243, v243
    v_mfma_f32_16x16x32_bf16 v[180:183], a[44:47], a[24:27], v[180:183]
    v_lshlrev_b32 v243, 16, v243
    ds_read_b128 a[84:87], v225 offset:6144
    buffer_load_dwordx4 v233, s[12:15], s31 offen offset:2048  lds
    v_mfma_f32_16x16x32_bf16 v[184:187], a[48:51], a[24:27], v[184:187]
    v_rcp_f32 v250, v243
    v_mfma_f32_16x16x32_bf16 v[188:191], a[52:55], a[24:27], v[188:191]
    v_mul_f32 v252, v243, v243
    v_mul_f32 v250, 0xbfb8aa3b, v250
    v_mfma_f32_16x16x32_bf16 v[192:195], a[56:59], a[24:27], v[192:195]
    v_mov_b32 v253, v252
    ds_read_b128 a[88:91], v225 offset:7168
    v_mfma_f32_16x16x32_bf16 v[220:223], a[56:59], a[28:31], v[220:223]
    v_mov_b32 v251, v250
    v_mfma_f32_16x16x32_bf16 v[216:219], a[52:55], a[28:31], v[216:219]
    v_lshl_add_u32 v242, v241, 4, v242
    v_mfma_f32_16x16x32_bf16 v[212:215], a[48:51], a[28:31], v[212:215]
    s_lshl_b32 s35, s28, 10
    s_add_u32 s35, s35, 153680
    v_mfma_f32_16x16x32_bf16 v[208:211], a[44:47], a[28:31], v[208:211]
    v_lshlrev_b32 v242, 4, v242
    buffer_load_dwordx4 v233, s[12:15], s31 offen offset:3072  lds
    v_mfma_f32_16x16x32_bf16 v[204:207], a[40:43], a[28:31], v[204:207]
    v_add_u32 v242, s35, v242
    v_mfma_f32_16x16x32_bf16 v[200:203], a[36:39], a[28:31], v[200:203]
    ds_write_b128 v242, v[250:253]
    v_mfma_f32_16x16x32_bf16 v[196:199], a[32:35], a[28:31], v[196:199]
    s_waitcnt vmcnt(16) lgkmcnt(0)
    s_barrier
    v_mfma_f32_16x16x32_bf16 v[0:3], a[92:95], a[60:63], v[0:3]
    ds_read_b128 a[0:3], v225 offset:30736
    v_mfma_f32_16x16x32_bf16 v[4:7], a[96:99], a[60:63], v[4:7]
    ds_read_b64_tr_b16 a[32:33], v228 offset:30736
    v_mfma_f32_16x16x32_bf16 v[8:11], a[100:103], a[60:63], v[8:11]
    s_add_u32 m0, s37, 30736
    v_readlane_b32 s31, v255, 11
    s_nop 1
    s_mul_i32 s32, s31, 229376
    s_lshl_b32 s31, s31, 14
    v_mfma_f32_16x16x32_bf16 v[12:15], a[104:107], a[60:63], v[12:15]
    buffer_load_dwordx4 v234, s[16:19], s32 offen offset:0 lds
    v_mfma_f32_16x16x32_bf16 v[16:19], a[108:111], a[60:63], v[16:19]
    v_mfma_f32_16x16x32_bf16 v[20:23], a[112:115], a[60:63], v[20:23]
    ds_read_b64_tr_b16 a[34:35], v228 offset:34320
    v_mfma_f32_16x16x32_bf16 v[24:27], a[116:119], a[60:63], v[24:27]
    ds_read_b64_tr_b16 a[36:37], v228 offset:30768
    v_mfma_f32_16x16x32_bf16 v[52:55], a[116:119], a[64:67], v[52:55]
    v_mfma_f32_16x16x32_bf16 v[48:51], a[112:115], a[64:67], v[48:51]
    ds_read_b64_tr_b16 a[38:39], v228 offset:34352
    v_mfma_f32_16x16x32_bf16 v[44:47], a[108:111], a[64:67], v[44:47]
    v_mfma_f32_16x16x32_bf16 v[40:43], a[104:107], a[64:67], v[40:43]
    buffer_load_dwordx4 v235, s[16:19], s32 offen offset:1024 lds
    v_mfma_f32_16x16x32_bf16 v[36:39], a[100:103], a[64:67], v[36:39]
    v_mfma_f32_16x16x32_bf16 v[32:35], a[96:99], a[64:67], v[32:35]
    ds_read_b64_tr_b16 a[40:41], v228 offset:30800
    v_mfma_f32_16x16x32_bf16 v[28:31], a[92:95], a[64:67], v[28:31]
    ds_read_b64_tr_b16 a[42:43], v228 offset:34384
    v_mfma_f32_16x16x32_bf16 v[56:59], a[92:95], a[68:71], v[56:59]
    v_mfma_f32_16x16x32_bf16 v[60:63], a[96:99], a[68:71], v[60:63]
    ds_read_b64_tr_b16 a[44:45], v228 offset:37920
    v_mfma_f32_16x16x32_bf16 v[64:67], a[100:103], a[68:71], v[64:67]
    v_mfma_f32_16x16x32_bf16 v[68:71], a[104:107], a[68:71], v[68:71]
    buffer_load_dwordx4 v236, s[16:19], s32 offen offset:2048 lds
    v_mfma_f32_16x16x32_bf16 v[72:75], a[108:111], a[68:71], v[72:75]
    v_mfma_f32_16x16x32_bf16 v[76:79], a[112:115], a[68:71], v[76:79]
    ds_read_b64_tr_b16 a[46:47], v228 offset:41504
    v_mfma_f32_16x16x32_bf16 v[80:83], a[116:119], a[68:71], v[80:83]
    ds_read_b64_tr_b16 a[48:49], v228 offset:37952
    v_mfma_f32_16x16x32_bf16 v[108:111], a[116:119], a[72:75], v[108:111]
    v_mfma_f32_16x16x32_bf16 v[104:107], a[112:115], a[72:75], v[104:107]
    ds_read_b64_tr_b16 a[50:51], v228 offset:41536
    v_mfma_f32_16x16x32_bf16 v[100:103], a[108:111], a[72:75], v[100:103]
    v_mfma_f32_16x16x32_bf16 v[96:99], a[104:107], a[72:75], v[96:99]
    s_mov_b64 exec, s[38:39]
    buffer_load_dwordx4 v237, s[16:19], s32 offen offset:3072 lds
    s_mov_b64 exec, -1
    v_mfma_f32_16x16x32_bf16 v[92:95], a[100:103], a[72:75], v[92:95]
    v_mfma_f32_16x16x32_bf16 v[88:91], a[96:99], a[72:75], v[88:91]
    ds_read_b64_tr_b16 a[52:53], v228 offset:37984
    v_mfma_f32_16x16x32_bf16 v[84:87], a[92:95], a[72:75], v[84:87]
    ds_read_b64_tr_b16 a[54:55], v228 offset:41568
    v_mfma_f32_16x16x32_bf16 v[112:115], a[92:95], a[76:79], v[112:115]
    v_mfma_f32_16x16x32_bf16 v[116:119], a[96:99], a[76:79], v[116:119]
    ds_read_b64_tr_b16 a[56:57], v231 offset:30736
    v_mfma_f32_16x16x32_bf16 v[120:123], a[100:103], a[76:79], v[120:123]
    s_add_u32 m0, s36, 30736
    v_mfma_f32_16x16x32_bf16 v[124:127], a[104:107], a[76:79], v[124:127]
    buffer_load_dwordx4 v233, s[12:15], s31 offen offset:0  lds
    v_mfma_f32_16x16x32_bf16 v[128:131], a[108:111], a[76:79], v[128:131]
    v_mfma_f32_16x16x32_bf16 v[132:135], a[112:115], a[76:79], v[132:135]
    ds_read_b64_tr_b16 a[58:59], v231 offset:34320
    v_mfma_f32_16x16x32_bf16 v[136:139], a[116:119], a[76:79], v[136:139]
    ds_read_b128 a[4:7], v225 offset:31760
    v_mfma_f32_16x16x32_bf16 v[164:167], a[116:119], a[80:83], v[164:167]
    ds_read_b128 a[8:11], v225 offset:32784
    v_mfma_f32_16x16x32_bf16 v[160:163], a[112:115], a[80:83], v[160:163]
    v_mfma_f32_16x16x32_bf16 v[156:159], a[108:111], a[80:83], v[156:159]
    v_mfma_f32_16x16x32_bf16 v[152:155], a[104:107], a[80:83], v[152:155]
    buffer_load_dwordx4 v233, s[12:15], s31 offen offset:1024  lds
    v_mfma_f32_16x16x32_bf16 v[148:151], a[100:103], a[80:83], v[148:151]
    v_mfma_f32_16x16x32_bf16 v[144:147], a[96:99], a[80:83], v[144:147]
    ds_read_b128 a[12:15], v225 offset:33808
    v_mfma_f32_16x16x32_bf16 v[140:143], a[92:95], a[80:83], v[140:143]
    ds_read_b128 a[16:19], v225 offset:34832
    v_mfma_f32_16x16x32_bf16 v[168:171], a[92:95], a[84:87], v[168:171]
    ds_read_b128 a[20:23], v225 offset:35856
    v_mfma_f32_16x16x32_bf16 v[172:175], a[96:99], a[84:87], v[172:175]
    v_mfma_f32_16x16x32_bf16 v[176:179], a[100:103], a[84:87], v[176:179]
    v_mfma_f32_16x16x32_bf16 v[180:183], a[104:107], a[84:87], v[180:183]
    buffer_load_dwordx4 v233, s[12:15], s31 offen offset:2048  lds
    v_mfma_f32_16x16x32_bf16 v[184:187], a[108:111], a[84:87], v[184:187]
    v_mfma_f32_16x16x32_bf16 v[188:191], a[112:115], a[84:87], v[188:191]
    ds_read_b128 a[24:27], v225 offset:36880
    v_mfma_f32_16x16x32_bf16 v[192:195], a[116:119], a[84:87], v[192:195]
    ds_read_b128 a[28:31], v225 offset:37904
    v_mfma_f32_16x16x32_bf16 v[220:223], a[116:119], a[88:91], v[220:223]
    v_mfma_f32_16x16x32_bf16 v[216:219], a[112:115], a[88:91], v[216:219]
    v_mfma_f32_16x16x32_bf16 v[212:215], a[108:111], a[88:91], v[212:215]
    v_mfma_f32_16x16x32_bf16 v[208:211], a[104:107], a[88:91], v[208:211]
    buffer_load_dwordx4 v233, s[12:15], s31 offen offset:3072  lds
    v_mfma_f32_16x16x32_bf16 v[204:207], a[100:103], a[88:91], v[204:207]
    v_mfma_f32_16x16x32_bf16 v[200:203], a[96:99], a[88:91], v[200:203]
    v_mfma_f32_16x16x32_bf16 v[196:199], a[92:95], a[88:91], v[196:199]
    s_waitcnt vmcnt(16) lgkmcnt(0)
    s_barrier
    v_mfma_f32_16x16x32_bf16 v[0:3], a[32:35], a[0:3], v[0:3]
    ds_read_b128 a[60:63], v226 offset:0
    v_mfma_f32_16x16x32_bf16 v[4:7], a[36:39], a[0:3], v[4:7]
    ds_read_b64_tr_b16 a[92:93], v229 offset:0
    v_mfma_f32_16x16x32_bf16 v[8:11], a[40:43], a[0:3], v[8:11]
    s_add_u32 m0, s37, 61472
    v_readlane_b32 s31, v255, 12
    s_nop 1
    s_mul_i32 s32, s31, 229376
    s_lshl_b32 s31, s31, 14
    v_mfma_f32_16x16x32_bf16 v[12:15], a[44:47], a[0:3], v[12:15]
    buffer_load_dwordx4 v234, s[16:19], s32 offen offset:0 lds
    v_mfma_f32_16x16x32_bf16 v[16:19], a[48:51], a[0:3], v[16:19]
    v_mfma_f32_16x16x32_bf16 v[20:23], a[52:55], a[0:3], v[20:23]
    ds_read_b64_tr_b16 a[94:95], v229 offset:3584
    v_mfma_f32_16x16x32_bf16 v[24:27], a[56:59], a[0:3], v[24:27]
    ds_read_b64_tr_b16 a[96:97], v229 offset:32
    v_mfma_f32_16x16x32_bf16 v[52:55], a[56:59], a[4:7], v[52:55]
    v_mfma_f32_16x16x32_bf16 v[48:51], a[52:55], a[4:7], v[48:51]
    ds_read_b64_tr_b16 a[98:99], v229 offset:3616
    v_mfma_f32_16x16x32_bf16 v[44:47], a[48:51], a[4:7], v[44:47]
    v_mfma_f32_16x16x32_bf16 v[40:43], a[44:47], a[4:7], v[40:43]
    buffer_load_dwordx4 v235, s[16:19], s32 offen offset:1024 lds
    v_mfma_f32_16x16x32_bf16 v[36:39], a[40:43], a[4:7], v[36:39]
    v_mfma_f32_16x16x32_bf16 v[32:35], a[36:39], a[4:7], v[32:35]
    ds_read_b64_tr_b16 a[100:101], v229 offset:64
    v_mfma_f32_16x16x32_bf16 v[28:31], a[32:35], a[4:7], v[28:31]
    ds_read_b64_tr_b16 a[102:103], v229 offset:3648
    v_mfma_f32_16x16x32_bf16 v[56:59], a[32:35], a[8:11], v[56:59]
    v_mfma_f32_16x16x32_bf16 v[60:63], a[36:39], a[8:11], v[60:63]
    ds_read_b64_tr_b16 a[104:105], v229 offset:7184
    v_mfma_f32_16x16x32_bf16 v[64:67], a[40:43], a[8:11], v[64:67]
    v_mfma_f32_16x16x32_bf16 v[68:71], a[44:47], a[8:11], v[68:71]
    buffer_load_dwordx4 v236, s[16:19], s32 offen offset:2048 lds
    v_mfma_f32_16x16x32_bf16 v[72:75], a[48:51], a[8:11], v[72:75]
    v_mfma_f32_16x16x32_bf16 v[76:79], a[52:55], a[8:11], v[76:79]
    ds_read_b64_tr_b16 a[106:107], v229 offset:10768
    v_mfma_f32_16x16x32_bf16 v[80:83], a[56:59], a[8:11], v[80:83]
    ds_read_b64_tr_b16 a[108:109], v229 offset:7216
    v_mfma_f32_16x16x32_bf16 v[108:111], a[56:59], a[12:15], v[108:111]
    v_mfma_f32_16x16x32_bf16 v[104:107], a[52:55], a[12:15], v[104:107]
    ds_read_b64_tr_b16 a[110:111], v229 offset:10800
    v_mfma_f32_16x16x32_bf16 v[100:103], a[48:51], a[12:15], v[100:103]
    v_mfma_f32_16x16x32_bf16 v[96:99], a[44:47], a[12:15], v[96:99]
    s_mov_b64 exec, s[38:39]
    buffer_load_dwordx4 v237, s[16:19], s32 offen offset:3072 lds
    s_mov_b64 exec, -1
    v_mfma_f32_16x16x32_bf16 v[92:95], a[40:43], a[12:15], v[92:95]
    v_mfma_f32_16x16x32_bf16 v[88:91], a[36:39], a[12:15], v[88:91]
    ds_read_b64_tr_b16 a[112:113], v229 offset:7248
    v_mfma_f32_16x16x32_bf16 v[84:87], a[32:35], a[12:15], v[84:87]
    ds_read_b64_tr_b16 a[114:115], v229 offset:10832
    v_mfma_f32_16x16x32_bf16 v[112:115], a[32:35], a[16:19], v[112:115]
    v_mfma_f32_16x16x32_bf16 v[116:119], a[36:39], a[16:19], v[116:119]
    ds_read_b64_tr_b16 a[116:117], v232 offset:0
    v_mfma_f32_16x16x32_bf16 v[120:123], a[40:43], a[16:19], v[120:123]
    s_add_u32 m0, s36, 61472
    v_mfma_f32_16x16x32_bf16 v[124:127], a[44:47], a[16:19], v[124:127]
    buffer_load_dwordx4 v233, s[12:15], s31 offen offset:0  lds
    v_mfma_f32_16x16x32_bf16 v[128:131], a[48:51], a[16:19], v[128:131]
    v_mfma_f32_16x16x32_bf16 v[132:135], a[52:55], a[16:19], v[132:135]
    ds_read_b64_tr_b16 a[118:119], v232 offset:3584
    v_mfma_f32_16x16x32_bf16 v[136:139], a[56:59], a[16:19], v[136:139]
    ds_read_b128 a[64:67], v226 offset:1024
    v_mfma_f32_16x16x32_bf16 v[164:167], a[56:59], a[20:23], v[164:167]
    ds_read_b128 a[68:71], v226 offset:2048
    v_mfma_f32_16x16x32_bf16 v[160:163], a[52:55], a[20:23], v[160:163]
    v_mfma_f32_16x16x32_bf16 v[156:159], a[48:51], a[20:23], v[156:159]
    v_mfma_f32_16x16x32_bf16 v[152:155], a[44:47], a[20:23], v[152:155]
    buffer_load_dwordx4 v233, s[12:15], s31 offen offset:1024  lds
    v_mfma_f32_16x16x32_bf16 v[148:151], a[40:43], a[20:23], v[148:151]
    v_mfma_f32_16x16x32_bf16 v[144:147], a[36:39], a[20:23], v[144:147]
    ds_read_b128 a[72:75], v226 offset:3072
    v_mfma_f32_16x16x32_bf16 v[140:143], a[32:35], a[20:23], v[140:143]
    ds_read_b128 a[76:79], v226 offset:4096
    v_mfma_f32_16x16x32_bf16 v[168:171], a[32:35], a[24:27], v[168:171]
    ds_read_b128 a[80:83], v226 offset:5120
    v_mfma_f32_16x16x32_bf16 v[172:175], a[36:39], a[24:27], v[172:175]
    v_mfma_f32_16x16x32_bf16 v[176:179], a[40:43], a[24:27], v[176:179]
    v_mfma_f32_16x16x32_bf16 v[180:183], a[44:47], a[24:27], v[180:183]
    buffer_load_dwordx4 v233, s[12:15], s31 offen offset:2048  lds
    v_mfma_f32_16x16x32_bf16 v[184:187], a[48:51], a[24:27], v[184:187]
    v_mfma_f32_16x16x32_bf16 v[188:191], a[52:55], a[24:27], v[188:191]
    ds_read_b128 a[84:87], v226 offset:6144
    v_mfma_f32_16x16x32_bf16 v[192:195], a[56:59], a[24:27], v[192:195]
    ds_read_b128 a[88:91], v226 offset:7168
    v_mfma_f32_16x16x32_bf16 v[220:223], a[56:59], a[28:31], v[220:223]
    v_mfma_f32_16x16x32_bf16 v[216:219], a[52:55], a[28:31], v[216:219]
    v_mfma_f32_16x16x32_bf16 v[212:215], a[48:51], a[28:31], v[212:215]
    v_mfma_f32_16x16x32_bf16 v[208:211], a[44:47], a[28:31], v[208:211]
    buffer_load_dwordx4 v233, s[12:15], s31 offen offset:3072  lds
    v_mfma_f32_16x16x32_bf16 v[204:207], a[40:43], a[28:31], v[204:207]
    v_mfma_f32_16x16x32_bf16 v[200:203], a[36:39], a[28:31], v[200:203]
    v_mfma_f32_16x16x32_bf16 v[196:199], a[32:35], a[28:31], v[196:199]
    s_waitcnt vmcnt(16) lgkmcnt(0)
    s_barrier
    v_mfma_f32_16x16x32_bf16 v[0:3], a[92:95], a[60:63], v[0:3]
    ds_read_b128 a[0:3], v224 offset:0
    v_mfma_f32_16x16x32_bf16 v[4:7], a[96:99], a[60:63], v[4:7]
    ds_read_b64_tr_b16 a[32:33], v227 offset:0
    v_mfma_f32_16x16x32_bf16 v[8:11], a[100:103], a[60:63], v[8:11]
    s_add_u32 m0, s37, 92208
    v_readlane_b32 s31, v255, 13
    s_nop 1
    s_mul_i32 s32, s31, 229376
    s_lshl_b32 s31, s31, 14
    v_mfma_f32_16x16x32_bf16 v[12:15], a[104:107], a[60:63], v[12:15]
    buffer_load_dwordx4 v234, s[16:19], s32 offen offset:0 lds
    v_mfma_f32_16x16x32_bf16 v[16:19], a[108:111], a[60:63], v[16:19]
    v_mfma_f32_16x16x32_bf16 v[20:23], a[112:115], a[60:63], v[20:23]
    ds_read_b64_tr_b16 a[34:35], v227 offset:3584
    v_mfma_f32_16x16x32_bf16 v[24:27], a[116:119], a[60:63], v[24:27]
    ds_read_b64_tr_b16 a[36:37], v227 offset:32
    v_mfma_f32_16x16x32_bf16 v[52:55], a[116:119], a[64:67], v[52:55]
    v_mfma_f32_16x16x32_bf16 v[48:51], a[112:115], a[64:67], v[48:51]
    ds_read_b64_tr_b16 a[38:39], v227 offset:3616
    v_mfma_f32_16x16x32_bf16 v[44:47], a[108:111], a[64:67], v[44:47]
    v_mfma_f32_16x16x32_bf16 v[40:43], a[104:107], a[64:67], v[40:43]
    buffer_load_dwordx4 v235, s[16:19], s32 offen offset:1024 lds
    v_mfma_f32_16x16x32_bf16 v[36:39], a[100:103], a[64:67], v[36:39]
    v_mfma_f32_16x16x32_bf16 v[32:35], a[96:99], a[64:67], v[32:35]
    ds_read_b64_tr_b16 a[40:41], v227 offset:64
    v_mfma_f32_16x16x32_bf16 v[28:31], a[92:95], a[64:67], v[28:31]
    ds_read_b64_tr_b16 a[42:43], v227 offset:3648
    v_mfma_f32_16x16x32_bf16 v[56:59], a[92:95], a[68:71], v[56:59]
    v_mfma_f32_16x16x32_bf16 v[60:63], a[96:99], a[68:71], v[60:63]
    ds_read_b64_tr_b16 a[44:45], v227 offset:7184
    v_mfma_f32_16x16x32_bf16 v[64:67], a[100:103], a[68:71], v[64:67]
    v_mfma_f32_16x16x32_bf16 v[68:71], a[104:107], a[68:71], v[68:71]
    buffer_load_dwordx4 v236, s[16:19], s32 offen offset:2048 lds
    v_mfma_f32_16x16x32_bf16 v[72:75], a[108:111], a[68:71], v[72:75]
    v_mfma_f32_16x16x32_bf16 v[76:79], a[112:115], a[68:71], v[76:79]
    ds_read_b64_tr_b16 a[46:47], v227 offset:10768
    v_mfma_f32_16x16x32_bf16 v[80:83], a[116:119], a[68:71], v[80:83]
    ds_read_b64_tr_b16 a[48:49], v227 offset:7216
    v_mfma_f32_16x16x32_bf16 v[108:111], a[116:119], a[72:75], v[108:111]
    v_mfma_f32_16x16x32_bf16 v[104:107], a[112:115], a[72:75], v[104:107]
    ds_read_b64_tr_b16 a[50:51], v227 offset:10800
    v_mfma_f32_16x16x32_bf16 v[100:103], a[108:111], a[72:75], v[100:103]
    v_mfma_f32_16x16x32_bf16 v[96:99], a[104:107], a[72:75], v[96:99]
    s_mov_b64 exec, s[38:39]
    buffer_load_dwordx4 v237, s[16:19], s32 offen offset:3072 lds
    s_mov_b64 exec, -1
    v_mfma_f32_16x16x32_bf16 v[92:95], a[100:103], a[72:75], v[92:95]
    v_mfma_f32_16x16x32_bf16 v[88:91], a[96:99], a[72:75], v[88:91]
    ds_read_b64_tr_b16 a[52:53], v227 offset:7248
    v_mfma_f32_16x16x32_bf16 v[84:87], a[92:95], a[72:75], v[84:87]
    ds_read_b64_tr_b16 a[54:55], v227 offset:10832
    v_mfma_f32_16x16x32_bf16 v[112:115], a[92:95], a[76:79], v[112:115]
    v_mfma_f32_16x16x32_bf16 v[116:119], a[96:99], a[76:79], v[116:119]
    ds_read_b64_tr_b16 a[56:57], v230 offset:0
    v_mfma_f32_16x16x32_bf16 v[120:123], a[100:103], a[76:79], v[120:123]
    s_add_u32 m0, s36, 92208
    v_mfma_f32_16x16x32_bf16 v[124:127], a[104:107], a[76:79], v[124:127]
    buffer_load_dwordx4 v233, s[12:15], s31 offen offset:0  lds
    v_mfma_f32_16x16x32_bf16 v[128:131], a[108:111], a[76:79], v[128:131]
    v_mfma_f32_16x16x32_bf16 v[132:135], a[112:115], a[76:79], v[132:135]
    ds_read_b64_tr_b16 a[58:59], v230 offset:3584
    v_mfma_f32_16x16x32_bf16 v[136:139], a[116:119], a[76:79], v[136:139]
    ds_read_b128 a[4:7], v224 offset:1024
    v_mfma_f32_16x16x32_bf16 v[164:167], a[116:119], a[80:83], v[164:167]
    ds_read_b128 a[8:11], v224 offset:2048
    v_mfma_f32_16x16x32_bf16 v[160:163], a[112:115], a[80:83], v[160:163]
    v_mfma_f32_16x16x32_bf16 v[156:159], a[108:111], a[80:83], v[156:159]
    v_mfma_f32_16x16x32_bf16 v[152:155], a[104:107], a[80:83], v[152:155]
    buffer_load_dwordx4 v233, s[12:15], s31 offen offset:1024  lds
    v_mfma_f32_16x16x32_bf16 v[148:151], a[100:103], a[80:83], v[148:151]
    v_mfma_f32_16x16x32_bf16 v[144:147], a[96:99], a[80:83], v[144:147]
    ds_read_b128 a[12:15], v224 offset:3072
    v_mfma_f32_16x16x32_bf16 v[140:143], a[92:95], a[80:83], v[140:143]
    ds_read_b128 a[16:19], v224 offset:4096
    v_mfma_f32_16x16x32_bf16 v[168:171], a[92:95], a[84:87], v[168:171]
    ds_read_b128 a[20:23], v224 offset:5120
    v_mfma_f32_16x16x32_bf16 v[172:175], a[96:99], a[84:87], v[172:175]
    v_mfma_f32_16x16x32_bf16 v[176:179], a[100:103], a[84:87], v[176:179]
    v_mfma_f32_16x16x32_bf16 v[180:183], a[104:107], a[84:87], v[180:183]
    buffer_load_dwordx4 v233, s[12:15], s31 offen offset:2048  lds
    v_mfma_f32_16x16x32_bf16 v[184:187], a[108:111], a[84:87], v[184:187]
    v_mfma_f32_16x16x32_bf16 v[188:191], a[112:115], a[84:87], v[188:191]
    ds_read_b128 a[24:27], v224 offset:6144
    v_mfma_f32_16x16x32_bf16 v[192:195], a[116:119], a[84:87], v[192:195]
    ds_read_b128 a[28:31], v224 offset:7168
    v_mfma_f32_16x16x32_bf16 v[220:223], a[116:119], a[88:91], v[220:223]
    v_mfma_f32_16x16x32_bf16 v[216:219], a[112:115], a[88:91], v[216:219]
    v_mfma_f32_16x16x32_bf16 v[212:215], a[108:111], a[88:91], v[212:215]
    v_mfma_f32_16x16x32_bf16 v[208:211], a[104:107], a[88:91], v[208:211]
    buffer_load_dwordx4 v233, s[12:15], s31 offen offset:3072  lds
    v_mfma_f32_16x16x32_bf16 v[204:207], a[100:103], a[88:91], v[204:207]
    v_mfma_f32_16x16x32_bf16 v[200:203], a[96:99], a[88:91], v[200:203]
    v_mfma_f32_16x16x32_bf16 v[196:199], a[92:95], a[88:91], v[196:199]
    s_waitcnt vmcnt(16) lgkmcnt(0)
    s_barrier
    v_mfma_f32_16x16x32_bf16 v[0:3], a[32:35], a[0:3], v[0:3]
    ds_read_b128 a[60:63], v224 offset:30736
    v_mfma_f32_16x16x32_bf16 v[4:7], a[36:39], a[0:3], v[4:7]
    ds_read_b64_tr_b16 a[92:93], v227 offset:30736
    v_mfma_f32_16x16x32_bf16 v[8:11], a[40:43], a[0:3], v[8:11]
    s_add_u32 m0, s37, 122944
    v_readlane_b32 s31, v255, 14
    s_nop 1
    s_mul_i32 s32, s31, 229376
    s_lshl_b32 s31, s31, 14
    v_mfma_f32_16x16x32_bf16 v[12:15], a[44:47], a[0:3], v[12:15]
    buffer_load_dwordx4 v234, s[16:19], s32 offen offset:0 lds
    v_mfma_f32_16x16x32_bf16 v[16:19], a[48:51], a[0:3], v[16:19]
    v_mfma_f32_16x16x32_bf16 v[20:23], a[52:55], a[0:3], v[20:23]
    ds_read_b64_tr_b16 a[94:95], v227 offset:34320
    v_mfma_f32_16x16x32_bf16 v[24:27], a[56:59], a[0:3], v[24:27]
    ds_read_b64_tr_b16 a[96:97], v227 offset:30768
    v_mfma_f32_16x16x32_bf16 v[52:55], a[56:59], a[4:7], v[52:55]
    ds_read_b64_tr_b16 a[98:99], v227 offset:34352
    v_mfma_f32_16x16x32_bf16 v[48:51], a[52:55], a[4:7], v[48:51]
    v_mfma_f32_16x16x32_bf16 v[44:47], a[48:51], a[4:7], v[44:47]
    buffer_load_dwordx4 v235, s[16:19], s32 offen offset:1024 lds
    v_mfma_f32_16x16x32_bf16 v[40:43], a[44:47], a[4:7], v[40:43]
    v_mfma_f32_16x16x32_bf16 v[36:39], a[40:43], a[4:7], v[36:39]
    ds_read_b64_tr_b16 a[100:101], v227 offset:30800
    v_mfma_f32_16x16x32_bf16 v[32:35], a[36:39], a[4:7], v[32:35]
    v_mfma_f32_16x16x32_bf16 v[28:31], a[32:35], a[4:7], v[28:31]
    ds_read_b64_tr_b16 a[102:103], v227 offset:34384
    v_mfma_f32_16x16x32_bf16 v[56:59], a[32:35], a[8:11], v[56:59]
    v_mfma_f32_16x16x32_bf16 v[60:63], a[36:39], a[8:11], v[60:63]
    buffer_load_dwordx4 v236, s[16:19], s32 offen offset:2048 lds
    v_mfma_f32_16x16x32_bf16 v[64:67], a[40:43], a[8:11], v[64:67]
    v_mfma_f32_16x16x32_bf16 v[68:71], a[44:47], a[8:11], v[68:71]
    ds_read_b64_tr_b16 a[104:105], v227 offset:37920
    v_mfma_f32_16x16x32_bf16 v[72:75], a[48:51], a[8:11], v[72:75]
    ds_read_b64_tr_b16 a[106:107], v227 offset:41504
    v_mfma_f32_16x16x32_bf16 v[76:79], a[52:55], a[8:11], v[76:79]
    ds_read_b64_tr_b16 a[108:109], v227 offset:37952
    v_mfma_f32_16x16x32_bf16 v[80:83], a[56:59], a[8:11], v[80:83]
    v_mfma_f32_16x16x32_bf16 v[108:111], a[56:59], a[12:15], v[108:111]
    s_mov_b64 exec, s[38:39]
    buffer_load_dwordx4 v237, s[16:19], s32 offen offset:3072 lds
    s_mov_b64 exec, -1
    v_mfma_f32_16x16x32_bf16 v[104:107], a[52:55], a[12:15], v[104:107]
    v_mfma_f32_16x16x32_bf16 v[100:103], a[48:51], a[12:15], v[100:103]
    ds_read_b64_tr_b16 a[110:111], v227 offset:41536
    v_mfma_f32_16x16x32_bf16 v[96:99], a[44:47], a[12:15], v[96:99]
    v_mfma_f32_16x16x32_bf16 v[92:95], a[40:43], a[12:15], v[92:95]
    ds_read_b64_tr_b16 a[112:113], v227 offset:37984
    v_mfma_f32_16x16x32_bf16 v[88:91], a[36:39], a[12:15], v[88:91]
    ds_read_b64_tr_b16 a[114:115], v227 offset:41568
    v_mfma_f32_16x16x32_bf16 v[84:87], a[32:35], a[12:15], v[84:87]
    s_add_u32 m0, s36, 122944
    v_mfma_f32_16x16x32_bf16 v[112:115], a[32:35], a[16:19], v[112:115]
    buffer_load_dwordx4 v233, s[12:15], s31 offen offset:0  lds
    v_mfma_f32_16x16x32_bf16 v[116:119], a[36:39], a[16:19], v[116:119]
    v_mfma_f32_16x16x32_bf16 v[120:123], a[40:43], a[16:19], v[120:123]
    ds_read_b64_tr_b16 a[116:117], v230 offset:30736
    v_mfma_f32_16x16x32_bf16 v[124:127], a[44:47], a[16:19], v[124:127]
    ds_read_b64_tr_b16 a[118:119], v230 offset:34320
    v_mfma_f32_16x16x32_bf16 v[128:131], a[48:51], a[16:19], v[128:131]
    ds_read_b128 a[64:67], v224 offset:31760
    v_mfma_f32_16x16x32_bf16 v[132:135], a[52:55], a[16:19], v[132:135]
    v_mfma_f32_16x16x32_bf16 v[136:139], a[56:59], a[16:19], v[136:139]
    buffer_load_dwordx4 v233, s[12:15], s31 offen offset:1024  lds
    v_mfma_f32_16x16x32_bf16 v[164:167], a[56:59], a[20:23], v[164:167]
    v_mfma_f32_16x16x32_bf16 v[160:163], a[52:55], a[20:23], v[160:163]
    ds_read_b128 a[68:71], v224 offset:32784
    v_mfma_f32_16x16x32_bf16 v[156:159], a[48:51], a[20:23], v[156:159]
    v_mfma_f32_16x16x32_bf16 v[152:155], a[44:47], a[20:23], v[152:155]
    ds_read_b128 a[72:75], v224 offset:33808
    v_mfma_f32_16x16x32_bf16 v[148:151], a[40:43], a[20:23], v[148:151]
    v_mfma_f32_16x16x32_bf16 v[144:147], a[36:39], a[20:23], v[144:147]
    buffer_load_dwordx4 v233, s[12:15], s31 offen offset:2048  lds
    v_mfma_f32_16x16x32_bf16 v[140:143], a[32:35], a[20:23], v[140:143]
    v_mfma_f32_16x16x32_bf16 v[168:171], a[32:35], a[24:27], v[168:171]
    ds_read_b128 a[76:79], v224 offset:34832
    v_mfma_f32_16x16x32_bf16 v[172:175], a[36:39], a[24:27], v[172:175]
    ds_read_b128 a[80:83], v224 offset:35856
    v_mfma_f32_16x16x32_bf16 v[176:179], a[40:43], a[24:27], v[176:179]
    ds_read_b128 a[84:87], v224 offset:36880
    v_mfma_f32_16x16x32_bf16 v[180:183], a[44:47], a[24:27], v[180:183]
    v_mfma_f32_16x16x32_bf16 v[184:187], a[48:51], a[24:27], v[184:187]
    buffer_load_dwordx4 v233, s[12:15], s31 offen offset:3072  lds
    v_mfma_f32_16x16x32_bf16 v[188:191], a[52:55], a[24:27], v[188:191]
    v_mfma_f32_16x16x32_bf16 v[192:195], a[56:59], a[24:27], v[192:195]
    ds_read_b128 a[88:91], v224 offset:37904
    v_mfma_f32_16x16x32_bf16 v[220:223], a[56:59], a[28:31], v[220:223]
    v_mfma_f32_16x16x32_bf16 v[216:219], a[52:55], a[28:31], v[216:219]
    v_mfma_f32_16x16x32_bf16 v[212:215], a[48:51], a[28:31], v[212:215]
    v_mfma_f32_16x16x32_bf16 v[208:211], a[44:47], a[28:31], v[208:211]
    buffer_load_dword v247, v249, s[56:59], 0 offen
    v_mfma_f32_16x16x32_bf16 v[204:207], a[40:43], a[28:31], v[204:207]
    v_mfma_f32_16x16x32_bf16 v[200:203], a[36:39], a[28:31], v[200:203]
    v_mfma_f32_16x16x32_bf16 v[196:199], a[32:35], a[28:31], v[196:199]
    s_waitcnt vmcnt(17) lgkmcnt(0)
    s_barrier
    v_mfma_f32_16x16x32_bf16 v[0:3], a[92:95], a[60:63], v[0:3]
    ds_read_b128 a[0:3], v225 offset:0
    v_mfma_f32_16x16x32_bf16 v[4:7], a[96:99], a[60:63], v[4:7]
    ds_read_b64_tr_b16 a[32:33], v228 offset:0
    v_mfma_f32_16x16x32_bf16 v[8:11], a[100:103], a[60:63], v[8:11]
    s_add_u32 m0, s37, 0
    v_readlane_b32 s31, v255, 15
    s_nop 1
    s_mul_i32 s32, s31, 229376
    s_lshl_b32 s31, s31, 14
    v_mfma_f32_16x16x32_bf16 v[12:15], a[104:107], a[60:63], v[12:15]
    buffer_load_dwordx4 v234, s[16:19], s32 offen offset:0 lds
    v_mfma_f32_16x16x32_bf16 v[16:19], a[108:111], a[60:63], v[16:19]
    v_mfma_f32_16x16x32_bf16 v[20:23], a[112:115], a[60:63], v[20:23]
    ds_read_b64_tr_b16 a[34:35], v228 offset:3584
    v_mfma_f32_16x16x32_bf16 v[24:27], a[116:119], a[60:63], v[24:27]
    ds_read_b64_tr_b16 a[36:37], v228 offset:32
    v_mfma_f32_16x16x32_bf16 v[52:55], a[116:119], a[64:67], v[52:55]
    v_mfma_f32_16x16x32_bf16 v[48:51], a[112:115], a[64:67], v[48:51]
    ds_read_b64_tr_b16 a[38:39], v228 offset:3616
    v_mfma_f32_16x16x32_bf16 v[44:47], a[108:111], a[64:67], v[44:47]
    v_mfma_f32_16x16x32_bf16 v[40:43], a[104:107], a[64:67], v[40:43]
    buffer_load_dwordx4 v235, s[16:19], s32 offen offset:1024 lds
    v_mfma_f32_16x16x32_bf16 v[36:39], a[100:103], a[64:67], v[36:39]
    v_mfma_f32_16x16x32_bf16 v[32:35], a[96:99], a[64:67], v[32:35]
    ds_read_b64_tr_b16 a[40:41], v228 offset:64
    v_mfma_f32_16x16x32_bf16 v[28:31], a[92:95], a[64:67], v[28:31]
    ds_read_b64_tr_b16 a[42:43], v228 offset:3648
    v_mfma_f32_16x16x32_bf16 v[56:59], a[92:95], a[68:71], v[56:59]
    v_mfma_f32_16x16x32_bf16 v[60:63], a[96:99], a[68:71], v[60:63]
    ds_read_b64_tr_b16 a[44:45], v228 offset:7184
    v_mfma_f32_16x16x32_bf16 v[64:67], a[100:103], a[68:71], v[64:67]
    v_mfma_f32_16x16x32_bf16 v[68:71], a[104:107], a[68:71], v[68:71]
    buffer_load_dwordx4 v236, s[16:19], s32 offen offset:2048 lds
    v_mfma_f32_16x16x32_bf16 v[72:75], a[108:111], a[68:71], v[72:75]
    v_mfma_f32_16x16x32_bf16 v[76:79], a[112:115], a[68:71], v[76:79]
    ds_read_b64_tr_b16 a[46:47], v228 offset:10768
    v_mfma_f32_16x16x32_bf16 v[80:83], a[116:119], a[68:71], v[80:83]
    ds_read_b64_tr_b16 a[48:49], v228 offset:7216
    v_mfma_f32_16x16x32_bf16 v[108:111], a[116:119], a[72:75], v[108:111]
    v_mfma_f32_16x16x32_bf16 v[104:107], a[112:115], a[72:75], v[104:107]
    ds_read_b64_tr_b16 a[50:51], v228 offset:10800
    v_mfma_f32_16x16x32_bf16 v[100:103], a[108:111], a[72:75], v[100:103]
    v_mfma_f32_16x16x32_bf16 v[96:99], a[104:107], a[72:75], v[96:99]
    s_mov_b64 exec, s[38:39]
    buffer_load_dwordx4 v237, s[16:19], s32 offen offset:3072 lds
    s_mov_b64 exec, -1
    v_mfma_f32_16x16x32_bf16 v[92:95], a[100:103], a[72:75], v[92:95]
    v_mfma_f32_16x16x32_bf16 v[88:91], a[96:99], a[72:75], v[88:91]
    ds_read_b64_tr_b16 a[52:53], v228 offset:7248
    v_mfma_f32_16x16x32_bf16 v[84:87], a[92:95], a[72:75], v[84:87]
    ds_read_b64_tr_b16 a[54:55], v228 offset:10832
    v_mfma_f32_16x16x32_bf16 v[112:115], a[92:95], a[76:79], v[112:115]
    v_mfma_f32_16x16x32_bf16 v[116:119], a[96:99], a[76:79], v[116:119]
    ds_read_b64_tr_b16 a[56:57], v231 offset:0
    v_mfma_f32_16x16x32_bf16 v[120:123], a[100:103], a[76:79], v[120:123]
    s_add_u32 m0, s36, 0
    v_mfma_f32_16x16x32_bf16 v[124:127], a[104:107], a[76:79], v[124:127]
    buffer_load_dwordx4 v233, s[12:15], s31 offen offset:0  lds
    v_mfma_f32_16x16x32_bf16 v[128:131], a[108:111], a[76:79], v[128:131]
    v_mfma_f32_16x16x32_bf16 v[132:135], a[112:115], a[76:79], v[132:135]
    ds_read_b64_tr_b16 a[58:59], v231 offset:3584
    v_mfma_f32_16x16x32_bf16 v[136:139], a[116:119], a[76:79], v[136:139]
    ds_read_b128 a[4:7], v225 offset:1024
    v_mfma_f32_16x16x32_bf16 v[164:167], a[116:119], a[80:83], v[164:167]
    ds_read_b128 a[8:11], v225 offset:2048
    v_mfma_f32_16x16x32_bf16 v[160:163], a[112:115], a[80:83], v[160:163]
    v_mfma_f32_16x16x32_bf16 v[156:159], a[108:111], a[80:83], v[156:159]
    v_mfma_f32_16x16x32_bf16 v[152:155], a[104:107], a[80:83], v[152:155]
    buffer_load_dwordx4 v233, s[12:15], s31 offen offset:1024  lds
    v_mfma_f32_16x16x32_bf16 v[148:151], a[100:103], a[80:83], v[148:151]
    v_mfma_f32_16x16x32_bf16 v[144:147], a[96:99], a[80:83], v[144:147]
    ds_read_b128 a[12:15], v225 offset:3072
    v_mfma_f32_16x16x32_bf16 v[140:143], a[92:95], a[80:83], v[140:143]
    ds_read_b128 a[16:19], v225 offset:4096
    v_mfma_f32_16x16x32_bf16 v[168:171], a[92:95], a[84:87], v[168:171]
    ds_read_b128 a[20:23], v225 offset:5120
    v_mfma_f32_16x16x32_bf16 v[172:175], a[96:99], a[84:87], v[172:175]
    v_mfma_f32_16x16x32_bf16 v[176:179], a[100:103], a[84:87], v[176:179]
    v_mfma_f32_16x16x32_bf16 v[180:183], a[104:107], a[84:87], v[180:183]
    buffer_load_dwordx4 v233, s[12:15], s31 offen offset:2048  lds
    v_mfma_f32_16x16x32_bf16 v[184:187], a[108:111], a[84:87], v[184:187]
    v_mfma_f32_16x16x32_bf16 v[188:191], a[112:115], a[84:87], v[188:191]
    ds_read_b128 a[24:27], v225 offset:6144
    v_mfma_f32_16x16x32_bf16 v[192:195], a[116:119], a[84:87], v[192:195]
    ds_read_b128 a[28:31], v225 offset:7168
    v_mfma_f32_16x16x32_bf16 v[220:223], a[116:119], a[88:91], v[220:223]
    v_mfma_f32_16x16x32_bf16 v[216:219], a[112:115], a[88:91], v[216:219]
    v_mfma_f32_16x16x32_bf16 v[212:215], a[108:111], a[88:91], v[212:215]
    v_mfma_f32_16x16x32_bf16 v[208:211], a[104:107], a[88:91], v[208:211]
    buffer_load_dwordx4 v233, s[12:15], s31 offen offset:3072  lds
    v_mfma_f32_16x16x32_bf16 v[204:207], a[100:103], a[88:91], v[204:207]
    v_mfma_f32_16x16x32_bf16 v[200:203], a[96:99], a[88:91], v[200:203]
    v_mfma_f32_16x16x32_bf16 v[196:199], a[92:95], a[88:91], v[196:199]
    s_waitcnt vmcnt(17) lgkmcnt(0)
    s_barrier
    v_mfma_f32_16x16x32_bf16 v[0:3], a[32:35], a[0:3], v[0:3]
    ds_read_b128 a[60:63], v225 offset:30736
    v_mfma_f32_16x16x32_bf16 v[4:7], a[36:39], a[0:3], v[4:7]
    ds_read_b64_tr_b16 a[92:93], v228 offset:30736
    v_mfma_f32_16x16x32_bf16 v[8:11], a[40:43], a[0:3], v[8:11]
    s_add_u32 m0, s37, 30736
    v_readlane_b32 s31, v255, 16
    s_nop 1
    s_mul_i32 s32, s31, 229376
    s_lshl_b32 s31, s31, 14
    v_mfma_f32_16x16x32_bf16 v[12:15], a[44:47], a[0:3], v[12:15]
    buffer_load_dwordx4 v234, s[16:19], s32 offen offset:0 lds
    v_mfma_f32_16x16x32_bf16 v[16:19], a[48:51], a[0:3], v[16:19]
    v_mfma_f32_16x16x32_bf16 v[20:23], a[52:55], a[0:3], v[20:23]
    ds_read_b64_tr_b16 a[94:95], v228 offset:34320
    v_mfma_f32_16x16x32_bf16 v[24:27], a[56:59], a[0:3], v[24:27]
    ds_read_b64_tr_b16 a[96:97], v228 offset:30768
    v_mfma_f32_16x16x32_bf16 v[52:55], a[56:59], a[4:7], v[52:55]
    v_mfma_f32_16x16x32_bf16 v[48:51], a[52:55], a[4:7], v[48:51]
    ds_read_b64_tr_b16 a[98:99], v228 offset:34352
    v_mfma_f32_16x16x32_bf16 v[44:47], a[48:51], a[4:7], v[44:47]
    v_mfma_f32_16x16x32_bf16 v[40:43], a[44:47], a[4:7], v[40:43]
    buffer_load_dwordx4 v235, s[16:19], s32 offen offset:1024 lds
    v_mfma_f32_16x16x32_bf16 v[36:39], a[40:43], a[4:7], v[36:39]
    v_mfma_f32_16x16x32_bf16 v[32:35], a[36:39], a[4:7], v[32:35]
    ds_read_b64_tr_b16 a[100:101], v228 offset:30800
    v_mfma_f32_16x16x32_bf16 v[28:31], a[32:35], a[4:7], v[28:31]
    ds_read_b64_tr_b16 a[102:103], v228 offset:34384
    v_mfma_f32_16x16x32_bf16 v[56:59], a[32:35], a[8:11], v[56:59]
    v_mfma_f32_16x16x32_bf16 v[60:63], a[36:39], a[8:11], v[60:63]
    ds_read_b64_tr_b16 a[104:105], v228 offset:37920
    v_mfma_f32_16x16x32_bf16 v[64:67], a[40:43], a[8:11], v[64:67]
    v_mfma_f32_16x16x32_bf16 v[68:71], a[44:47], a[8:11], v[68:71]
    buffer_load_dwordx4 v236, s[16:19], s32 offen offset:2048 lds
    v_mfma_f32_16x16x32_bf16 v[72:75], a[48:51], a[8:11], v[72:75]
    v_mfma_f32_16x16x32_bf16 v[76:79], a[52:55], a[8:11], v[76:79]
    ds_read_b64_tr_b16 a[106:107], v228 offset:41504
    v_mfma_f32_16x16x32_bf16 v[80:83], a[56:59], a[8:11], v[80:83]
    ds_read_b64_tr_b16 a[108:109], v228 offset:37952
    v_mfma_f32_16x16x32_bf16 v[108:111], a[56:59], a[12:15], v[108:111]
    v_mfma_f32_16x16x32_bf16 v[104:107], a[52:55], a[12:15], v[104:107]
    ds_read_b64_tr_b16 a[110:111], v228 offset:41536
    v_mfma_f32_16x16x32_bf16 v[100:103], a[48:51], a[12:15], v[100:103]
    v_mfma_f32_16x16x32_bf16 v[96:99], a[44:47], a[12:15], v[96:99]
    s_mov_b64 exec, s[38:39]
    buffer_load_dwordx4 v237, s[16:19], s32 offen offset:3072 lds
    s_mov_b64 exec, -1
    v_mfma_f32_16x16x32_bf16 v[92:95], a[40:43], a[12:15], v[92:95]
    v_mfma_f32_16x16x32_bf16 v[88:91], a[36:39], a[12:15], v[88:91]
    ds_read_b64_tr_b16 a[112:113], v228 offset:37984
    v_mfma_f32_16x16x32_bf16 v[84:87], a[32:35], a[12:15], v[84:87]
    ds_read_b64_tr_b16 a[114:115], v228 offset:41568
    v_mfma_f32_16x16x32_bf16 v[112:115], a[32:35], a[16:19], v[112:115]
    v_mfma_f32_16x16x32_bf16 v[116:119], a[36:39], a[16:19], v[116:119]
    ds_read_b64_tr_b16 a[116:117], v231 offset:30736
    v_mfma_f32_16x16x32_bf16 v[120:123], a[40:43], a[16:19], v[120:123]
    s_add_u32 m0, s36, 30736
    v_mfma_f32_16x16x32_bf16 v[124:127], a[44:47], a[16:19], v[124:127]
    buffer_load_dwordx4 v233, s[12:15], s31 offen offset:0  lds
    v_mfma_f32_16x16x32_bf16 v[128:131], a[48:51], a[16:19], v[128:131]
    v_mfma_f32_16x16x32_bf16 v[132:135], a[52:55], a[16:19], v[132:135]
    ds_read_b64_tr_b16 a[118:119], v231 offset:34320
    v_mfma_f32_16x16x32_bf16 v[136:139], a[56:59], a[16:19], v[136:139]
    ds_read_b128 a[64:67], v225 offset:31760
    v_mfma_f32_16x16x32_bf16 v[164:167], a[56:59], a[20:23], v[164:167]
    ds_read_b128 a[68:71], v225 offset:32784
    v_mfma_f32_16x16x32_bf16 v[160:163], a[52:55], a[20:23], v[160:163]
    v_mfma_f32_16x16x32_bf16 v[156:159], a[48:51], a[20:23], v[156:159]
    v_mfma_f32_16x16x32_bf16 v[152:155], a[44:47], a[20:23], v[152:155]
    buffer_load_dwordx4 v233, s[12:15], s31 offen offset:1024  lds
    v_mfma_f32_16x16x32_bf16 v[148:151], a[40:43], a[20:23], v[148:151]
    v_mfma_f32_16x16x32_bf16 v[144:147], a[36:39], a[20:23], v[144:147]
    ds_read_b128 a[72:75], v225 offset:33808
    v_mfma_f32_16x16x32_bf16 v[140:143], a[32:35], a[20:23], v[140:143]
    ds_read_b128 a[76:79], v225 offset:34832
    v_mfma_f32_16x16x32_bf16 v[168:171], a[32:35], a[24:27], v[168:171]
    ds_read_b128 a[80:83], v225 offset:35856
    v_mfma_f32_16x16x32_bf16 v[172:175], a[36:39], a[24:27], v[172:175]
    v_mfma_f32_16x16x32_bf16 v[176:179], a[40:43], a[24:27], v[176:179]
    v_mfma_f32_16x16x32_bf16 v[180:183], a[44:47], a[24:27], v[180:183]
    buffer_load_dwordx4 v233, s[12:15], s31 offen offset:2048  lds
    v_mfma_f32_16x16x32_bf16 v[184:187], a[48:51], a[24:27], v[184:187]
    v_mfma_f32_16x16x32_bf16 v[188:191], a[52:55], a[24:27], v[188:191]
    ds_read_b128 a[84:87], v225 offset:36880
    v_mfma_f32_16x16x32_bf16 v[192:195], a[56:59], a[24:27], v[192:195]
    ds_read_b128 a[88:91], v225 offset:37904
    v_mfma_f32_16x16x32_bf16 v[220:223], a[56:59], a[28:31], v[220:223]
    v_mfma_f32_16x16x32_bf16 v[216:219], a[52:55], a[28:31], v[216:219]
    v_mfma_f32_16x16x32_bf16 v[212:215], a[48:51], a[28:31], v[212:215]
    v_mfma_f32_16x16x32_bf16 v[208:211], a[44:47], a[28:31], v[208:211]
    buffer_load_dwordx4 v233, s[12:15], s31 offen offset:3072  lds
    v_mfma_f32_16x16x32_bf16 v[204:207], a[40:43], a[28:31], v[204:207]
    v_mfma_f32_16x16x32_bf16 v[200:203], a[36:39], a[28:31], v[200:203]
    v_mfma_f32_16x16x32_bf16 v[196:199], a[32:35], a[28:31], v[196:199]
    s_waitcnt vmcnt(17) lgkmcnt(0)
    s_barrier
    v_mfma_f32_16x16x32_bf16 v[0:3], a[92:95], a[60:63], v[0:3]
    ds_read_b128 a[0:3], v226 offset:0
    v_mfma_f32_16x16x32_bf16 v[4:7], a[96:99], a[60:63], v[4:7]
    ds_read_b64_tr_b16 a[32:33], v229 offset:0
    v_mfma_f32_16x16x32_bf16 v[8:11], a[100:103], a[60:63], v[8:11]
    s_add_u32 m0, s37, 61472
    v_readlane_b32 s31, v255, 17
    s_nop 1
    s_mul_i32 s32, s31, 229376
    s_lshl_b32 s31, s31, 14
    v_mfma_f32_16x16x32_bf16 v[12:15], a[104:107], a[60:63], v[12:15]
    buffer_load_dwordx4 v234, s[16:19], s32 offen offset:0 lds
    v_mfma_f32_16x16x32_bf16 v[16:19], a[108:111], a[60:63], v[16:19]
    v_mfma_f32_16x16x32_bf16 v[20:23], a[112:115], a[60:63], v[20:23]
    ds_read_b64_tr_b16 a[34:35], v229 offset:3584
    v_mfma_f32_16x16x32_bf16 v[24:27], a[116:119], a[60:63], v[24:27]
    ds_read_b64_tr_b16 a[36:37], v229 offset:32
    v_mfma_f32_16x16x32_bf16 v[52:55], a[116:119], a[64:67], v[52:55]
    v_mfma_f32_16x16x32_bf16 v[48:51], a[112:115], a[64:67], v[48:51]
    ds_read_b64_tr_b16 a[38:39], v229 offset:3616
    v_mfma_f32_16x16x32_bf16 v[44:47], a[108:111], a[64:67], v[44:47]
    v_mfma_f32_16x16x32_bf16 v[40:43], a[104:107], a[64:67], v[40:43]
    buffer_load_dwordx4 v235, s[16:19], s32 offen offset:1024 lds
    v_mfma_f32_16x16x32_bf16 v[36:39], a[100:103], a[64:67], v[36:39]
    v_mfma_f32_16x16x32_bf16 v[32:35], a[96:99], a[64:67], v[32:35]
    ds_read_b64_tr_b16 a[40:41], v229 offset:64
    v_mfma_f32_16x16x32_bf16 v[28:31], a[92:95], a[64:67], v[28:31]
    ds_read_b64_tr_b16 a[42:43], v229 offset:3648
    v_mfma_f32_16x16x32_bf16 v[56:59], a[92:95], a[68:71], v[56:59]
    v_mfma_f32_16x16x32_bf16 v[60:63], a[96:99], a[68:71], v[60:63]
    ds_read_b64_tr_b16 a[44:45], v229 offset:7184
    v_mfma_f32_16x16x32_bf16 v[64:67], a[100:103], a[68:71], v[64:67]
    v_mfma_f32_16x16x32_bf16 v[68:71], a[104:107], a[68:71], v[68:71]
    buffer_load_dwordx4 v236, s[16:19], s32 offen offset:2048 lds
    v_mfma_f32_16x16x32_bf16 v[72:75], a[108:111], a[68:71], v[72:75]
    v_mfma_f32_16x16x32_bf16 v[76:79], a[112:115], a[68:71], v[76:79]
    ds_read_b64_tr_b16 a[46:47], v229 offset:10768
    v_mfma_f32_16x16x32_bf16 v[80:83], a[116:119], a[68:71], v[80:83]
    ds_read_b64_tr_b16 a[48:49], v229 offset:7216
    v_mfma_f32_16x16x32_bf16 v[108:111], a[116:119], a[72:75], v[108:111]
    v_mfma_f32_16x16x32_bf16 v[104:107], a[112:115], a[72:75], v[104:107]
    ds_read_b64_tr_b16 a[50:51], v229 offset:10800
    v_mfma_f32_16x16x32_bf16 v[100:103], a[108:111], a[72:75], v[100:103]
    v_mfma_f32_16x16x32_bf16 v[96:99], a[104:107], a[72:75], v[96:99]
    s_mov_b64 exec, s[38:39]
    buffer_load_dwordx4 v237, s[16:19], s32 offen offset:3072 lds
    s_mov_b64 exec, -1
    v_mfma_f32_16x16x32_bf16 v[92:95], a[100:103], a[72:75], v[92:95]
    v_mfma_f32_16x16x32_bf16 v[88:91], a[96:99], a[72:75], v[88:91]
    ds_read_b64_tr_b16 a[52:53], v229 offset:7248
    v_mfma_f32_16x16x32_bf16 v[84:87], a[92:95], a[72:75], v[84:87]
    ds_read_b64_tr_b16 a[54:55], v229 offset:10832
    v_mfma_f32_16x16x32_bf16 v[112:115], a[92:95], a[76:79], v[112:115]
    v_mfma_f32_16x16x32_bf16 v[116:119], a[96:99], a[76:79], v[116:119]
    ds_read_b64_tr_b16 a[56:57], v232 offset:0
    v_mfma_f32_16x16x32_bf16 v[120:123], a[100:103], a[76:79], v[120:123]
    s_add_u32 m0, s36, 61472
    v_mfma_f32_16x16x32_bf16 v[124:127], a[104:107], a[76:79], v[124:127]
    buffer_load_dwordx4 v233, s[12:15], s31 offen offset:0  lds
    v_mfma_f32_16x16x32_bf16 v[128:131], a[108:111], a[76:79], v[128:131]
    v_mfma_f32_16x16x32_bf16 v[132:135], a[112:115], a[76:79], v[132:135]
    ds_read_b64_tr_b16 a[58:59], v232 offset:3584
    v_mfma_f32_16x16x32_bf16 v[136:139], a[116:119], a[76:79], v[136:139]
    ds_read_b128 a[4:7], v226 offset:1024
    v_mfma_f32_16x16x32_bf16 v[164:167], a[116:119], a[80:83], v[164:167]
    ds_read_b128 a[8:11], v226 offset:2048
    v_mfma_f32_16x16x32_bf16 v[160:163], a[112:115], a[80:83], v[160:163]
    v_mfma_f32_16x16x32_bf16 v[156:159], a[108:111], a[80:83], v[156:159]
    v_mfma_f32_16x16x32_bf16 v[152:155], a[104:107], a[80:83], v[152:155]
    buffer_load_dwordx4 v233, s[12:15], s31 offen offset:1024  lds
    v_mfma_f32_16x16x32_bf16 v[148:151], a[100:103], a[80:83], v[148:151]
    v_mfma_f32_16x16x32_bf16 v[144:147], a[96:99], a[80:83], v[144:147]
    ds_read_b128 a[12:15], v226 offset:3072
    v_mfma_f32_16x16x32_bf16 v[140:143], a[92:95], a[80:83], v[140:143]
    ds_read_b128 a[16:19], v226 offset:4096
    v_mfma_f32_16x16x32_bf16 v[168:171], a[92:95], a[84:87], v[168:171]
    ds_read_b128 a[20:23], v226 offset:5120
    v_mfma_f32_16x16x32_bf16 v[172:175], a[96:99], a[84:87], v[172:175]
    v_mfma_f32_16x16x32_bf16 v[176:179], a[100:103], a[84:87], v[176:179]
    v_mfma_f32_16x16x32_bf16 v[180:183], a[104:107], a[84:87], v[180:183]
    buffer_load_dwordx4 v233, s[12:15], s31 offen offset:2048  lds
    v_mfma_f32_16x16x32_bf16 v[184:187], a[108:111], a[84:87], v[184:187]
    v_mfma_f32_16x16x32_bf16 v[188:191], a[112:115], a[84:87], v[188:191]
    ds_read_b128 a[24:27], v226 offset:6144
    v_mfma_f32_16x16x32_bf16 v[192:195], a[116:119], a[84:87], v[192:195]
    ds_read_b128 a[28:31], v226 offset:7168
    v_mfma_f32_16x16x32_bf16 v[220:223], a[116:119], a[88:91], v[220:223]
    v_mfma_f32_16x16x32_bf16 v[216:219], a[112:115], a[88:91], v[216:219]
    v_mfma_f32_16x16x32_bf16 v[212:215], a[108:111], a[88:91], v[212:215]
    v_mfma_f32_16x16x32_bf16 v[208:211], a[104:107], a[88:91], v[208:211]
    buffer_load_dwordx4 v233, s[12:15], s31 offen offset:3072  lds
    v_mfma_f32_16x16x32_bf16 v[204:207], a[100:103], a[88:91], v[204:207]
    v_mfma_f32_16x16x32_bf16 v[200:203], a[96:99], a[88:91], v[200:203]
    v_mfma_f32_16x16x32_bf16 v[196:199], a[92:95], a[88:91], v[196:199]
    s_waitcnt vmcnt(16) lgkmcnt(0)
    s_barrier
    v_mfma_f32_16x16x32_bf16 v[0:3], a[32:35], a[0:3], v[0:3]
    ds_read_b128 a[60:63], v224 offset:0
    v_mfma_f32_16x16x32_bf16 v[4:7], a[36:39], a[0:3], v[4:7]
    ds_read_b64_tr_b16 a[92:93], v227 offset:0
    v_mfma_f32_16x16x32_bf16 v[8:11], a[40:43], a[0:3], v[8:11]
    s_add_u32 m0, s37, 92208
    v_readlane_b32 s31, v255, 18
    s_nop 1
    s_mul_i32 s32, s31, 229376
    s_lshl_b32 s31, s31, 14
    v_mfma_f32_16x16x32_bf16 v[12:15], a[44:47], a[0:3], v[12:15]
    buffer_load_dwordx4 v234, s[16:19], s32 offen offset:0 lds
    v_mfma_f32_16x16x32_bf16 v[16:19], a[48:51], a[0:3], v[16:19]
    v_mfma_f32_16x16x32_bf16 v[20:23], a[52:55], a[0:3], v[20:23]
    ds_read_b64_tr_b16 a[94:95], v227 offset:3584
    v_mfma_f32_16x16x32_bf16 v[24:27], a[56:59], a[0:3], v[24:27]
    ds_read_b64_tr_b16 a[96:97], v227 offset:32
    v_mfma_f32_16x16x32_bf16 v[52:55], a[56:59], a[4:7], v[52:55]
    v_mfma_f32_16x16x32_bf16 v[48:51], a[52:55], a[4:7], v[48:51]
    ds_read_b64_tr_b16 a[98:99], v227 offset:3616
    v_mfma_f32_16x16x32_bf16 v[44:47], a[48:51], a[4:7], v[44:47]
    v_mfma_f32_16x16x32_bf16 v[40:43], a[44:47], a[4:7], v[40:43]
    buffer_load_dwordx4 v235, s[16:19], s32 offen offset:1024 lds
    v_mfma_f32_16x16x32_bf16 v[36:39], a[40:43], a[4:7], v[36:39]
    v_mfma_f32_16x16x32_bf16 v[32:35], a[36:39], a[4:7], v[32:35]
    ds_read_b64_tr_b16 a[100:101], v227 offset:64
    v_mfma_f32_16x16x32_bf16 v[28:31], a[32:35], a[4:7], v[28:31]
    ds_read_b64_tr_b16 a[102:103], v227 offset:3648
    v_mfma_f32_16x16x32_bf16 v[56:59], a[32:35], a[8:11], v[56:59]
    v_mfma_f32_16x16x32_bf16 v[60:63], a[36:39], a[8:11], v[60:63]
    ds_read_b64_tr_b16 a[104:105], v227 offset:7184
    v_mfma_f32_16x16x32_bf16 v[64:67], a[40:43], a[8:11], v[64:67]
    v_mfma_f32_16x16x32_bf16 v[68:71], a[44:47], a[8:11], v[68:71]
    buffer_load_dwordx4 v236, s[16:19], s32 offen offset:2048 lds
    v_mfma_f32_16x16x32_bf16 v[72:75], a[48:51], a[8:11], v[72:75]
    v_mfma_f32_16x16x32_bf16 v[76:79], a[52:55], a[8:11], v[76:79]
    ds_read_b64_tr_b16 a[106:107], v227 offset:10768
    v_mfma_f32_16x16x32_bf16 v[80:83], a[56:59], a[8:11], v[80:83]
    ds_read_b64_tr_b16 a[108:109], v227 offset:7216
    v_mfma_f32_16x16x32_bf16 v[108:111], a[56:59], a[12:15], v[108:111]
    v_mfma_f32_16x16x32_bf16 v[104:107], a[52:55], a[12:15], v[104:107]
    ds_read_b64_tr_b16 a[110:111], v227 offset:10800
    v_mfma_f32_16x16x32_bf16 v[100:103], a[48:51], a[12:15], v[100:103]
    v_mfma_f32_16x16x32_bf16 v[96:99], a[44:47], a[12:15], v[96:99]
    s_mov_b64 exec, s[38:39]
    buffer_load_dwordx4 v237, s[16:19], s32 offen offset:3072 lds
    s_mov_b64 exec, -1
    v_mfma_f32_16x16x32_bf16 v[92:95], a[40:43], a[12:15], v[92:95]
    v_mfma_f32_16x16x32_bf16 v[88:91], a[36:39], a[12:15], v[88:91]
    ds_read_b64_tr_b16 a[112:113], v227 offset:7248
    v_mfma_f32_16x16x32_bf16 v[84:87], a[32:35], a[12:15], v[84:87]
    ds_read_b64_tr_b16 a[114:115], v227 offset:10832
    v_mfma_f32_16x16x32_bf16 v[112:115], a[32:35], a[16:19], v[112:115]
    v_mfma_f32_16x16x32_bf16 v[116:119], a[36:39], a[16:19], v[116:119]
    ds_read_b64_tr_b16 a[116:117], v230 offset:0
    v_mfma_f32_16x16x32_bf16 v[120:123], a[40:43], a[16:19], v[120:123]
    s_add_u32 m0, s36, 92208
    v_mfma_f32_16x16x32_bf16 v[124:127], a[44:47], a[16:19], v[124:127]
    buffer_load_dwordx4 v233, s[12:15], s31 offen offset:0  lds
    v_mfma_f32_16x16x32_bf16 v[128:131], a[48:51], a[16:19], v[128:131]
    v_mfma_f32_16x16x32_bf16 v[132:135], a[52:55], a[16:19], v[132:135]
    ds_read_b64_tr_b16 a[118:119], v230 offset:3584
    v_mfma_f32_16x16x32_bf16 v[136:139], a[56:59], a[16:19], v[136:139]
    ds_read_b128 a[64:67], v224 offset:1024
    v_mfma_f32_16x16x32_bf16 v[164:167], a[56:59], a[20:23], v[164:167]
    ds_read_b128 a[68:71], v224 offset:2048
    v_mfma_f32_16x16x32_bf16 v[160:163], a[52:55], a[20:23], v[160:163]
    v_mfma_f32_16x16x32_bf16 v[156:159], a[48:51], a[20:23], v[156:159]
    v_mfma_f32_16x16x32_bf16 v[152:155], a[44:47], a[20:23], v[152:155]
    buffer_load_dwordx4 v233, s[12:15], s31 offen offset:1024  lds
    v_mfma_f32_16x16x32_bf16 v[148:151], a[40:43], a[20:23], v[148:151]
    v_mfma_f32_16x16x32_bf16 v[144:147], a[36:39], a[20:23], v[144:147]
    ds_read_b128 a[72:75], v224 offset:3072
    v_mfma_f32_16x16x32_bf16 v[140:143], a[32:35], a[20:23], v[140:143]
    ds_read_b128 a[76:79], v224 offset:4096
    v_mfma_f32_16x16x32_bf16 v[168:171], a[32:35], a[24:27], v[168:171]
    ds_read_b128 a[80:83], v224 offset:5120
    v_mfma_f32_16x16x32_bf16 v[172:175], a[36:39], a[24:27], v[172:175]
    v_mfma_f32_16x16x32_bf16 v[176:179], a[40:43], a[24:27], v[176:179]
    v_mfma_f32_16x16x32_bf16 v[180:183], a[44:47], a[24:27], v[180:183]
    buffer_load_dwordx4 v233, s[12:15], s31 offen offset:2048  lds
    v_mfma_f32_16x16x32_bf16 v[184:187], a[48:51], a[24:27], v[184:187]
    v_mfma_f32_16x16x32_bf16 v[188:191], a[52:55], a[24:27], v[188:191]
    ds_read_b128 a[84:87], v224 offset:6144
    v_mfma_f32_16x16x32_bf16 v[192:195], a[56:59], a[24:27], v[192:195]
    ds_read_b128 a[88:91], v224 offset:7168
    v_mfma_f32_16x16x32_bf16 v[220:223], a[56:59], a[28:31], v[220:223]
    v_mfma_f32_16x16x32_bf16 v[216:219], a[52:55], a[28:31], v[216:219]
    v_mfma_f32_16x16x32_bf16 v[212:215], a[48:51], a[28:31], v[212:215]
    v_mfma_f32_16x16x32_bf16 v[208:211], a[44:47], a[28:31], v[208:211]
    buffer_load_dwordx4 v233, s[12:15], s31 offen offset:3072  lds
    v_mfma_f32_16x16x32_bf16 v[204:207], a[40:43], a[28:31], v[204:207]
    v_mfma_f32_16x16x32_bf16 v[200:203], a[36:39], a[28:31], v[200:203]
    v_mfma_f32_16x16x32_bf16 v[196:199], a[32:35], a[28:31], v[196:199]
    s_waitcnt vmcnt(16) lgkmcnt(0)
    s_barrier
    v_mfma_f32_16x16x32_bf16 v[0:3], a[92:95], a[60:63], v[0:3]
    ds_read_b128 a[0:3], v224 offset:30736
    v_mfma_f32_16x16x32_bf16 v[4:7], a[96:99], a[60:63], v[4:7]
    ds_read_b64_tr_b16 a[32:33], v227 offset:30736
    v_mfma_f32_16x16x32_bf16 v[8:11], a[100:103], a[60:63], v[8:11]
    s_add_u32 m0, s37, 122944
    v_readlane_b32 s31, v255, 19
    s_nop 1
    s_mul_i32 s32, s31, 229376
    s_lshl_b32 s31, s31, 14
    v_mfma_f32_16x16x32_bf16 v[12:15], a[104:107], a[60:63], v[12:15]
    buffer_load_dwordx4 v234, s[16:19], s32 offen offset:0 lds
    v_mfma_f32_16x16x32_bf16 v[16:19], a[108:111], a[60:63], v[16:19]
    v_mfma_f32_16x16x32_bf16 v[20:23], a[112:115], a[60:63], v[20:23]
    ds_read_b64_tr_b16 a[34:35], v227 offset:34320
    v_mfma_f32_16x16x32_bf16 v[24:27], a[116:119], a[60:63], v[24:27]
    ds_read_b64_tr_b16 a[36:37], v227 offset:30768
    v_mfma_f32_16x16x32_bf16 v[52:55], a[116:119], a[64:67], v[52:55]
    v_mfma_f32_16x16x32_bf16 v[48:51], a[112:115], a[64:67], v[48:51]
    ds_read_b64_tr_b16 a[38:39], v227 offset:34352
    v_mfma_f32_16x16x32_bf16 v[44:47], a[108:111], a[64:67], v[44:47]
    v_mfma_f32_16x16x32_bf16 v[40:43], a[104:107], a[64:67], v[40:43]
    buffer_load_dwordx4 v235, s[16:19], s32 offen offset:1024 lds
    v_mfma_f32_16x16x32_bf16 v[36:39], a[100:103], a[64:67], v[36:39]
    v_mfma_f32_16x16x32_bf16 v[32:35], a[96:99], a[64:67], v[32:35]
    ds_read_b64_tr_b16 a[40:41], v227 offset:30800
    v_mfma_f32_16x16x32_bf16 v[28:31], a[92:95], a[64:67], v[28:31]
    ds_read_b64_tr_b16 a[42:43], v227 offset:34384
    v_mfma_f32_16x16x32_bf16 v[56:59], a[92:95], a[68:71], v[56:59]
    v_mfma_f32_16x16x32_bf16 v[60:63], a[96:99], a[68:71], v[60:63]
    ds_read_b64_tr_b16 a[44:45], v227 offset:37920
    v_mfma_f32_16x16x32_bf16 v[64:67], a[100:103], a[68:71], v[64:67]
    v_mfma_f32_16x16x32_bf16 v[68:71], a[104:107], a[68:71], v[68:71]
    buffer_load_dwordx4 v236, s[16:19], s32 offen offset:2048 lds
    v_mfma_f32_16x16x32_bf16 v[72:75], a[108:111], a[68:71], v[72:75]
    v_mfma_f32_16x16x32_bf16 v[76:79], a[112:115], a[68:71], v[76:79]
    ds_read_b64_tr_b16 a[46:47], v227 offset:41504
    v_mfma_f32_16x16x32_bf16 v[80:83], a[116:119], a[68:71], v[80:83]
    ds_read_b64_tr_b16 a[48:49], v227 offset:37952
    v_mfma_f32_16x16x32_bf16 v[108:111], a[116:119], a[72:75], v[108:111]
    v_mfma_f32_16x16x32_bf16 v[104:107], a[112:115], a[72:75], v[104:107]
    ds_read_b64_tr_b16 a[50:51], v227 offset:41536
    v_mfma_f32_16x16x32_bf16 v[100:103], a[108:111], a[72:75], v[100:103]
    v_mfma_f32_16x16x32_bf16 v[96:99], a[104:107], a[72:75], v[96:99]
    s_mov_b64 exec, s[38:39]
    buffer_load_dwordx4 v237, s[16:19], s32 offen offset:3072 lds
    s_mov_b64 exec, -1
    v_mfma_f32_16x16x32_bf16 v[92:95], a[100:103], a[72:75], v[92:95]
    v_mfma_f32_16x16x32_bf16 v[88:91], a[96:99], a[72:75], v[88:91]
    ds_read_b64_tr_b16 a[52:53], v227 offset:37984
    v_mfma_f32_16x16x32_bf16 v[84:87], a[92:95], a[72:75], v[84:87]
    ds_read_b64_tr_b16 a[54:55], v227 offset:41568
    v_mfma_f32_16x16x32_bf16 v[112:115], a[92:95], a[76:79], v[112:115]
    v_mfma_f32_16x16x32_bf16 v[116:119], a[96:99], a[76:79], v[116:119]
    ds_read_b64_tr_b16 a[56:57], v230 offset:30736
    v_mfma_f32_16x16x32_bf16 v[120:123], a[100:103], a[76:79], v[120:123]
    s_add_u32 m0, s36, 122944
    v_mfma_f32_16x16x32_bf16 v[124:127], a[104:107], a[76:79], v[124:127]
    buffer_load_dwordx4 v233, s[12:15], s31 offen offset:0  lds
    v_mfma_f32_16x16x32_bf16 v[128:131], a[108:111], a[76:79], v[128:131]
    v_mfma_f32_16x16x32_bf16 v[132:135], a[112:115], a[76:79], v[132:135]
    ds_read_b64_tr_b16 a[58:59], v230 offset:34320
    v_mfma_f32_16x16x32_bf16 v[136:139], a[116:119], a[76:79], v[136:139]
    ds_read_b128 a[4:7], v224 offset:31760
    v_mfma_f32_16x16x32_bf16 v[164:167], a[116:119], a[80:83], v[164:167]
    ds_read_b128 a[8:11], v224 offset:32784
    v_mfma_f32_16x16x32_bf16 v[160:163], a[112:115], a[80:83], v[160:163]
    v_mfma_f32_16x16x32_bf16 v[156:159], a[108:111], a[80:83], v[156:159]
    v_mfma_f32_16x16x32_bf16 v[152:155], a[104:107], a[80:83], v[152:155]
    buffer_load_dwordx4 v233, s[12:15], s31 offen offset:1024  lds
    v_mfma_f32_16x16x32_bf16 v[148:151], a[100:103], a[80:83], v[148:151]
    v_mfma_f32_16x16x32_bf16 v[144:147], a[96:99], a[80:83], v[144:147]
    ds_read_b128 a[12:15], v224 offset:33808
    v_mfma_f32_16x16x32_bf16 v[140:143], a[92:95], a[80:83], v[140:143]
    ds_read_b128 a[16:19], v224 offset:34832
    v_mfma_f32_16x16x32_bf16 v[168:171], a[92:95], a[84:87], v[168:171]
    ds_read_b128 a[20:23], v224 offset:35856
    v_mfma_f32_16x16x32_bf16 v[172:175], a[96:99], a[84:87], v[172:175]
    v_mfma_f32_16x16x32_bf16 v[176:179], a[100:103], a[84:87], v[176:179]
    v_mfma_f32_16x16x32_bf16 v[180:183], a[104:107], a[84:87], v[180:183]
    buffer_load_dwordx4 v233, s[12:15], s31 offen offset:2048  lds
    v_mfma_f32_16x16x32_bf16 v[184:187], a[108:111], a[84:87], v[184:187]
    v_mfma_f32_16x16x32_bf16 v[188:191], a[112:115], a[84:87], v[188:191]
    ds_read_b128 a[24:27], v224 offset:36880
    v_mfma_f32_16x16x32_bf16 v[192:195], a[116:119], a[84:87], v[192:195]
    ds_read_b128 a[28:31], v224 offset:37904
    v_mfma_f32_16x16x32_bf16 v[220:223], a[116:119], a[88:91], v[220:223]
    v_mfma_f32_16x16x32_bf16 v[216:219], a[112:115], a[88:91], v[216:219]
    v_mfma_f32_16x16x32_bf16 v[212:215], a[108:111], a[88:91], v[212:215]
    v_mfma_f32_16x16x32_bf16 v[208:211], a[104:107], a[88:91], v[208:211]
    buffer_load_dwordx4 v233, s[12:15], s31 offen offset:3072  lds
    v_mfma_f32_16x16x32_bf16 v[204:207], a[100:103], a[88:91], v[204:207]
    v_mfma_f32_16x16x32_bf16 v[200:203], a[96:99], a[88:91], v[200:203]
    v_mfma_f32_16x16x32_bf16 v[196:199], a[92:95], a[88:91], v[196:199]
    s_waitcnt vmcnt(16) lgkmcnt(0)
    s_barrier
    v_mfma_f32_16x16x32_bf16 v[0:3], a[32:35], a[0:3], v[0:3]
    ds_read_b128 a[60:63], v225 offset:0
    v_mfma_f32_16x16x32_bf16 v[4:7], a[36:39], a[0:3], v[4:7]
    ds_read_b64_tr_b16 a[92:93], v228 offset:0
    v_mfma_f32_16x16x32_bf16 v[8:11], a[40:43], a[0:3], v[8:11]
    s_add_u32 m0, s37, 0
    v_readlane_b32 s31, v255, 20
    s_nop 1
    s_mul_i32 s32, s31, 229376
    s_lshl_b32 s31, s31, 14
    v_mfma_f32_16x16x32_bf16 v[12:15], a[44:47], a[0:3], v[12:15]
    buffer_load_dwordx4 v234, s[16:19], s32 offen offset:0 lds
    v_mfma_f32_16x16x32_bf16 v[16:19], a[48:51], a[0:3], v[16:19]
    v_mfma_f32_16x16x32_bf16 v[20:23], a[52:55], a[0:3], v[20:23]
    ds_read_b64_tr_b16 a[94:95], v228 offset:3584
    v_mfma_f32_16x16x32_bf16 v[24:27], a[56:59], a[0:3], v[24:27]
    ds_read_b64_tr_b16 a[96:97], v228 offset:32
    v_mfma_f32_16x16x32_bf16 v[52:55], a[56:59], a[4:7], v[52:55]
    v_mfma_f32_16x16x32_bf16 v[48:51], a[52:55], a[4:7], v[48:51]
    ds_read_b64_tr_b16 a[98:99], v228 offset:3616
    v_mfma_f32_16x16x32_bf16 v[44:47], a[48:51], a[4:7], v[44:47]
    v_mfma_f32_16x16x32_bf16 v[40:43], a[44:47], a[4:7], v[40:43]
    buffer_load_dwordx4 v235, s[16:19], s32 offen offset:1024 lds
    v_mfma_f32_16x16x32_bf16 v[36:39], a[40:43], a[4:7], v[36:39]
    v_mfma_f32_16x16x32_bf16 v[32:35], a[36:39], a[4:7], v[32:35]
    ds_read_b64_tr_b16 a[100:101], v228 offset:64
    v_mfma_f32_16x16x32_bf16 v[28:31], a[32:35], a[4:7], v[28:31]
    ds_read_b64_tr_b16 a[102:103], v228 offset:3648
    v_mfma_f32_16x16x32_bf16 v[56:59], a[32:35], a[8:11], v[56:59]
    v_mfma_f32_16x16x32_bf16 v[60:63], a[36:39], a[8:11], v[60:63]
    ds_read_b64_tr_b16 a[104:105], v228 offset:7184
    v_mfma_f32_16x16x32_bf16 v[64:67], a[40:43], a[8:11], v[64:67]
    v_mfma_f32_16x16x32_bf16 v[68:71], a[44:47], a[8:11], v[68:71]
    buffer_load_dwordx4 v236, s[16:19], s32 offen offset:2048 lds
    v_mfma_f32_16x16x32_bf16 v[72:75], a[48:51], a[8:11], v[72:75]
    v_mfma_f32_16x16x32_bf16 v[76:79], a[52:55], a[8:11], v[76:79]
    ds_read_b64_tr_b16 a[106:107], v228 offset:10768
    v_mfma_f32_16x16x32_bf16 v[80:83], a[56:59], a[8:11], v[80:83]
    ds_read_b64_tr_b16 a[108:109], v228 offset:7216
    v_mfma_f32_16x16x32_bf16 v[108:111], a[56:59], a[12:15], v[108:111]
    v_mfma_f32_16x16x32_bf16 v[104:107], a[52:55], a[12:15], v[104:107]
    ds_read_b64_tr_b16 a[110:111], v228 offset:10800
    v_mfma_f32_16x16x32_bf16 v[100:103], a[48:51], a[12:15], v[100:103]
    v_mfma_f32_16x16x32_bf16 v[96:99], a[44:47], a[12:15], v[96:99]
    s_mov_b64 exec, s[38:39]
    buffer_load_dwordx4 v237, s[16:19], s32 offen offset:3072 lds
    s_mov_b64 exec, -1
    v_mfma_f32_16x16x32_bf16 v[92:95], a[40:43], a[12:15], v[92:95]
    v_mfma_f32_16x16x32_bf16 v[88:91], a[36:39], a[12:15], v[88:91]
    ds_read_b64_tr_b16 a[112:113], v228 offset:7248
    v_mfma_f32_16x16x32_bf16 v[84:87], a[32:35], a[12:15], v[84:87]
    ds_read_b64_tr_b16 a[114:115], v228 offset:10832
    v_mfma_f32_16x16x32_bf16 v[112:115], a[32:35], a[16:19], v[112:115]
    v_mfma_f32_16x16x32_bf16 v[116:119], a[36:39], a[16:19], v[116:119]
    ds_read_b64_tr_b16 a[116:117], v231 offset:0
    v_mfma_f32_16x16x32_bf16 v[120:123], a[40:43], a[16:19], v[120:123]
    s_add_u32 m0, s36, 0
    v_mfma_f32_16x16x32_bf16 v[124:127], a[44:47], a[16:19], v[124:127]
    buffer_load_dwordx4 v233, s[12:15], s31 offen offset:0  lds
    v_mfma_f32_16x16x32_bf16 v[128:131], a[48:51], a[16:19], v[128:131]
    v_mfma_f32_16x16x32_bf16 v[132:135], a[52:55], a[16:19], v[132:135]
    ds_read_b64_tr_b16 a[118:119], v231 offset:3584
    v_mfma_f32_16x16x32_bf16 v[136:139], a[56:59], a[16:19], v[136:139]
    ds_read_b128 a[64:67], v225 offset:1024
    v_mfma_f32_16x16x32_bf16 v[164:167], a[56:59], a[20:23], v[164:167]
    ds_read_b128 a[68:71], v225 offset:2048
    v_mfma_f32_16x16x32_bf16 v[160:163], a[52:55], a[20:23], v[160:163]
    v_mfma_f32_16x16x32_bf16 v[156:159], a[48:51], a[20:23], v[156:159]
    v_mfma_f32_16x16x32_bf16 v[152:155], a[44:47], a[20:23], v[152:155]
    buffer_load_dwordx4 v233, s[12:15], s31 offen offset:1024  lds
    v_mfma_f32_16x16x32_bf16 v[148:151], a[40:43], a[20:23], v[148:151]
    v_mfma_f32_16x16x32_bf16 v[144:147], a[36:39], a[20:23], v[144:147]
    ds_read_b128 a[72:75], v225 offset:3072
    v_mfma_f32_16x16x32_bf16 v[140:143], a[32:35], a[20:23], v[140:143]
    ds_read_b128 a[76:79], v225 offset:4096
    v_mfma_f32_16x16x32_bf16 v[168:171], a[32:35], a[24:27], v[168:171]
    ds_read_b128 a[80:83], v225 offset:5120
    v_mfma_f32_16x16x32_bf16 v[172:175], a[36:39], a[24:27], v[172:175]
    v_mfma_f32_16x16x32_bf16 v[176:179], a[40:43], a[24:27], v[176:179]
    v_mfma_f32_16x16x32_bf16 v[180:183], a[44:47], a[24:27], v[180:183]
    buffer_load_dwordx4 v233, s[12:15], s31 offen offset:2048  lds
    v_mfma_f32_16x16x32_bf16 v[184:187], a[48:51], a[24:27], v[184:187]
    v_mfma_f32_16x16x32_bf16 v[188:191], a[52:55], a[24:27], v[188:191]
    ds_read_b128 a[84:87], v225 offset:6144
    v_mfma_f32_16x16x32_bf16 v[192:195], a[56:59], a[24:27], v[192:195]
    ds_read_b128 a[88:91], v225 offset:7168
    v_mfma_f32_16x16x32_bf16 v[220:223], a[56:59], a[28:31], v[220:223]
    v_mfma_f32_16x16x32_bf16 v[216:219], a[52:55], a[28:31], v[216:219]
    v_mfma_f32_16x16x32_bf16 v[212:215], a[48:51], a[28:31], v[212:215]
    v_mfma_f32_16x16x32_bf16 v[208:211], a[44:47], a[28:31], v[208:211]
    buffer_load_dwordx4 v233, s[12:15], s31 offen offset:3072  lds
    v_mfma_f32_16x16x32_bf16 v[204:207], a[40:43], a[28:31], v[204:207]
    v_mfma_f32_16x16x32_bf16 v[200:203], a[36:39], a[28:31], v[200:203]
    v_mfma_f32_16x16x32_bf16 v[196:199], a[32:35], a[28:31], v[196:199]
    s_waitcnt vmcnt(16) lgkmcnt(0)
    s_barrier
    v_mfma_f32_16x16x32_bf16 v[0:3], a[92:95], a[60:63], v[0:3]
    ds_read_b128 a[0:3], v225 offset:30736
    v_mfma_f32_16x16x32_bf16 v[4:7], a[96:99], a[60:63], v[4:7]
    ds_read_b64_tr_b16 a[32:33], v228 offset:30736
    v_mfma_f32_16x16x32_bf16 v[8:11], a[100:103], a[60:63], v[8:11]
    s_add_u32 m0, s37, 30736
    v_readlane_b32 s31, v255, 21
    s_nop 1
    s_mul_i32 s32, s31, 229376
    s_lshl_b32 s31, s31, 14
    v_mfma_f32_16x16x32_bf16 v[12:15], a[104:107], a[60:63], v[12:15]
    buffer_load_dwordx4 v234, s[16:19], s32 offen offset:0 lds
    v_mfma_f32_16x16x32_bf16 v[16:19], a[108:111], a[60:63], v[16:19]
    v_mfma_f32_16x16x32_bf16 v[20:23], a[112:115], a[60:63], v[20:23]
    ds_read_b64_tr_b16 a[34:35], v228 offset:34320
    v_mfma_f32_16x16x32_bf16 v[24:27], a[116:119], a[60:63], v[24:27]
    ds_read_b64_tr_b16 a[36:37], v228 offset:30768
    v_mfma_f32_16x16x32_bf16 v[52:55], a[116:119], a[64:67], v[52:55]
    v_mfma_f32_16x16x32_bf16 v[48:51], a[112:115], a[64:67], v[48:51]
    ds_read_b64_tr_b16 a[38:39], v228 offset:34352
    v_mfma_f32_16x16x32_bf16 v[44:47], a[108:111], a[64:67], v[44:47]
    v_mfma_f32_16x16x32_bf16 v[40:43], a[104:107], a[64:67], v[40:43]
    buffer_load_dwordx4 v235, s[16:19], s32 offen offset:1024 lds
    v_mfma_f32_16x16x32_bf16 v[36:39], a[100:103], a[64:67], v[36:39]
    v_mfma_f32_16x16x32_bf16 v[32:35], a[96:99], a[64:67], v[32:35]
    ds_read_b64_tr_b16 a[40:41], v228 offset:30800
    v_mfma_f32_16x16x32_bf16 v[28:31], a[92:95], a[64:67], v[28:31]
    ds_read_b64_tr_b16 a[42:43], v228 offset:34384
    v_mfma_f32_16x16x32_bf16 v[56:59], a[92:95], a[68:71], v[56:59]
    v_mfma_f32_16x16x32_bf16 v[60:63], a[96:99], a[68:71], v[60:63]
    ds_read_b64_tr_b16 a[44:45], v228 offset:37920
    v_mfma_f32_16x16x32_bf16 v[64:67], a[100:103], a[68:71], v[64:67]
    v_mfma_f32_16x16x32_bf16 v[68:71], a[104:107], a[68:71], v[68:71]
    buffer_load_dwordx4 v236, s[16:19], s32 offen offset:2048 lds
    v_mfma_f32_16x16x32_bf16 v[72:75], a[108:111], a[68:71], v[72:75]
    v_mfma_f32_16x16x32_bf16 v[76:79], a[112:115], a[68:71], v[76:79]
    ds_read_b64_tr_b16 a[46:47], v228 offset:41504
    v_mfma_f32_16x16x32_bf16 v[80:83], a[116:119], a[68:71], v[80:83]
    ds_read_b64_tr_b16 a[48:49], v228 offset:37952
    v_mfma_f32_16x16x32_bf16 v[108:111], a[116:119], a[72:75], v[108:111]
    v_mfma_f32_16x16x32_bf16 v[104:107], a[112:115], a[72:75], v[104:107]
    ds_read_b64_tr_b16 a[50:51], v228 offset:41536
    v_mfma_f32_16x16x32_bf16 v[100:103], a[108:111], a[72:75], v[100:103]
    v_mfma_f32_16x16x32_bf16 v[96:99], a[104:107], a[72:75], v[96:99]
    s_mov_b64 exec, s[38:39]
    buffer_load_dwordx4 v237, s[16:19], s32 offen offset:3072 lds
    s_mov_b64 exec, -1
    v_mfma_f32_16x16x32_bf16 v[92:95], a[100:103], a[72:75], v[92:95]
    v_mfma_f32_16x16x32_bf16 v[88:91], a[96:99], a[72:75], v[88:91]
    ds_read_b64_tr_b16 a[52:53], v228 offset:37984
    v_mfma_f32_16x16x32_bf16 v[84:87], a[92:95], a[72:75], v[84:87]
    ds_read_b64_tr_b16 a[54:55], v228 offset:41568
    v_mfma_f32_16x16x32_bf16 v[112:115], a[92:95], a[76:79], v[112:115]
    v_mfma_f32_16x16x32_bf16 v[116:119], a[96:99], a[76:79], v[116:119]
    ds_read_b64_tr_b16 a[56:57], v231 offset:30736
    v_mfma_f32_16x16x32_bf16 v[120:123], a[100:103], a[76:79], v[120:123]
    s_add_u32 m0, s36, 30736
    v_mfma_f32_16x16x32_bf16 v[124:127], a[104:107], a[76:79], v[124:127]
    buffer_load_dwordx4 v233, s[12:15], s31 offen offset:0  lds
    v_mfma_f32_16x16x32_bf16 v[128:131], a[108:111], a[76:79], v[128:131]
    v_mfma_f32_16x16x32_bf16 v[132:135], a[112:115], a[76:79], v[132:135]
    ds_read_b64_tr_b16 a[58:59], v231 offset:34320
    v_mfma_f32_16x16x32_bf16 v[136:139], a[116:119], a[76:79], v[136:139]
    ds_read_b128 a[4:7], v225 offset:31760
    v_mfma_f32_16x16x32_bf16 v[164:167], a[116:119], a[80:83], v[164:167]
    ds_read_b128 a[8:11], v225 offset:32784
    v_mfma_f32_16x16x32_bf16 v[160:163], a[112:115], a[80:83], v[160:163]
    v_mfma_f32_16x16x32_bf16 v[156:159], a[108:111], a[80:83], v[156:159]
    v_mfma_f32_16x16x32_bf16 v[152:155], a[104:107], a[80:83], v[152:155]
    buffer_load_dwordx4 v233, s[12:15], s31 offen offset:1024  lds
    v_mfma_f32_16x16x32_bf16 v[148:151], a[100:103], a[80:83], v[148:151]
    v_mfma_f32_16x16x32_bf16 v[144:147], a[96:99], a[80:83], v[144:147]
    ds_read_b128 a[12:15], v225 offset:33808
    v_mfma_f32_16x16x32_bf16 v[140:143], a[92:95], a[80:83], v[140:143]
    ds_read_b128 a[16:19], v225 offset:34832
    v_mfma_f32_16x16x32_bf16 v[168:171], a[92:95], a[84:87], v[168:171]
    ds_read_b128 a[20:23], v225 offset:35856
    v_mfma_f32_16x16x32_bf16 v[172:175], a[96:99], a[84:87], v[172:175]
    v_mfma_f32_16x16x32_bf16 v[176:179], a[100:103], a[84:87], v[176:179]
    v_mfma_f32_16x16x32_bf16 v[180:183], a[104:107], a[84:87], v[180:183]
    buffer_load_dwordx4 v233, s[12:15], s31 offen offset:2048  lds
    v_mfma_f32_16x16x32_bf16 v[184:187], a[108:111], a[84:87], v[184:187]
    v_mfma_f32_16x16x32_bf16 v[188:191], a[112:115], a[84:87], v[188:191]
    ds_read_b128 a[24:27], v225 offset:36880
    v_mfma_f32_16x16x32_bf16 v[192:195], a[116:119], a[84:87], v[192:195]
    ds_read_b128 a[28:31], v225 offset:37904
    v_mfma_f32_16x16x32_bf16 v[220:223], a[116:119], a[88:91], v[220:223]
    v_mfma_f32_16x16x32_bf16 v[216:219], a[112:115], a[88:91], v[216:219]
    v_mfma_f32_16x16x32_bf16 v[212:215], a[108:111], a[88:91], v[212:215]
    v_mfma_f32_16x16x32_bf16 v[208:211], a[104:107], a[88:91], v[208:211]
    buffer_load_dwordx4 v233, s[12:15], s31 offen offset:3072  lds
    v_mfma_f32_16x16x32_bf16 v[204:207], a[100:103], a[88:91], v[204:207]
    v_mfma_f32_16x16x32_bf16 v[200:203], a[96:99], a[88:91], v[200:203]
    v_mfma_f32_16x16x32_bf16 v[196:199], a[92:95], a[88:91], v[196:199]
    s_waitcnt vmcnt(16) lgkmcnt(0)
    s_barrier
    v_mfma_f32_16x16x32_bf16 v[0:3], a[32:35], a[0:3], v[0:3]
    ds_read_b128 a[60:63], v226 offset:0
    v_mfma_f32_16x16x32_bf16 v[4:7], a[36:39], a[0:3], v[4:7]
    ds_read_b64_tr_b16 a[92:93], v229 offset:0
    v_mfma_f32_16x16x32_bf16 v[8:11], a[40:43], a[0:3], v[8:11]
    s_add_u32 m0, s37, 61472
    v_readlane_b32 s31, v255, 22
    s_nop 1
    s_mul_i32 s32, s31, 229376
    s_lshl_b32 s31, s31, 14
    v_mfma_f32_16x16x32_bf16 v[12:15], a[44:47], a[0:3], v[12:15]
    buffer_load_dwordx4 v234, s[16:19], s32 offen offset:0 lds
    v_mfma_f32_16x16x32_bf16 v[16:19], a[48:51], a[0:3], v[16:19]
    v_mfma_f32_16x16x32_bf16 v[20:23], a[52:55], a[0:3], v[20:23]
    ds_read_b64_tr_b16 a[94:95], v229 offset:3584
    v_mfma_f32_16x16x32_bf16 v[24:27], a[56:59], a[0:3], v[24:27]
    ds_read_b64_tr_b16 a[96:97], v229 offset:32
    v_mfma_f32_16x16x32_bf16 v[52:55], a[56:59], a[4:7], v[52:55]
    ds_read_b64_tr_b16 a[98:99], v229 offset:3616
    v_mfma_f32_16x16x32_bf16 v[48:51], a[52:55], a[4:7], v[48:51]
    v_mfma_f32_16x16x32_bf16 v[44:47], a[48:51], a[4:7], v[44:47]
    buffer_load_dwordx4 v235, s[16:19], s32 offen offset:1024 lds
    v_mfma_f32_16x16x32_bf16 v[40:43], a[44:47], a[4:7], v[40:43]
    v_mfma_f32_16x16x32_bf16 v[36:39], a[40:43], a[4:7], v[36:39]
    ds_read_b64_tr_b16 a[100:101], v229 offset:64
    v_mfma_f32_16x16x32_bf16 v[32:35], a[36:39], a[4:7], v[32:35]
    v_mfma_f32_16x16x32_bf16 v[28:31], a[32:35], a[4:7], v[28:31]
    ds_read_b64_tr_b16 a[102:103], v229 offset:3648
    v_mfma_f32_16x16x32_bf16 v[56:59], a[32:35], a[8:11], v[56:59]
    v_mfma_f32_16x16x32_bf16 v[60:63], a[36:39], a[8:11], v[60:63]
    buffer_load_dwordx4 v236, s[16:19], s32 offen offset:2048 lds
    v_mfma_f32_16x16x32_bf16 v[64:67], a[40:43], a[8:11], v[64:67]
    v_mfma_f32_16x16x32_bf16 v[68:71], a[44:47], a[8:11], v[68:71]
    ds_read_b64_tr_b16 a[104:105], v229 offset:7184
    v_mfma_f32_16x16x32_bf16 v[72:75], a[48:51], a[8:11], v[72:75]
    ds_read_b64_tr_b16 a[106:107], v229 offset:10768
    v_mfma_f32_16x16x32_bf16 v[76:79], a[52:55], a[8:11], v[76:79]
    ds_read_b64_tr_b16 a[108:109], v229 offset:7216
    v_mfma_f32_16x16x32_bf16 v[80:83], a[56:59], a[8:11], v[80:83]
    v_mfma_f32_16x16x32_bf16 v[108:111], a[56:59], a[12:15], v[108:111]
    s_mov_b64 exec, s[38:39]
    buffer_load_dwordx4 v237, s[16:19], s32 offen offset:3072 lds
    s_mov_b64 exec, -1
    v_mfma_f32_16x16x32_bf16 v[104:107], a[52:55], a[12:15], v[104:107]
    v_mfma_f32_16x16x32_bf16 v[100:103], a[48:51], a[12:15], v[100:103]
    ds_read_b64_tr_b16 a[110:111], v229 offset:10800
    v_mfma_f32_16x16x32_bf16 v[96:99], a[44:47], a[12:15], v[96:99]
    v_mfma_f32_16x16x32_bf16 v[92:95], a[40:43], a[12:15], v[92:95]
    ds_read_b64_tr_b16 a[112:113], v229 offset:7248
    v_mfma_f32_16x16x32_bf16 v[88:91], a[36:39], a[12:15], v[88:91]
    ds_read_b64_tr_b16 a[114:115], v229 offset:10832
    v_mfma_f32_16x16x32_bf16 v[84:87], a[32:35], a[12:15], v[84:87]
    s_add_u32 m0, s36, 61472
    v_mfma_f32_16x16x32_bf16 v[112:115], a[32:35], a[16:19], v[112:115]
    buffer_load_dwordx4 v233, s[12:15], s31 offen offset:0  lds
    v_mfma_f32_16x16x32_bf16 v[116:119], a[36:39], a[16:19], v[116:119]
    v_mfma_f32_16x16x32_bf16 v[120:123], a[40:43], a[16:19], v[120:123]
    ds_read_b64_tr_b16 a[116:117], v232 offset:0
    v_mfma_f32_16x16x32_bf16 v[124:127], a[44:47], a[16:19], v[124:127]
    ds_read_b64_tr_b16 a[118:119], v232 offset:3584
    v_mfma_f32_16x16x32_bf16 v[128:131], a[48:51], a[16:19], v[128:131]
    ds_read_b128 a[64:67], v226 offset:1024
    v_mfma_f32_16x16x32_bf16 v[132:135], a[52:55], a[16:19], v[132:135]
    v_mfma_f32_16x16x32_bf16 v[136:139], a[56:59], a[16:19], v[136:139]
    buffer_load_dwordx4 v233, s[12:15], s31 offen offset:1024  lds
    v_mfma_f32_16x16x32_bf16 v[164:167], a[56:59], a[20:23], v[164:167]
    v_mfma_f32_16x16x32_bf16 v[160:163], a[52:55], a[20:23], v[160:163]
    ds_read_b128 a[68:71], v226 offset:2048
    v_mfma_f32_16x16x32_bf16 v[156:159], a[48:51], a[20:23], v[156:159]
    v_mfma_f32_16x16x32_bf16 v[152:155], a[44:47], a[20:23], v[152:155]
    ds_read_b128 a[72:75], v226 offset:3072
    v_mfma_f32_16x16x32_bf16 v[148:151], a[40:43], a[20:23], v[148:151]
    v_mfma_f32_16x16x32_bf16 v[144:147], a[36:39], a[20:23], v[144:147]
    buffer_load_dwordx4 v233, s[12:15], s31 offen offset:2048  lds
    v_mfma_f32_16x16x32_bf16 v[140:143], a[32:35], a[20:23], v[140:143]
    v_mfma_f32_16x16x32_bf16 v[168:171], a[32:35], a[24:27], v[168:171]
    ds_read_b128 a[76:79], v226 offset:4096
    v_mfma_f32_16x16x32_bf16 v[172:175], a[36:39], a[24:27], v[172:175]
    ds_read_b128 a[80:83], v226 offset:5120
    v_mfma_f32_16x16x32_bf16 v[176:179], a[40:43], a[24:27], v[176:179]
    ds_read_b128 a[84:87], v226 offset:6144
    v_mfma_f32_16x16x32_bf16 v[180:183], a[44:47], a[24:27], v[180:183]
    v_mfma_f32_16x16x32_bf16 v[184:187], a[48:51], a[24:27], v[184:187]
    buffer_load_dwordx4 v233, s[12:15], s31 offen offset:3072  lds
    v_mfma_f32_16x16x32_bf16 v[188:191], a[52:55], a[24:27], v[188:191]
    v_mfma_f32_16x16x32_bf16 v[192:195], a[56:59], a[24:27], v[192:195]
    ds_read_b128 a[88:91], v226 offset:7168
    v_mfma_f32_16x16x32_bf16 v[220:223], a[56:59], a[28:31], v[220:223]
    v_mfma_f32_16x16x32_bf16 v[216:219], a[52:55], a[28:31], v[216:219]
    v_mfma_f32_16x16x32_bf16 v[212:215], a[48:51], a[28:31], v[212:215]
    v_mfma_f32_16x16x32_bf16 v[208:211], a[44:47], a[28:31], v[208:211]
    buffer_load_dword v247, v249, s[56:59], 0 offen
    v_mfma_f32_16x16x32_bf16 v[204:207], a[40:43], a[28:31], v[204:207]
    v_mfma_f32_16x16x32_bf16 v[200:203], a[36:39], a[28:31], v[200:203]
    v_mfma_f32_16x16x32_bf16 v[196:199], a[32:35], a[28:31], v[196:199]
    s_waitcnt vmcnt(17) lgkmcnt(0)
    s_barrier
    v_mfma_f32_16x16x32_bf16 v[0:3], a[92:95], a[60:63], v[0:3]
    ds_read_b128 a[0:3], v224 offset:0
    v_mfma_f32_16x16x32_bf16 v[4:7], a[96:99], a[60:63], v[4:7]
    ds_read_b64_tr_b16 a[32:33], v227 offset:0
    v_mfma_f32_16x16x32_bf16 v[8:11], a[100:103], a[60:63], v[8:11]
    s_add_u32 m0, s37, 92208
    v_readlane_b32 s31, v255, 23
    s_nop 1
    s_mul_i32 s32, s31, 229376
    s_lshl_b32 s31, s31, 14
    v_mfma_f32_16x16x32_bf16 v[12:15], a[104:107], a[60:63], v[12:15]
    buffer_load_dwordx4 v234, s[16:19], s32 offen offset:0 lds
    v_mfma_f32_16x16x32_bf16 v[16:19], a[108:111], a[60:63], v[16:19]
    v_mfma_f32_16x16x32_bf16 v[20:23], a[112:115], a[60:63], v[20:23]
    ds_read_b64_tr_b16 a[34:35], v227 offset:3584
    v_mfma_f32_16x16x32_bf16 v[24:27], a[116:119], a[60:63], v[24:27]
    ds_read_b64_tr_b16 a[36:37], v227 offset:32
    v_mfma_f32_16x16x32_bf16 v[52:55], a[116:119], a[64:67], v[52:55]
    v_mfma_f32_16x16x32_bf16 v[48:51], a[112:115], a[64:67], v[48:51]
    ds_read_b64_tr_b16 a[38:39], v227 offset:3616
    v_mfma_f32_16x16x32_bf16 v[44:47], a[108:111], a[64:67], v[44:47]
    v_mfma_f32_16x16x32_bf16 v[40:43], a[104:107], a[64:67], v[40:43]
    buffer_load_dwordx4 v235, s[16:19], s32 offen offset:1024 lds
    v_mfma_f32_16x16x32_bf16 v[36:39], a[100:103], a[64:67], v[36:39]
    v_mfma_f32_16x16x32_bf16 v[32:35], a[96:99], a[64:67], v[32:35]
    ds_read_b64_tr_b16 a[40:41], v227 offset:64
    v_mfma_f32_16x16x32_bf16 v[28:31], a[92:95], a[64:67], v[28:31]
    ds_read_b64_tr_b16 a[42:43], v227 offset:3648
    v_mfma_f32_16x16x32_bf16 v[56:59], a[92:95], a[68:71], v[56:59]
    v_mfma_f32_16x16x32_bf16 v[60:63], a[96:99], a[68:71], v[60:63]
    ds_read_b64_tr_b16 a[44:45], v227 offset:7184
    v_mfma_f32_16x16x32_bf16 v[64:67], a[100:103], a[68:71], v[64:67]
    v_mfma_f32_16x16x32_bf16 v[68:71], a[104:107], a[68:71], v[68:71]
    buffer_load_dwordx4 v236, s[16:19], s32 offen offset:2048 lds
    v_mfma_f32_16x16x32_bf16 v[72:75], a[108:111], a[68:71], v[72:75]
    v_mfma_f32_16x16x32_bf16 v[76:79], a[112:115], a[68:71], v[76:79]
    ds_read_b64_tr_b16 a[46:47], v227 offset:10768
    v_mfma_f32_16x16x32_bf16 v[80:83], a[116:119], a[68:71], v[80:83]
    ds_read_b64_tr_b16 a[48:49], v227 offset:7216
    v_mfma_f32_16x16x32_bf16 v[108:111], a[116:119], a[72:75], v[108:111]
    v_mfma_f32_16x16x32_bf16 v[104:107], a[112:115], a[72:75], v[104:107]
    ds_read_b64_tr_b16 a[50:51], v227 offset:10800
    v_mfma_f32_16x16x32_bf16 v[100:103], a[108:111], a[72:75], v[100:103]
    v_mfma_f32_16x16x32_bf16 v[96:99], a[104:107], a[72:75], v[96:99]
    s_mov_b64 exec, s[38:39]
    buffer_load_dwordx4 v237, s[16:19], s32 offen offset:3072 lds
    s_mov_b64 exec, -1
    v_mfma_f32_16x16x32_bf16 v[92:95], a[100:103], a[72:75], v[92:95]
    v_mfma_f32_16x16x32_bf16 v[88:91], a[96:99], a[72:75], v[88:91]
    ds_read_b64_tr_b16 a[52:53], v227 offset:7248
    v_mfma_f32_16x16x32_bf16 v[84:87], a[92:95], a[72:75], v[84:87]
    ds_read_b64_tr_b16 a[54:55], v227 offset:10832
    v_mfma_f32_16x16x32_bf16 v[112:115], a[92:95], a[76:79], v[112:115]
    v_mfma_f32_16x16x32_bf16 v[116:119], a[96:99], a[76:79], v[116:119]
    ds_read_b64_tr_b16 a[56:57], v230 offset:0
    v_mfma_f32_16x16x32_bf16 v[120:123], a[100:103], a[76:79], v[120:123]
    s_add_u32 m0, s36, 92208
    v_mfma_f32_16x16x32_bf16 v[124:127], a[104:107], a[76:79], v[124:127]
    buffer_load_dwordx4 v233, s[12:15], s31 offen offset:0  lds
    v_mfma_f32_16x16x32_bf16 v[128:131], a[108:111], a[76:79], v[128:131]
    v_mfma_f32_16x16x32_bf16 v[132:135], a[112:115], a[76:79], v[132:135]
    ds_read_b64_tr_b16 a[58:59], v230 offset:3584
    v_mfma_f32_16x16x32_bf16 v[136:139], a[116:119], a[76:79], v[136:139]
    ds_read_b128 a[4:7], v224 offset:1024
    v_mfma_f32_16x16x32_bf16 v[164:167], a[116:119], a[80:83], v[164:167]
    ds_read_b128 a[8:11], v224 offset:2048
    v_mfma_f32_16x16x32_bf16 v[160:163], a[112:115], a[80:83], v[160:163]
    v_mfma_f32_16x16x32_bf16 v[156:159], a[108:111], a[80:83], v[156:159]
    v_mfma_f32_16x16x32_bf16 v[152:155], a[104:107], a[80:83], v[152:155]
    buffer_load_dwordx4 v233, s[12:15], s31 offen offset:1024  lds
    v_mfma_f32_16x16x32_bf16 v[148:151], a[100:103], a[80:83], v[148:151]
    v_mfma_f32_16x16x32_bf16 v[144:147], a[96:99], a[80:83], v[144:147]
    ds_read_b128 a[12:15], v224 offset:3072
    v_mfma_f32_16x16x32_bf16 v[140:143], a[92:95], a[80:83], v[140:143]
    ds_read_b128 a[16:19], v224 offset:4096
    v_mfma_f32_16x16x32_bf16 v[168:171], a[92:95], a[84:87], v[168:171]
    ds_read_b128 a[20:23], v224 offset:5120
    v_mfma_f32_16x16x32_bf16 v[172:175], a[96:99], a[84:87], v[172:175]
    v_mfma_f32_16x16x32_bf16 v[176:179], a[100:103], a[84:87], v[176:179]
    v_mfma_f32_16x16x32_bf16 v[180:183], a[104:107], a[84:87], v[180:183]
    buffer_load_dwordx4 v233, s[12:15], s31 offen offset:2048  lds
    v_mfma_f32_16x16x32_bf16 v[184:187], a[108:111], a[84:87], v[184:187]
    v_mfma_f32_16x16x32_bf16 v[188:191], a[112:115], a[84:87], v[188:191]
    ds_read_b128 a[24:27], v224 offset:6144
    v_mfma_f32_16x16x32_bf16 v[192:195], a[116:119], a[84:87], v[192:195]
    ds_read_b128 a[28:31], v224 offset:7168
    v_mfma_f32_16x16x32_bf16 v[220:223], a[116:119], a[88:91], v[220:223]
    v_mfma_f32_16x16x32_bf16 v[216:219], a[112:115], a[88:91], v[216:219]
    v_mfma_f32_16x16x32_bf16 v[212:215], a[108:111], a[88:91], v[212:215]
    v_mfma_f32_16x16x32_bf16 v[208:211], a[104:107], a[88:91], v[208:211]
    buffer_load_dwordx4 v233, s[12:15], s31 offen offset:3072  lds
    v_mfma_f32_16x16x32_bf16 v[204:207], a[100:103], a[88:91], v[204:207]
    v_mfma_f32_16x16x32_bf16 v[200:203], a[96:99], a[88:91], v[200:203]
    v_mfma_f32_16x16x32_bf16 v[196:199], a[92:95], a[88:91], v[196:199]
    s_waitcnt vmcnt(17) lgkmcnt(0)
    s_barrier
    v_mfma_f32_16x16x32_bf16 v[0:3], a[32:35], a[0:3], v[0:3]
    ds_read_b128 a[60:63], v224 offset:30736
    v_mfma_f32_16x16x32_bf16 v[4:7], a[36:39], a[0:3], v[4:7]
    ds_read_b64_tr_b16 a[92:93], v227 offset:30736
    v_mfma_f32_16x16x32_bf16 v[8:11], a[40:43], a[0:3], v[8:11]
    s_add_u32 m0, s37, 122944
    v_readlane_b32 s31, v255, 24
    s_nop 1
    s_mul_i32 s32, s31, 229376
    s_lshl_b32 s31, s31, 14
    v_mfma_f32_16x16x32_bf16 v[12:15], a[44:47], a[0:3], v[12:15]
    buffer_load_dwordx4 v234, s[16:19], s32 offen offset:0 lds
    v_mfma_f32_16x16x32_bf16 v[16:19], a[48:51], a[0:3], v[16:19]
    v_mfma_f32_16x16x32_bf16 v[20:23], a[52:55], a[0:3], v[20:23]
    ds_read_b64_tr_b16 a[94:95], v227 offset:34320
    v_mfma_f32_16x16x32_bf16 v[24:27], a[56:59], a[0:3], v[24:27]
    ds_read_b64_tr_b16 a[96:97], v227 offset:30768
    v_mfma_f32_16x16x32_bf16 v[52:55], a[56:59], a[4:7], v[52:55]
    v_mfma_f32_16x16x32_bf16 v[48:51], a[52:55], a[4:7], v[48:51]
    ds_read_b64_tr_b16 a[98:99], v227 offset:34352
    v_mfma_f32_16x16x32_bf16 v[44:47], a[48:51], a[4:7], v[44:47]
    v_mfma_f32_16x16x32_bf16 v[40:43], a[44:47], a[4:7], v[40:43]
    buffer_load_dwordx4 v235, s[16:19], s32 offen offset:1024 lds
    v_mfma_f32_16x16x32_bf16 v[36:39], a[40:43], a[4:7], v[36:39]
    v_mfma_f32_16x16x32_bf16 v[32:35], a[36:39], a[4:7], v[32:35]
    ds_read_b64_tr_b16 a[100:101], v227 offset:30800
    v_mfma_f32_16x16x32_bf16 v[28:31], a[32:35], a[4:7], v[28:31]
    ds_read_b64_tr_b16 a[102:103], v227 offset:34384
    v_mfma_f32_16x16x32_bf16 v[56:59], a[32:35], a[8:11], v[56:59]
    v_mfma_f32_16x16x32_bf16 v[60:63], a[36:39], a[8:11], v[60:63]
    ds_read_b64_tr_b16 a[104:105], v227 offset:37920
    v_mfma_f32_16x16x32_bf16 v[64:67], a[40:43], a[8:11], v[64:67]
    v_mfma_f32_16x16x32_bf16 v[68:71], a[44:47], a[8:11], v[68:71]
    buffer_load_dwordx4 v236, s[16:19], s32 offen offset:2048 lds
    v_mfma_f32_16x16x32_bf16 v[72:75], a[48:51], a[8:11], v[72:75]
    v_mfma_f32_16x16x32_bf16 v[76:79], a[52:55], a[8:11], v[76:79]
    ds_read_b64_tr_b16 a[106:107], v227 offset:41504
    v_mfma_f32_16x16x32_bf16 v[80:83], a[56:59], a[8:11], v[80:83]
    ds_read_b64_tr_b16 a[108:109], v227 offset:37952
    v_mfma_f32_16x16x32_bf16 v[108:111], a[56:59], a[12:15], v[108:111]
    v_mfma_f32_16x16x32_bf16 v[104:107], a[52:55], a[12:15], v[104:107]
    ds_read_b64_tr_b16 a[110:111], v227 offset:41536
    v_mfma_f32_16x16x32_bf16 v[100:103], a[48:51], a[12:15], v[100:103]
    v_mfma_f32_16x16x32_bf16 v[96:99], a[44:47], a[12:15], v[96:99]
    s_mov_b64 exec, s[38:39]
    buffer_load_dwordx4 v237, s[16:19], s32 offen offset:3072 lds
    s_mov_b64 exec, -1
    v_mfma_f32_16x16x32_bf16 v[92:95], a[40:43], a[12:15], v[92:95]
    v_mfma_f32_16x16x32_bf16 v[88:91], a[36:39], a[12:15], v[88:91]
    ds_read_b64_tr_b16 a[112:113], v227 offset:37984
    v_mfma_f32_16x16x32_bf16 v[84:87], a[32:35], a[12:15], v[84:87]
    ds_read_b64_tr_b16 a[114:115], v227 offset:41568
    v_mfma_f32_16x16x32_bf16 v[112:115], a[32:35], a[16:19], v[112:115]
    v_mfma_f32_16x16x32_bf16 v[116:119], a[36:39], a[16:19], v[116:119]
    ds_read_b64_tr_b16 a[116:117], v230 offset:30736
    v_mfma_f32_16x16x32_bf16 v[120:123], a[40:43], a[16:19], v[120:123]
    s_add_u32 m0, s36, 122944
    v_mfma_f32_16x16x32_bf16 v[124:127], a[44:47], a[16:19], v[124:127]
    buffer_load_dwordx4 v233, s[12:15], s31 offen offset:0  lds
    v_mfma_f32_16x16x32_bf16 v[128:131], a[48:51], a[16:19], v[128:131]
    v_mfma_f32_16x16x32_bf16 v[132:135], a[52:55], a[16:19], v[132:135]
    ds_read_b64_tr_b16 a[118:119], v230 offset:34320
    v_mfma_f32_16x16x32_bf16 v[136:139], a[56:59], a[16:19], v[136:139]
    ds_read_b128 a[64:67], v224 offset:31760
    v_mfma_f32_16x16x32_bf16 v[164:167], a[56:59], a[20:23], v[164:167]
    ds_read_b128 a[68:71], v224 offset:32784
    v_mfma_f32_16x16x32_bf16 v[160:163], a[52:55], a[20:23], v[160:163]
    v_mfma_f32_16x16x32_bf16 v[156:159], a[48:51], a[20:23], v[156:159]
    v_mfma_f32_16x16x32_bf16 v[152:155], a[44:47], a[20:23], v[152:155]
    buffer_load_dwordx4 v233, s[12:15], s31 offen offset:1024  lds
    v_mfma_f32_16x16x32_bf16 v[148:151], a[40:43], a[20:23], v[148:151]
    v_mfma_f32_16x16x32_bf16 v[144:147], a[36:39], a[20:23], v[144:147]
    ds_read_b128 a[72:75], v224 offset:33808
    v_mfma_f32_16x16x32_bf16 v[140:143], a[32:35], a[20:23], v[140:143]
    ds_read_b128 a[76:79], v224 offset:34832
    v_mfma_f32_16x16x32_bf16 v[168:171], a[32:35], a[24:27], v[168:171]
    ds_read_b128 a[80:83], v224 offset:35856
    v_mfma_f32_16x16x32_bf16 v[172:175], a[36:39], a[24:27], v[172:175]
    v_mfma_f32_16x16x32_bf16 v[176:179], a[40:43], a[24:27], v[176:179]
    v_mfma_f32_16x16x32_bf16 v[180:183], a[44:47], a[24:27], v[180:183]
    buffer_load_dwordx4 v233, s[12:15], s31 offen offset:2048  lds
    v_mfma_f32_16x16x32_bf16 v[184:187], a[48:51], a[24:27], v[184:187]
    v_mfma_f32_16x16x32_bf16 v[188:191], a[52:55], a[24:27], v[188:191]
    ds_read_b128 a[84:87], v224 offset:36880
    v_mfma_f32_16x16x32_bf16 v[192:195], a[56:59], a[24:27], v[192:195]
    ds_read_b128 a[88:91], v224 offset:37904
    v_mfma_f32_16x16x32_bf16 v[220:223], a[56:59], a[28:31], v[220:223]
    v_mfma_f32_16x16x32_bf16 v[216:219], a[52:55], a[28:31], v[216:219]
    v_mfma_f32_16x16x32_bf16 v[212:215], a[48:51], a[28:31], v[212:215]
    v_mfma_f32_16x16x32_bf16 v[208:211], a[44:47], a[28:31], v[208:211]
    buffer_load_dwordx4 v233, s[12:15], s31 offen offset:3072  lds
    v_mfma_f32_16x16x32_bf16 v[204:207], a[40:43], a[28:31], v[204:207]
    v_mfma_f32_16x16x32_bf16 v[200:203], a[36:39], a[28:31], v[200:203]
    v_mfma_f32_16x16x32_bf16 v[196:199], a[32:35], a[28:31], v[196:199]
    s_waitcnt vmcnt(17) lgkmcnt(0)
    s_barrier
    v_mfma_f32_16x16x32_bf16 v[0:3], a[92:95], a[60:63], v[0:3]
    ds_read_b128 a[0:3], v225 offset:0
    v_mfma_f32_16x16x32_bf16 v[4:7], a[96:99], a[60:63], v[4:7]
    ds_read_b64_tr_b16 a[32:33], v228 offset:0
    v_mfma_f32_16x16x32_bf16 v[8:11], a[100:103], a[60:63], v[8:11]
    s_add_u32 m0, s37, 0
    v_readlane_b32 s31, v255, 25
    s_nop 1
    s_mul_i32 s32, s31, 229376
    s_lshl_b32 s31, s31, 14
    v_mfma_f32_16x16x32_bf16 v[12:15], a[104:107], a[60:63], v[12:15]
    buffer_load_dwordx4 v234, s[16:19], s32 offen offset:0 lds
    v_mfma_f32_16x16x32_bf16 v[16:19], a[108:111], a[60:63], v[16:19]
    v_mfma_f32_16x16x32_bf16 v[20:23], a[112:115], a[60:63], v[20:23]
    ds_read_b64_tr_b16 a[34:35], v228 offset:3584
    v_mfma_f32_16x16x32_bf16 v[24:27], a[116:119], a[60:63], v[24:27]
    ds_read_b64_tr_b16 a[36:37], v228 offset:32
    v_mfma_f32_16x16x32_bf16 v[52:55], a[116:119], a[64:67], v[52:55]
    v_mfma_f32_16x16x32_bf16 v[48:51], a[112:115], a[64:67], v[48:51]
    ds_read_b64_tr_b16 a[38:39], v228 offset:3616
    v_mfma_f32_16x16x32_bf16 v[44:47], a[108:111], a[64:67], v[44:47]
    v_mfma_f32_16x16x32_bf16 v[40:43], a[104:107], a[64:67], v[40:43]
    buffer_load_dwordx4 v235, s[16:19], s32 offen offset:1024 lds
    v_mfma_f32_16x16x32_bf16 v[36:39], a[100:103], a[64:67], v[36:39]
    v_mfma_f32_16x16x32_bf16 v[32:35], a[96:99], a[64:67], v[32:35]
    ds_read_b64_tr_b16 a[40:41], v228 offset:64
    v_mfma_f32_16x16x32_bf16 v[28:31], a[92:95], a[64:67], v[28:31]
    ds_read_b64_tr_b16 a[42:43], v228 offset:3648
    v_mfma_f32_16x16x32_bf16 v[56:59], a[92:95], a[68:71], v[56:59]
    v_mfma_f32_16x16x32_bf16 v[60:63], a[96:99], a[68:71], v[60:63]
    ds_read_b64_tr_b16 a[44:45], v228 offset:7184
    v_mfma_f32_16x16x32_bf16 v[64:67], a[100:103], a[68:71], v[64:67]
    v_mfma_f32_16x16x32_bf16 v[68:71], a[104:107], a[68:71], v[68:71]
    buffer_load_dwordx4 v236, s[16:19], s32 offen offset:2048 lds
    v_mfma_f32_16x16x32_bf16 v[72:75], a[108:111], a[68:71], v[72:75]
    v_mfma_f32_16x16x32_bf16 v[76:79], a[112:115], a[68:71], v[76:79]
    ds_read_b64_tr_b16 a[46:47], v228 offset:10768
    v_mfma_f32_16x16x32_bf16 v[80:83], a[116:119], a[68:71], v[80:83]
    ds_read_b64_tr_b16 a[48:49], v228 offset:7216
    v_mfma_f32_16x16x32_bf16 v[108:111], a[116:119], a[72:75], v[108:111]
    v_mfma_f32_16x16x32_bf16 v[104:107], a[112:115], a[72:75], v[104:107]
    ds_read_b64_tr_b16 a[50:51], v228 offset:10800
    v_mfma_f32_16x16x32_bf16 v[100:103], a[108:111], a[72:75], v[100:103]
    v_mfma_f32_16x16x32_bf16 v[96:99], a[104:107], a[72:75], v[96:99]
    s_mov_b64 exec, s[38:39]
    buffer_load_dwordx4 v237, s[16:19], s32 offen offset:3072 lds
    s_mov_b64 exec, -1
    v_mfma_f32_16x16x32_bf16 v[92:95], a[100:103], a[72:75], v[92:95]
    v_mfma_f32_16x16x32_bf16 v[88:91], a[96:99], a[72:75], v[88:91]
    ds_read_b64_tr_b16 a[52:53], v228 offset:7248
    v_mfma_f32_16x16x32_bf16 v[84:87], a[92:95], a[72:75], v[84:87]
    ds_read_b64_tr_b16 a[54:55], v228 offset:10832
    v_mfma_f32_16x16x32_bf16 v[112:115], a[92:95], a[76:79], v[112:115]
    v_mfma_f32_16x16x32_bf16 v[116:119], a[96:99], a[76:79], v[116:119]
    ds_read_b64_tr_b16 a[56:57], v231 offset:0
    v_mfma_f32_16x16x32_bf16 v[120:123], a[100:103], a[76:79], v[120:123]
    s_add_u32 m0, s36, 0
    v_mfma_f32_16x16x32_bf16 v[124:127], a[104:107], a[76:79], v[124:127]
    buffer_load_dwordx4 v233, s[12:15], s31 offen offset:0  lds
    v_mfma_f32_16x16x32_bf16 v[128:131], a[108:111], a[76:79], v[128:131]
    v_mfma_f32_16x16x32_bf16 v[132:135], a[112:115], a[76:79], v[132:135]
    ds_read_b64_tr_b16 a[58:59], v231 offset:3584
    v_mfma_f32_16x16x32_bf16 v[136:139], a[116:119], a[76:79], v[136:139]
    ds_read_b128 a[4:7], v225 offset:1024
    v_mfma_f32_16x16x32_bf16 v[164:167], a[116:119], a[80:83], v[164:167]
    ds_read_b128 a[8:11], v225 offset:2048
    v_mfma_f32_16x16x32_bf16 v[160:163], a[112:115], a[80:83], v[160:163]
    v_mfma_f32_16x16x32_bf16 v[156:159], a[108:111], a[80:83], v[156:159]
    v_mfma_f32_16x16x32_bf16 v[152:155], a[104:107], a[80:83], v[152:155]
    buffer_load_dwordx4 v233, s[12:15], s31 offen offset:1024  lds
    v_mfma_f32_16x16x32_bf16 v[148:151], a[100:103], a[80:83], v[148:151]
    v_mfma_f32_16x16x32_bf16 v[144:147], a[96:99], a[80:83], v[144:147]
    ds_read_b128 a[12:15], v225 offset:3072
    v_mfma_f32_16x16x32_bf16 v[140:143], a[92:95], a[80:83], v[140:143]
    ds_read_b128 a[16:19], v225 offset:4096
    v_mfma_f32_16x16x32_bf16 v[168:171], a[92:95], a[84:87], v[168:171]
    ds_read_b128 a[20:23], v225 offset:5120
    v_mfma_f32_16x16x32_bf16 v[172:175], a[96:99], a[84:87], v[172:175]
    v_mfma_f32_16x16x32_bf16 v[176:179], a[100:103], a[84:87], v[176:179]
    v_mfma_f32_16x16x32_bf16 v[180:183], a[104:107], a[84:87], v[180:183]
    buffer_load_dwordx4 v233, s[12:15], s31 offen offset:2048  lds
    v_mfma_f32_16x16x32_bf16 v[184:187], a[108:111], a[84:87], v[184:187]
    v_mfma_f32_16x16x32_bf16 v[188:191], a[112:115], a[84:87], v[188:191]
    ds_read_b128 a[24:27], v225 offset:6144
    v_mfma_f32_16x16x32_bf16 v[192:195], a[116:119], a[84:87], v[192:195]
    ds_read_b128 a[28:31], v225 offset:7168
    v_mfma_f32_16x16x32_bf16 v[220:223], a[116:119], a[88:91], v[220:223]
    v_mfma_f32_16x16x32_bf16 v[216:219], a[112:115], a[88:91], v[216:219]
    v_mfma_f32_16x16x32_bf16 v[212:215], a[108:111], a[88:91], v[212:215]
    v_mfma_f32_16x16x32_bf16 v[208:211], a[104:107], a[88:91], v[208:211]
    buffer_load_dwordx4 v233, s[12:15], s31 offen offset:3072  lds
    v_mfma_f32_16x16x32_bf16 v[204:207], a[100:103], a[88:91], v[204:207]
    v_mfma_f32_16x16x32_bf16 v[200:203], a[96:99], a[88:91], v[200:203]
    v_mfma_f32_16x16x32_bf16 v[196:199], a[92:95], a[88:91], v[196:199]
    s_waitcnt vmcnt(16) lgkmcnt(0)
    s_barrier
    v_mfma_f32_16x16x32_bf16 v[0:3], a[32:35], a[0:3], v[0:3]
    ds_read_b128 a[60:63], v225 offset:30736
    v_mfma_f32_16x16x32_bf16 v[4:7], a[36:39], a[0:3], v[4:7]
    ds_read_b64_tr_b16 a[92:93], v228 offset:30736
    v_mfma_f32_16x16x32_bf16 v[8:11], a[40:43], a[0:3], v[8:11]
    s_add_u32 m0, s37, 30736
    v_readlane_b32 s31, v255, 26
    s_nop 1
    s_mul_i32 s32, s31, 229376
    s_lshl_b32 s31, s31, 14
    v_mfma_f32_16x16x32_bf16 v[12:15], a[44:47], a[0:3], v[12:15]
    buffer_load_dwordx4 v234, s[16:19], s32 offen offset:0 lds
    v_mfma_f32_16x16x32_bf16 v[16:19], a[48:51], a[0:3], v[16:19]
    v_mfma_f32_16x16x32_bf16 v[20:23], a[52:55], a[0:3], v[20:23]
    ds_read_b64_tr_b16 a[94:95], v228 offset:34320
    v_mfma_f32_16x16x32_bf16 v[24:27], a[56:59], a[0:3], v[24:27]
    ds_read_b64_tr_b16 a[96:97], v228 offset:30768
    v_mfma_f32_16x16x32_bf16 v[52:55], a[56:59], a[4:7], v[52:55]
    v_mfma_f32_16x16x32_bf16 v[48:51], a[52:55], a[4:7], v[48:51]
    ds_read_b64_tr_b16 a[98:99], v228 offset:34352
    v_mfma_f32_16x16x32_bf16 v[44:47], a[48:51], a[4:7], v[44:47]
    v_mfma_f32_16x16x32_bf16 v[40:43], a[44:47], a[4:7], v[40:43]
    buffer_load_dwordx4 v235, s[16:19], s32 offen offset:1024 lds
    v_mfma_f32_16x16x32_bf16 v[36:39], a[40:43], a[4:7], v[36:39]
    v_mfma_f32_16x16x32_bf16 v[32:35], a[36:39], a[4:7], v[32:35]
    ds_read_b64_tr_b16 a[100:101], v228 offset:30800
    v_mfma_f32_16x16x32_bf16 v[28:31], a[32:35], a[4:7], v[28:31]
    ds_read_b64_tr_b16 a[102:103], v228 offset:34384
    v_mfma_f32_16x16x32_bf16 v[56:59], a[32:35], a[8:11], v[56:59]
    v_mfma_f32_16x16x32_bf16 v[60:63], a[36:39], a[8:11], v[60:63]
    ds_read_b64_tr_b16 a[104:105], v228 offset:37920
    v_mfma_f32_16x16x32_bf16 v[64:67], a[40:43], a[8:11], v[64:67]
    v_mfma_f32_16x16x32_bf16 v[68:71], a[44:47], a[8:11], v[68:71]
    buffer_load_dwordx4 v236, s[16:19], s32 offen offset:2048 lds
    v_mfma_f32_16x16x32_bf16 v[72:75], a[48:51], a[8:11], v[72:75]
    v_mfma_f32_16x16x32_bf16 v[76:79], a[52:55], a[8:11], v[76:79]
    ds_read_b64_tr_b16 a[106:107], v228 offset:41504
    v_mfma_f32_16x16x32_bf16 v[80:83], a[56:59], a[8:11], v[80:83]
    ds_read_b64_tr_b16 a[108:109], v228 offset:37952
    v_mfma_f32_16x16x32_bf16 v[108:111], a[56:59], a[12:15], v[108:111]
    v_mfma_f32_16x16x32_bf16 v[104:107], a[52:55], a[12:15], v[104:107]
    ds_read_b64_tr_b16 a[110:111], v228 offset:41536
    v_mfma_f32_16x16x32_bf16 v[100:103], a[48:51], a[12:15], v[100:103]
    v_mfma_f32_16x16x32_bf16 v[96:99], a[44:47], a[12:15], v[96:99]
    s_mov_b64 exec, s[38:39]
    buffer_load_dwordx4 v237, s[16:19], s32 offen offset:3072 lds
    s_mov_b64 exec, -1
    v_mfma_f32_16x16x32_bf16 v[92:95], a[40:43], a[12:15], v[92:95]
    v_mfma_f32_16x16x32_bf16 v[88:91], a[36:39], a[12:15], v[88:91]
    ds_read_b64_tr_b16 a[112:113], v228 offset:37984
    v_mfma_f32_16x16x32_bf16 v[84:87], a[32:35], a[12:15], v[84:87]
    ds_read_b64_tr_b16 a[114:115], v228 offset:41568
    v_mfma_f32_16x16x32_bf16 v[112:115], a[32:35], a[16:19], v[112:115]
    v_mfma_f32_16x16x32_bf16 v[116:119], a[36:39], a[16:19], v[116:119]
    ds_read_b64_tr_b16 a[116:117], v231 offset:30736
    v_mfma_f32_16x16x32_bf16 v[120:123], a[40:43], a[16:19], v[120:123]
    s_add_u32 m0, s36, 30736
    v_mfma_f32_16x16x32_bf16 v[124:127], a[44:47], a[16:19], v[124:127]
    buffer_load_dwordx4 v233, s[12:15], s31 offen offset:0  lds
    v_mfma_f32_16x16x32_bf16 v[128:131], a[48:51], a[16:19], v[128:131]
    v_mfma_f32_16x16x32_bf16 v[132:135], a[52:55], a[16:19], v[132:135]
    ds_read_b64_tr_b16 a[118:119], v231 offset:34320
    v_mfma_f32_16x16x32_bf16 v[136:139], a[56:59], a[16:19], v[136:139]
    ds_read_b128 a[64:67], v225 offset:31760
    v_mfma_f32_16x16x32_bf16 v[164:167], a[56:59], a[20:23], v[164:167]
    ds_read_b128 a[68:71], v225 offset:32784
    v_mfma_f32_16x16x32_bf16 v[160:163], a[52:55], a[20:23], v[160:163]
    v_mfma_f32_16x16x32_bf16 v[156:159], a[48:51], a[20:23], v[156:159]
    v_mfma_f32_16x16x32_bf16 v[152:155], a[44:47], a[20:23], v[152:155]
    buffer_load_dwordx4 v233, s[12:15], s31 offen offset:1024  lds
    v_mfma_f32_16x16x32_bf16 v[148:151], a[40:43], a[20:23], v[148:151]
    v_mfma_f32_16x16x32_bf16 v[144:147], a[36:39], a[20:23], v[144:147]
    ds_read_b128 a[72:75], v225 offset:33808
    v_mfma_f32_16x16x32_bf16 v[140:143], a[32:35], a[20:23], v[140:143]
    ds_read_b128 a[76:79], v225 offset:34832
    v_mfma_f32_16x16x32_bf16 v[168:171], a[32:35], a[24:27], v[168:171]
    ds_read_b128 a[80:83], v225 offset:35856
    v_mfma_f32_16x16x32_bf16 v[172:175], a[36:39], a[24:27], v[172:175]
    v_mfma_f32_16x16x32_bf16 v[176:179], a[40:43], a[24:27], v[176:179]
    v_mfma_f32_16x16x32_bf16 v[180:183], a[44:47], a[24:27], v[180:183]
    buffer_load_dwordx4 v233, s[12:15], s31 offen offset:2048  lds
    v_mfma_f32_16x16x32_bf16 v[184:187], a[48:51], a[24:27], v[184:187]
    v_mfma_f32_16x16x32_bf16 v[188:191], a[52:55], a[24:27], v[188:191]
    ds_read_b128 a[84:87], v225 offset:36880
    v_mfma_f32_16x16x32_bf16 v[192:195], a[56:59], a[24:27], v[192:195]
    ds_read_b128 a[88:91], v225 offset:37904
    v_mfma_f32_16x16x32_bf16 v[220:223], a[56:59], a[28:31], v[220:223]
    v_mfma_f32_16x16x32_bf16 v[216:219], a[52:55], a[28:31], v[216:219]
    v_mfma_f32_16x16x32_bf16 v[212:215], a[48:51], a[28:31], v[212:215]
    v_mfma_f32_16x16x32_bf16 v[208:211], a[44:47], a[28:31], v[208:211]
    buffer_load_dwordx4 v233, s[12:15], s31 offen offset:3072  lds
    v_mfma_f32_16x16x32_bf16 v[204:207], a[40:43], a[28:31], v[204:207]
    v_mfma_f32_16x16x32_bf16 v[200:203], a[36:39], a[28:31], v[200:203]
    v_mfma_f32_16x16x32_bf16 v[196:199], a[32:35], a[28:31], v[196:199]
    s_waitcnt vmcnt(16) lgkmcnt(0)
    s_barrier
    v_mfma_f32_16x16x32_bf16 v[0:3], a[92:95], a[60:63], v[0:3]
    ds_read_b128 a[0:3], v226 offset:0
    v_mfma_f32_16x16x32_bf16 v[4:7], a[96:99], a[60:63], v[4:7]
    ds_read_b64_tr_b16 a[32:33], v229 offset:0
    v_mfma_f32_16x16x32_bf16 v[8:11], a[100:103], a[60:63], v[8:11]
    s_add_u32 m0, s37, 61472
    v_readlane_b32 s31, v255, 27
    s_nop 1
    s_mul_i32 s32, s31, 229376
    s_lshl_b32 s31, s31, 14
    v_mfma_f32_16x16x32_bf16 v[12:15], a[104:107], a[60:63], v[12:15]
    buffer_load_dwordx4 v234, s[16:19], s32 offen offset:0 lds
    v_mfma_f32_16x16x32_bf16 v[16:19], a[108:111], a[60:63], v[16:19]
    v_mfma_f32_16x16x32_bf16 v[20:23], a[112:115], a[60:63], v[20:23]
    ds_read_b64_tr_b16 a[34:35], v229 offset:3584
    v_mfma_f32_16x16x32_bf16 v[24:27], a[116:119], a[60:63], v[24:27]
    ds_read_b64_tr_b16 a[36:37], v229 offset:32
    v_mfma_f32_16x16x32_bf16 v[52:55], a[116:119], a[64:67], v[52:55]
    v_mfma_f32_16x16x32_bf16 v[48:51], a[112:115], a[64:67], v[48:51]
    ds_read_b64_tr_b16 a[38:39], v229 offset:3616
    v_mfma_f32_16x16x32_bf16 v[44:47], a[108:111], a[64:67], v[44:47]
    v_mfma_f32_16x16x32_bf16 v[40:43], a[104:107], a[64:67], v[40:43]
    buffer_load_dwordx4 v235, s[16:19], s32 offen offset:1024 lds
    v_mfma_f32_16x16x32_bf16 v[36:39], a[100:103], a[64:67], v[36:39]
    v_mfma_f32_16x16x32_bf16 v[32:35], a[96:99], a[64:67], v[32:35]
    ds_read_b64_tr_b16 a[40:41], v229 offset:64
    v_mfma_f32_16x16x32_bf16 v[28:31], a[92:95], a[64:67], v[28:31]
    ds_read_b64_tr_b16 a[42:43], v229 offset:3648
    v_mfma_f32_16x16x32_bf16 v[56:59], a[92:95], a[68:71], v[56:59]
    v_mfma_f32_16x16x32_bf16 v[60:63], a[96:99], a[68:71], v[60:63]
    ds_read_b64_tr_b16 a[44:45], v229 offset:7184
    v_mfma_f32_16x16x32_bf16 v[64:67], a[100:103], a[68:71], v[64:67]
    v_mfma_f32_16x16x32_bf16 v[68:71], a[104:107], a[68:71], v[68:71]
    buffer_load_dwordx4 v236, s[16:19], s32 offen offset:2048 lds
    v_mfma_f32_16x16x32_bf16 v[72:75], a[108:111], a[68:71], v[72:75]
    v_mfma_f32_16x16x32_bf16 v[76:79], a[112:115], a[68:71], v[76:79]
    ds_read_b64_tr_b16 a[46:47], v229 offset:10768
    v_mfma_f32_16x16x32_bf16 v[80:83], a[116:119], a[68:71], v[80:83]
    ds_read_b64_tr_b16 a[48:49], v229 offset:7216
    v_mfma_f32_16x16x32_bf16 v[108:111], a[116:119], a[72:75], v[108:111]
    v_mfma_f32_16x16x32_bf16 v[104:107], a[112:115], a[72:75], v[104:107]
    ds_read_b64_tr_b16 a[50:51], v229 offset:10800
    v_mfma_f32_16x16x32_bf16 v[100:103], a[108:111], a[72:75], v[100:103]
    v_mfma_f32_16x16x32_bf16 v[96:99], a[104:107], a[72:75], v[96:99]
    s_mov_b64 exec, s[38:39]
    buffer_load_dwordx4 v237, s[16:19], s32 offen offset:3072 lds
    s_mov_b64 exec, -1
    v_mfma_f32_16x16x32_bf16 v[92:95], a[100:103], a[72:75], v[92:95]
    v_mfma_f32_16x16x32_bf16 v[88:91], a[96:99], a[72:75], v[88:91]
    ds_read_b64_tr_b16 a[52:53], v229 offset:7248
    v_mfma_f32_16x16x32_bf16 v[84:87], a[92:95], a[72:75], v[84:87]
    ds_read_b64_tr_b16 a[54:55], v229 offset:10832
    v_mfma_f32_16x16x32_bf16 v[112:115], a[92:95], a[76:79], v[112:115]
    v_mfma_f32_16x16x32_bf16 v[116:119], a[96:99], a[76:79], v[116:119]
    ds_read_b64_tr_b16 a[56:57], v232 offset:0
    v_mfma_f32_16x16x32_bf16 v[120:123], a[100:103], a[76:79], v[120:123]
    s_add_u32 m0, s36, 61472
    v_mfma_f32_16x16x32_bf16 v[124:127], a[104:107], a[76:79], v[124:127]
    buffer_load_dwordx4 v233, s[12:15], s31 offen offset:0  lds
    v_mfma_f32_16x16x32_bf16 v[128:131], a[108:111], a[76:79], v[128:131]
    v_mfma_f32_16x16x32_bf16 v[132:135], a[112:115], a[76:79], v[132:135]
    ds_read_b64_tr_b16 a[58:59], v232 offset:3584
    v_mfma_f32_16x16x32_bf16 v[136:139], a[116:119], a[76:79], v[136:139]
    ds_read_b128 a[4:7], v226 offset:1024
    v_mfma_f32_16x16x32_bf16 v[164:167], a[116:119], a[80:83], v[164:167]
    ds_read_b128 a[8:11], v226 offset:2048
    v_mfma_f32_16x16x32_bf16 v[160:163], a[112:115], a[80:83], v[160:163]
    v_mfma_f32_16x16x32_bf16 v[156:159], a[108:111], a[80:83], v[156:159]
    v_mfma_f32_16x16x32_bf16 v[152:155], a[104:107], a[80:83], v[152:155]
    buffer_load_dwordx4 v233, s[12:15], s31 offen offset:1024  lds
    v_mfma_f32_16x16x32_bf16 v[148:151], a[100:103], a[80:83], v[148:151]
    v_mfma_f32_16x16x32_bf16 v[144:147], a[96:99], a[80:83], v[144:147]
    ds_read_b128 a[12:15], v226 offset:3072
    v_mfma_f32_16x16x32_bf16 v[140:143], a[92:95], a[80:83], v[140:143]
    ds_read_b128 a[16:19], v226 offset:4096
    v_mfma_f32_16x16x32_bf16 v[168:171], a[92:95], a[84:87], v[168:171]
    ds_read_b128 a[20:23], v226 offset:5120
    v_mfma_f32_16x16x32_bf16 v[172:175], a[96:99], a[84:87], v[172:175]
    v_mfma_f32_16x16x32_bf16 v[176:179], a[100:103], a[84:87], v[176:179]
    v_mfma_f32_16x16x32_bf16 v[180:183], a[104:107], a[84:87], v[180:183]
    buffer_load_dwordx4 v233, s[12:15], s31 offen offset:2048  lds
    v_mfma_f32_16x16x32_bf16 v[184:187], a[108:111], a[84:87], v[184:187]
    v_mfma_f32_16x16x32_bf16 v[188:191], a[112:115], a[84:87], v[188:191]
    ds_read_b128 a[24:27], v226 offset:6144
    v_mfma_f32_16x16x32_bf16 v[192:195], a[116:119], a[84:87], v[192:195]
    ds_read_b128 a[28:31], v226 offset:7168
    v_mfma_f32_16x16x32_bf16 v[220:223], a[116:119], a[88:91], v[220:223]
    v_mfma_f32_16x16x32_bf16 v[216:219], a[112:115], a[88:91], v[216:219]
    v_mfma_f32_16x16x32_bf16 v[212:215], a[108:111], a[88:91], v[212:215]
    v_mfma_f32_16x16x32_bf16 v[208:211], a[104:107], a[88:91], v[208:211]
    buffer_load_dwordx4 v233, s[12:15], s31 offen offset:3072  lds
    v_mfma_f32_16x16x32_bf16 v[204:207], a[100:103], a[88:91], v[204:207]
    v_mfma_f32_16x16x32_bf16 v[200:203], a[96:99], a[88:91], v[200:203]
    v_mfma_f32_16x16x32_bf16 v[196:199], a[92:95], a[88:91], v[196:199]
    s_waitcnt vmcnt(16) lgkmcnt(0)
    s_barrier
    v_mfma_f32_16x16x32_bf16 v[0:3], a[32:35], a[0:3], v[0:3]
    ds_read_b128 a[60:63], v224 offset:0
    v_mfma_f32_16x16x32_bf16 v[4:7], a[36:39], a[0:3], v[4:7]
    ds_read_b64_tr_b16 a[92:93], v227 offset:0
    v_mfma_f32_16x16x32_bf16 v[8:11], a[40:43], a[0:3], v[8:11]
    s_add_u32 m0, s37, 92208
    v_readlane_b32 s31, v255, 28
    s_nop 1
    s_mul_i32 s32, s31, 229376
    s_lshl_b32 s31, s31, 14
    v_mfma_f32_16x16x32_bf16 v[12:15], a[44:47], a[0:3], v[12:15]
    buffer_load_dwordx4 v234, s[16:19], s32 offen offset:0 lds
    v_mfma_f32_16x16x32_bf16 v[16:19], a[48:51], a[0:3], v[16:19]
    v_mfma_f32_16x16x32_bf16 v[20:23], a[52:55], a[0:3], v[20:23]
    ds_read_b64_tr_b16 a[94:95], v227 offset:3584
    v_mfma_f32_16x16x32_bf16 v[24:27], a[56:59], a[0:3], v[24:27]
    ds_read_b64_tr_b16 a[96:97], v227 offset:32
    v_mfma_f32_16x16x32_bf16 v[52:55], a[56:59], a[4:7], v[52:55]
    v_mfma_f32_16x16x32_bf16 v[48:51], a[52:55], a[4:7], v[48:51]
    ds_read_b64_tr_b16 a[98:99], v227 offset:3616
    v_mfma_f32_16x16x32_bf16 v[44:47], a[48:51], a[4:7], v[44:47]
    v_mfma_f32_16x16x32_bf16 v[40:43], a[44:47], a[4:7], v[40:43]
    buffer_load_dwordx4 v235, s[16:19], s32 offen offset:1024 lds
    v_mfma_f32_16x16x32_bf16 v[36:39], a[40:43], a[4:7], v[36:39]
    v_mfma_f32_16x16x32_bf16 v[32:35], a[36:39], a[4:7], v[32:35]
    ds_read_b64_tr_b16 a[100:101], v227 offset:64
    v_mfma_f32_16x16x32_bf16 v[28:31], a[32:35], a[4:7], v[28:31]
    ds_read_b64_tr_b16 a[102:103], v227 offset:3648
    v_mfma_f32_16x16x32_bf16 v[56:59], a[32:35], a[8:11], v[56:59]
    v_mfma_f32_16x16x32_bf16 v[60:63], a[36:39], a[8:11], v[60:63]
    ds_read_b64_tr_b16 a[104:105], v227 offset:7184
    v_mfma_f32_16x16x32_bf16 v[64:67], a[40:43], a[8:11], v[64:67]
    v_mfma_f32_16x16x32_bf16 v[68:71], a[44:47], a[8:11], v[68:71]
    buffer_load_dwordx4 v236, s[16:19], s32 offen offset:2048 lds
    v_mfma_f32_16x16x32_bf16 v[72:75], a[48:51], a[8:11], v[72:75]
    v_mfma_f32_16x16x32_bf16 v[76:79], a[52:55], a[8:11], v[76:79]
    ds_read_b64_tr_b16 a[106:107], v227 offset:10768
    v_mfma_f32_16x16x32_bf16 v[80:83], a[56:59], a[8:11], v[80:83]
    ds_read_b64_tr_b16 a[108:109], v227 offset:7216
    v_mfma_f32_16x16x32_bf16 v[108:111], a[56:59], a[12:15], v[108:111]
    v_mfma_f32_16x16x32_bf16 v[104:107], a[52:55], a[12:15], v[104:107]
    ds_read_b64_tr_b16 a[110:111], v227 offset:10800
    v_mfma_f32_16x16x32_bf16 v[100:103], a[48:51], a[12:15], v[100:103]
    v_mfma_f32_16x16x32_bf16 v[96:99], a[44:47], a[12:15], v[96:99]
    s_mov_b64 exec, s[38:39]
    buffer_load_dwordx4 v237, s[16:19], s32 offen offset:3072 lds
    s_mov_b64 exec, -1
    v_mfma_f32_16x16x32_bf16 v[92:95], a[40:43], a[12:15], v[92:95]
    v_mfma_f32_16x16x32_bf16 v[88:91], a[36:39], a[12:15], v[88:91]
    ds_read_b64_tr_b16 a[112:113], v227 offset:7248
    v_mfma_f32_16x16x32_bf16 v[84:87], a[32:35], a[12:15], v[84:87]
    ds_read_b64_tr_b16 a[114:115], v227 offset:10832
    v_mfma_f32_16x16x32_bf16 v[112:115], a[32:35], a[16:19], v[112:115]
    v_mfma_f32_16x16x32_bf16 v[116:119], a[36:39], a[16:19], v[116:119]
    ds_read_b64_tr_b16 a[116:117], v230 offset:0
    v_mfma_f32_16x16x32_bf16 v[120:123], a[40:43], a[16:19], v[120:123]
    s_add_u32 m0, s36, 92208
    v_mfma_f32_16x16x32_bf16 v[124:127], a[44:47], a[16:19], v[124:127]
    buffer_load_dwordx4 v233, s[12:15], s31 offen offset:0  lds
    v_mfma_f32_16x16x32_bf16 v[128:131], a[48:51], a[16:19], v[128:131]
    v_mfma_f32_16x16x32_bf16 v[132:135], a[52:55], a[16:19], v[132:135]
    ds_read_b64_tr_b16 a[118:119], v230 offset:3584
    v_mfma_f32_16x16x32_bf16 v[136:139], a[56:59], a[16:19], v[136:139]
    ds_read_b128 a[64:67], v224 offset:1024
    v_mfma_f32_16x16x32_bf16 v[164:167], a[56:59], a[20:23], v[164:167]
    ds_read_b128 a[68:71], v224 offset:2048
    v_mfma_f32_16x16x32_bf16 v[160:163], a[52:55], a[20:23], v[160:163]
    v_mfma_f32_16x16x32_bf16 v[156:159], a[48:51], a[20:23], v[156:159]
    v_mfma_f32_16x16x32_bf16 v[152:155], a[44:47], a[20:23], v[152:155]
    buffer_load_dwordx4 v233, s[12:15], s31 offen offset:1024  lds
    v_mfma_f32_16x16x32_bf16 v[148:151], a[40:43], a[20:23], v[148:151]
    v_mfma_f32_16x16x32_bf16 v[144:147], a[36:39], a[20:23], v[144:147]
    ds_read_b128 a[72:75], v224 offset:3072
    v_mfma_f32_16x16x32_bf16 v[140:143], a[32:35], a[20:23], v[140:143]
    ds_read_b128 a[76:79], v224 offset:4096
    v_mfma_f32_16x16x32_bf16 v[168:171], a[32:35], a[24:27], v[168:171]
    ds_read_b128 a[80:83], v224 offset:5120
    v_mfma_f32_16x16x32_bf16 v[172:175], a[36:39], a[24:27], v[172:175]
    v_mfma_f32_16x16x32_bf16 v[176:179], a[40:43], a[24:27], v[176:179]
    v_mfma_f32_16x16x32_bf16 v[180:183], a[44:47], a[24:27], v[180:183]
    buffer_load_dwordx4 v233, s[12:15], s31 offen offset:2048  lds
    v_mfma_f32_16x16x32_bf16 v[184:187], a[48:51], a[24:27], v[184:187]
    v_mfma_f32_16x16x32_bf16 v[188:191], a[52:55], a[24:27], v[188:191]
    ds_read_b128 a[84:87], v224 offset:6144
    v_mfma_f32_16x16x32_bf16 v[192:195], a[56:59], a[24:27], v[192:195]
    ds_read_b128 a[88:91], v224 offset:7168
    v_mfma_f32_16x16x32_bf16 v[220:223], a[56:59], a[28:31], v[220:223]
    v_mfma_f32_16x16x32_bf16 v[216:219], a[52:55], a[28:31], v[216:219]
    v_mfma_f32_16x16x32_bf16 v[212:215], a[48:51], a[28:31], v[212:215]
    v_mfma_f32_16x16x32_bf16 v[208:211], a[44:47], a[28:31], v[208:211]
    buffer_load_dwordx4 v233, s[12:15], s31 offen offset:3072  lds
    v_mfma_f32_16x16x32_bf16 v[204:207], a[40:43], a[28:31], v[204:207]
    v_mfma_f32_16x16x32_bf16 v[200:203], a[36:39], a[28:31], v[200:203]
    v_mfma_f32_16x16x32_bf16 v[196:199], a[32:35], a[28:31], v[196:199]
    s_waitcnt vmcnt(16) lgkmcnt(0)
    s_barrier
    v_mfma_f32_16x16x32_bf16 v[0:3], a[92:95], a[60:63], v[0:3]
    ds_read_b128 a[0:3], v224 offset:30736
    v_mfma_f32_16x16x32_bf16 v[4:7], a[96:99], a[60:63], v[4:7]
    ds_read_b64_tr_b16 a[32:33], v227 offset:30736
    v_mfma_f32_16x16x32_bf16 v[8:11], a[100:103], a[60:63], v[8:11]
    s_add_u32 m0, s37, 122944
    v_readlane_b32 s31, v255, 29
    s_nop 1
    s_mul_i32 s32, s31, 229376
    s_lshl_b32 s31, s31, 14
    v_mfma_f32_16x16x32_bf16 v[12:15], a[104:107], a[60:63], v[12:15]
    buffer_load_dwordx4 v234, s[16:19], s32 offen offset:0 lds
    v_mfma_f32_16x16x32_bf16 v[16:19], a[108:111], a[60:63], v[16:19]
    v_mfma_f32_16x16x32_bf16 v[20:23], a[112:115], a[60:63], v[20:23]
    ds_read_b64_tr_b16 a[34:35], v227 offset:34320
    v_mfma_f32_16x16x32_bf16 v[24:27], a[116:119], a[60:63], v[24:27]
    ds_read_b64_tr_b16 a[36:37], v227 offset:30768
    v_mfma_f32_16x16x32_bf16 v[52:55], a[116:119], a[64:67], v[52:55]
    v_mfma_f32_16x16x32_bf16 v[48:51], a[112:115], a[64:67], v[48:51]
    ds_read_b64_tr_b16 a[38:39], v227 offset:34352
    v_mfma_f32_16x16x32_bf16 v[44:47], a[108:111], a[64:67], v[44:47]
    v_mfma_f32_16x16x32_bf16 v[40:43], a[104:107], a[64:67], v[40:43]
    buffer_load_dwordx4 v235, s[16:19], s32 offen offset:1024 lds
    v_mfma_f32_16x16x32_bf16 v[36:39], a[100:103], a[64:67], v[36:39]
    v_mfma_f32_16x16x32_bf16 v[32:35], a[96:99], a[64:67], v[32:35]
    ds_read_b64_tr_b16 a[40:41], v227 offset:30800
    v_mfma_f32_16x16x32_bf16 v[28:31], a[92:95], a[64:67], v[28:31]
    ds_read_b64_tr_b16 a[42:43], v227 offset:34384
    v_mfma_f32_16x16x32_bf16 v[56:59], a[92:95], a[68:71], v[56:59]
    v_mfma_f32_16x16x32_bf16 v[60:63], a[96:99], a[68:71], v[60:63]
    ds_read_b64_tr_b16 a[44:45], v227 offset:37920
    v_mfma_f32_16x16x32_bf16 v[64:67], a[100:103], a[68:71], v[64:67]
    v_mfma_f32_16x16x32_bf16 v[68:71], a[104:107], a[68:71], v[68:71]
    buffer_load_dwordx4 v236, s[16:19], s32 offen offset:2048 lds
    v_mfma_f32_16x16x32_bf16 v[72:75], a[108:111], a[68:71], v[72:75]
    v_mfma_f32_16x16x32_bf16 v[76:79], a[112:115], a[68:71], v[76:79]
    ds_read_b64_tr_b16 a[46:47], v227 offset:41504
    v_mfma_f32_16x16x32_bf16 v[80:83], a[116:119], a[68:71], v[80:83]
    ds_read_b64_tr_b16 a[48:49], v227 offset:37952
    v_mfma_f32_16x16x32_bf16 v[108:111], a[116:119], a[72:75], v[108:111]
    v_mfma_f32_16x16x32_bf16 v[104:107], a[112:115], a[72:75], v[104:107]
    ds_read_b64_tr_b16 a[50:51], v227 offset:41536
    v_mfma_f32_16x16x32_bf16 v[100:103], a[108:111], a[72:75], v[100:103]
    v_mfma_f32_16x16x32_bf16 v[96:99], a[104:107], a[72:75], v[96:99]
    s_mov_b64 exec, s[38:39]
    buffer_load_dwordx4 v237, s[16:19], s32 offen offset:3072 lds
    s_mov_b64 exec, -1
    v_mfma_f32_16x16x32_bf16 v[92:95], a[100:103], a[72:75], v[92:95]
    v_mfma_f32_16x16x32_bf16 v[88:91], a[96:99], a[72:75], v[88:91]
    ds_read_b64_tr_b16 a[52:53], v227 offset:37984
    v_mfma_f32_16x16x32_bf16 v[84:87], a[92:95], a[72:75], v[84:87]
    ds_read_b64_tr_b16 a[54:55], v227 offset:41568
    v_mfma_f32_16x16x32_bf16 v[112:115], a[92:95], a[76:79], v[112:115]
    v_mfma_f32_16x16x32_bf16 v[116:119], a[96:99], a[76:79], v[116:119]
    ds_read_b64_tr_b16 a[56:57], v230 offset:30736
    v_mfma_f32_16x16x32_bf16 v[120:123], a[100:103], a[76:79], v[120:123]
    s_add_u32 m0, s36, 122944
    v_mfma_f32_16x16x32_bf16 v[124:127], a[104:107], a[76:79], v[124:127]
    buffer_load_dwordx4 v233, s[12:15], s31 offen offset:0  lds
    v_mfma_f32_16x16x32_bf16 v[128:131], a[108:111], a[76:79], v[128:131]
    v_mfma_f32_16x16x32_bf16 v[132:135], a[112:115], a[76:79], v[132:135]
    ds_read_b64_tr_b16 a[58:59], v230 offset:34320
    v_mfma_f32_16x16x32_bf16 v[136:139], a[116:119], a[76:79], v[136:139]
    ds_read_b128 a[4:7], v224 offset:31760
    v_mfma_f32_16x16x32_bf16 v[164:167], a[116:119], a[80:83], v[164:167]
    ds_read_b128 a[8:11], v224 offset:32784
    v_mfma_f32_16x16x32_bf16 v[160:163], a[112:115], a[80:83], v[160:163]
    v_mfma_f32_16x16x32_bf16 v[156:159], a[108:111], a[80:83], v[156:159]
    v_mfma_f32_16x16x32_bf16 v[152:155], a[104:107], a[80:83], v[152:155]
    buffer_load_dwordx4 v233, s[12:15], s31 offen offset:1024  lds
    v_mfma_f32_16x16x32_bf16 v[148:151], a[100:103], a[80:83], v[148:151]
    v_mfma_f32_16x16x32_bf16 v[144:147], a[96:99], a[80:83], v[144:147]
    ds_read_b128 a[12:15], v224 offset:33808
    v_mfma_f32_16x16x32_bf16 v[140:143], a[92:95], a[80:83], v[140:143]
    ds_read_b128 a[16:19], v224 offset:34832
    v_mfma_f32_16x16x32_bf16 v[168:171], a[92:95], a[84:87], v[168:171]
    ds_read_b128 a[20:23], v224 offset:35856
    v_mfma_f32_16x16x32_bf16 v[172:175], a[96:99], a[84:87], v[172:175]
    v_mfma_f32_16x16x32_bf16 v[176:179], a[100:103], a[84:87], v[176:179]
    v_mfma_f32_16x16x32_bf16 v[180:183], a[104:107], a[84:87], v[180:183]
    buffer_load_dwordx4 v233, s[12:15], s31 offen offset:2048  lds
    v_mfma_f32_16x16x32_bf16 v[184:187], a[108:111], a[84:87], v[184:187]
    v_mfma_f32_16x16x32_bf16 v[188:191], a[112:115], a[84:87], v[188:191]
    ds_read_b128 a[24:27], v224 offset:36880
    v_mfma_f32_16x16x32_bf16 v[192:195], a[116:119], a[84:87], v[192:195]
    ds_read_b128 a[28:31], v224 offset:37904
    v_mfma_f32_16x16x32_bf16 v[220:223], a[116:119], a[88:91], v[220:223]
    v_mfma_f32_16x16x32_bf16 v[216:219], a[112:115], a[88:91], v[216:219]
    v_mfma_f32_16x16x32_bf16 v[212:215], a[108:111], a[88:91], v[212:215]
    v_mfma_f32_16x16x32_bf16 v[208:211], a[104:107], a[88:91], v[208:211]
    buffer_load_dwordx4 v233, s[12:15], s31 offen offset:3072  lds
    v_mfma_f32_16x16x32_bf16 v[204:207], a[100:103], a[88:91], v[204:207]
    v_mfma_f32_16x16x32_bf16 v[200:203], a[96:99], a[88:91], v[200:203]
    v_mfma_f32_16x16x32_bf16 v[196:199], a[92:95], a[88:91], v[196:199]
    s_waitcnt vmcnt(16) lgkmcnt(0)
    s_barrier
    v_mfma_f32_16x16x32_bf16 v[0:3], a[32:35], a[0:3], v[0:3]
    ds_read_b128 a[60:63], v225 offset:0
    v_mfma_f32_16x16x32_bf16 v[4:7], a[36:39], a[0:3], v[4:7]
    ds_read_b64_tr_b16 a[92:93], v228 offset:0
    v_mfma_f32_16x16x32_bf16 v[8:11], a[40:43], a[0:3], v[8:11]
    s_add_u32 m0, s37, 0
    v_readlane_b32 s31, v255, 30
    s_nop 1
    s_mul_i32 s32, s31, 229376
    s_lshl_b32 s31, s31, 14
    v_mfma_f32_16x16x32_bf16 v[12:15], a[44:47], a[0:3], v[12:15]
    buffer_load_dwordx4 v234, s[16:19], s32 offen offset:0 lds
    v_mfma_f32_16x16x32_bf16 v[16:19], a[48:51], a[0:3], v[16:19]
    v_mfma_f32_16x16x32_bf16 v[20:23], a[52:55], a[0:3], v[20:23]
    ds_read_b64_tr_b16 a[94:95], v228 offset:3584
    v_mfma_f32_16x16x32_bf16 v[24:27], a[56:59], a[0:3], v[24:27]
    ds_read_b64_tr_b16 a[96:97], v228 offset:32
    v_mfma_f32_16x16x32_bf16 v[52:55], a[56:59], a[4:7], v[52:55]
    ds_read_b64_tr_b16 a[98:99], v228 offset:3616
    v_mfma_f32_16x16x32_bf16 v[48:51], a[52:55], a[4:7], v[48:51]
    v_mfma_f32_16x16x32_bf16 v[44:47], a[48:51], a[4:7], v[44:47]
    buffer_load_dwordx4 v235, s[16:19], s32 offen offset:1024 lds
    v_mfma_f32_16x16x32_bf16 v[40:43], a[44:47], a[4:7], v[40:43]
    v_mfma_f32_16x16x32_bf16 v[36:39], a[40:43], a[4:7], v[36:39]
    ds_read_b64_tr_b16 a[100:101], v228 offset:64
    v_mfma_f32_16x16x32_bf16 v[32:35], a[36:39], a[4:7], v[32:35]
    v_mfma_f32_16x16x32_bf16 v[28:31], a[32:35], a[4:7], v[28:31]
    ds_read_b64_tr_b16 a[102:103], v228 offset:3648
    v_mfma_f32_16x16x32_bf16 v[56:59], a[32:35], a[8:11], v[56:59]
    v_mfma_f32_16x16x32_bf16 v[60:63], a[36:39], a[8:11], v[60:63]
    buffer_load_dwordx4 v236, s[16:19], s32 offen offset:2048 lds
    v_mfma_f32_16x16x32_bf16 v[64:67], a[40:43], a[8:11], v[64:67]
    v_mfma_f32_16x16x32_bf16 v[68:71], a[44:47], a[8:11], v[68:71]
    ds_read_b64_tr_b16 a[104:105], v228 offset:7184
    v_mfma_f32_16x16x32_bf16 v[72:75], a[48:51], a[8:11], v[72:75]
    ds_read_b64_tr_b16 a[106:107], v228 offset:10768
    v_mfma_f32_16x16x32_bf16 v[76:79], a[52:55], a[8:11], v[76:79]
    ds_read_b64_tr_b16 a[108:109], v228 offset:7216
    v_mfma_f32_16x16x32_bf16 v[80:83], a[56:59], a[8:11], v[80:83]
    v_mfma_f32_16x16x32_bf16 v[108:111], a[56:59], a[12:15], v[108:111]
    s_mov_b64 exec, s[38:39]
    buffer_load_dwordx4 v237, s[16:19], s32 offen offset:3072 lds
    s_mov_b64 exec, -1
    v_mfma_f32_16x16x32_bf16 v[104:107], a[52:55], a[12:15], v[104:107]
    v_mfma_f32_16x16x32_bf16 v[100:103], a[48:51], a[12:15], v[100:103]
    ds_read_b64_tr_b16 a[110:111], v228 offset:10800
    v_mfma_f32_16x16x32_bf16 v[96:99], a[44:47], a[12:15], v[96:99]
    v_mfma_f32_16x16x32_bf16 v[92:95], a[40:43], a[12:15], v[92:95]
    ds_read_b64_tr_b16 a[112:113], v228 offset:7248
    v_mfma_f32_16x16x32_bf16 v[88:91], a[36:39], a[12:15], v[88:91]
    ds_read_b64_tr_b16 a[114:115], v228 offset:10832
    v_mfma_f32_16x16x32_bf16 v[84:87], a[32:35], a[12:15], v[84:87]
    s_add_u32 m0, s36, 0
    v_mfma_f32_16x16x32_bf16 v[112:115], a[32:35], a[16:19], v[112:115]
    buffer_load_dwordx4 v233, s[12:15], s31 offen offset:0  lds
    v_mfma_f32_16x16x32_bf16 v[116:119], a[36:39], a[16:19], v[116:119]
    v_mfma_f32_16x16x32_bf16 v[120:123], a[40:43], a[16:19], v[120:123]
    ds_read_b64_tr_b16 a[116:117], v231 offset:0
    v_mfma_f32_16x16x32_bf16 v[124:127], a[44:47], a[16:19], v[124:127]
    ds_read_b64_tr_b16 a[118:119], v231 offset:3584
    v_mfma_f32_16x16x32_bf16 v[128:131], a[48:51], a[16:19], v[128:131]
    ds_read_b128 a[64:67], v225 offset:1024
    v_mfma_f32_16x16x32_bf16 v[132:135], a[52:55], a[16:19], v[132:135]
    v_mfma_f32_16x16x32_bf16 v[136:139], a[56:59], a[16:19], v[136:139]
    buffer_load_dwordx4 v233, s[12:15], s31 offen offset:1024  lds
    v_mfma_f32_16x16x32_bf16 v[164:167], a[56:59], a[20:23], v[164:167]
    v_mfma_f32_16x16x32_bf16 v[160:163], a[52:55], a[20:23], v[160:163]
    ds_read_b128 a[68:71], v225 offset:2048
    v_mfma_f32_16x16x32_bf16 v[156:159], a[48:51], a[20:23], v[156:159]
    v_mfma_f32_16x16x32_bf16 v[152:155], a[44:47], a[20:23], v[152:155]
    ds_read_b128 a[72:75], v225 offset:3072
    v_mfma_f32_16x16x32_bf16 v[148:151], a[40:43], a[20:23], v[148:151]
    v_mfma_f32_16x16x32_bf16 v[144:147], a[36:39], a[20:23], v[144:147]
    buffer_load_dwordx4 v233, s[12:15], s31 offen offset:2048  lds
    v_mfma_f32_16x16x32_bf16 v[140:143], a[32:35], a[20:23], v[140:143]
    v_mfma_f32_16x16x32_bf16 v[168:171], a[32:35], a[24:27], v[168:171]
    ds_read_b128 a[76:79], v225 offset:4096
    v_mfma_f32_16x16x32_bf16 v[172:175], a[36:39], a[24:27], v[172:175]
    ds_read_b128 a[80:83], v225 offset:5120
    v_mfma_f32_16x16x32_bf16 v[176:179], a[40:43], a[24:27], v[176:179]
    ds_read_b128 a[84:87], v225 offset:6144
    v_mfma_f32_16x16x32_bf16 v[180:183], a[44:47], a[24:27], v[180:183]
    v_mfma_f32_16x16x32_bf16 v[184:187], a[48:51], a[24:27], v[184:187]
    buffer_load_dwordx4 v233, s[12:15], s31 offen offset:3072  lds
    v_mfma_f32_16x16x32_bf16 v[188:191], a[52:55], a[24:27], v[188:191]
    v_mfma_f32_16x16x32_bf16 v[192:195], a[56:59], a[24:27], v[192:195]
    ds_read_b128 a[88:91], v225 offset:7168
    v_mfma_f32_16x16x32_bf16 v[220:223], a[56:59], a[28:31], v[220:223]
    v_mfma_f32_16x16x32_bf16 v[216:219], a[52:55], a[28:31], v[216:219]
    v_mfma_f32_16x16x32_bf16 v[212:215], a[48:51], a[28:31], v[212:215]
    v_mfma_f32_16x16x32_bf16 v[208:211], a[44:47], a[28:31], v[208:211]
    buffer_load_dword v247, v249, s[56:59], 0 offen
    v_mfma_f32_16x16x32_bf16 v[204:207], a[40:43], a[28:31], v[204:207]
    v_mfma_f32_16x16x32_bf16 v[200:203], a[36:39], a[28:31], v[200:203]
    v_mfma_f32_16x16x32_bf16 v[196:199], a[32:35], a[28:31], v[196:199]
    s_waitcnt vmcnt(17) lgkmcnt(0)
    s_barrier
    v_mfma_f32_16x16x32_bf16 v[0:3], a[92:95], a[60:63], v[0:3]
    ds_read_b128 a[0:3], v225 offset:30736
    v_mfma_f32_16x16x32_bf16 v[4:7], a[96:99], a[60:63], v[4:7]
    ds_read_b64_tr_b16 a[32:33], v228 offset:30736
    v_mfma_f32_16x16x32_bf16 v[8:11], a[100:103], a[60:63], v[8:11]
    s_add_u32 m0, s37, 30736
    v_readlane_b32 s31, v255, 31
    s_nop 1
    s_mul_i32 s32, s31, 229376
    s_lshl_b32 s31, s31, 14
    v_mfma_f32_16x16x32_bf16 v[12:15], a[104:107], a[60:63], v[12:15]
    buffer_load_dwordx4 v234, s[16:19], s32 offen offset:0 lds
    v_mfma_f32_16x16x32_bf16 v[16:19], a[108:111], a[60:63], v[16:19]
    v_mfma_f32_16x16x32_bf16 v[20:23], a[112:115], a[60:63], v[20:23]
    ds_read_b64_tr_b16 a[34:35], v228 offset:34320
    v_mfma_f32_16x16x32_bf16 v[24:27], a[116:119], a[60:63], v[24:27]
    ds_read_b64_tr_b16 a[36:37], v228 offset:30768
    v_mfma_f32_16x16x32_bf16 v[52:55], a[116:119], a[64:67], v[52:55]
    ds_read_b64_tr_b16 a[38:39], v228 offset:34352
    v_mfma_f32_16x16x32_bf16 v[48:51], a[112:115], a[64:67], v[48:51]
    v_mfma_f32_16x16x32_bf16 v[44:47], a[108:111], a[64:67], v[44:47]
    buffer_load_dwordx4 v235, s[16:19], s32 offen offset:1024 lds
    v_mfma_f32_16x16x32_bf16 v[40:43], a[104:107], a[64:67], v[40:43]
    v_mfma_f32_16x16x32_bf16 v[36:39], a[100:103], a[64:67], v[36:39]
    ds_read_b64_tr_b16 a[40:41], v228 offset:30800
    v_mfma_f32_16x16x32_bf16 v[32:35], a[96:99], a[64:67], v[32:35]
    v_mfma_f32_16x16x32_bf16 v[28:31], a[92:95], a[64:67], v[28:31]
    ds_read_b64_tr_b16 a[42:43], v228 offset:34384
    v_mfma_f32_16x16x32_bf16 v[56:59], a[92:95], a[68:71], v[56:59]
    v_mfma_f32_16x16x32_bf16 v[60:63], a[96:99], a[68:71], v[60:63]
    buffer_load_dwordx4 v236, s[16:19], s32 offen offset:2048 lds
    v_mfma_f32_16x16x32_bf16 v[64:67], a[100:103], a[68:71], v[64:67]
    v_mfma_f32_16x16x32_bf16 v[68:71], a[104:107], a[68:71], v[68:71]
    ds_read_b64_tr_b16 a[44:45], v228 offset:37920
    v_mfma_f32_16x16x32_bf16 v[72:75], a[108:111], a[68:71], v[72:75]
    ds_read_b64_tr_b16 a[46:47], v228 offset:41504
    v_mfma_f32_16x16x32_bf16 v[76:79], a[112:115], a[68:71], v[76:79]
    ds_read_b64_tr_b16 a[48:49], v228 offset:37952
    v_mfma_f32_16x16x32_bf16 v[80:83], a[116:119], a[68:71], v[80:83]
    v_mfma_f32_16x16x32_bf16 v[108:111], a[116:119], a[72:75], v[108:111]
    s_mov_b64 exec, s[38:39]
    buffer_load_dwordx4 v237, s[16:19], s32 offen offset:3072 lds
    s_mov_b64 exec, -1
    v_mfma_f32_16x16x32_bf16 v[104:107], a[112:115], a[72:75], v[104:107]
    v_mfma_f32_16x16x32_bf16 v[100:103], a[108:111], a[72:75], v[100:103]
    ds_read_b64_tr_b16 a[50:51], v228 offset:41536
    v_mfma_f32_16x16x32_bf16 v[96:99], a[104:107], a[72:75], v[96:99]
    v_mfma_f32_16x16x32_bf16 v[92:95], a[100:103], a[72:75], v[92:95]
    ds_read_b64_tr_b16 a[52:53], v228 offset:37984
    v_mfma_f32_16x16x32_bf16 v[88:91], a[96:99], a[72:75], v[88:91]
    ds_read_b64_tr_b16 a[54:55], v228 offset:41568
    v_mfma_f32_16x16x32_bf16 v[84:87], a[92:95], a[72:75], v[84:87]
    s_add_u32 m0, s36, 30736
    v_mfma_f32_16x16x32_bf16 v[112:115], a[92:95], a[76:79], v[112:115]
    buffer_load_dwordx4 v233, s[12:15], s31 offen offset:0  lds
    v_mfma_f32_16x16x32_bf16 v[116:119], a[96:99], a[76:79], v[116:119]
    v_mfma_f32_16x16x32_bf16 v[120:123], a[100:103], a[76:79], v[120:123]
    ds_read_b64_tr_b16 a[56:57], v231 offset:30736
    v_mfma_f32_16x16x32_bf16 v[124:127], a[104:107], a[76:79], v[124:127]
    ds_read_b64_tr_b16 a[58:59], v231 offset:34320
    v_mfma_f32_16x16x32_bf16 v[128:131], a[108:111], a[76:79], v[128:131]
    ds_read_b128 a[4:7], v225 offset:31760
    v_mfma_f32_16x16x32_bf16 v[132:135], a[112:115], a[76:79], v[132:135]
    v_mfma_f32_16x16x32_bf16 v[136:139], a[116:119], a[76:79], v[136:139]
    buffer_load_dwordx4 v233, s[12:15], s31 offen offset:1024  lds
    v_mfma_f32_16x16x32_bf16 v[164:167], a[116:119], a[80:83], v[164:167]
    v_mfma_f32_16x16x32_bf16 v[160:163], a[112:115], a[80:83], v[160:163]
    ds_read_b128 a[8:11], v225 offset:32784
    v_mfma_f32_16x16x32_bf16 v[156:159], a[108:111], a[80:83], v[156:159]
    v_mfma_f32_16x16x32_bf16 v[152:155], a[104:107], a[80:83], v[152:155]
    ds_read_b128 a[12:15], v225 offset:33808
    v_mfma_f32_16x16x32_bf16 v[148:151], a[100:103], a[80:83], v[148:151]
    v_mfma_f32_16x16x32_bf16 v[144:147], a[96:99], a[80:83], v[144:147]
    buffer_load_dwordx4 v233, s[12:15], s31 offen offset:2048  lds
    v_mfma_f32_16x16x32_bf16 v[140:143], a[92:95], a[80:83], v[140:143]
    v_mfma_f32_16x16x32_bf16 v[168:171], a[92:95], a[84:87], v[168:171]
    ds_read_b128 a[16:19], v225 offset:34832
    v_mfma_f32_16x16x32_bf16 v[172:175], a[96:99], a[84:87], v[172:175]
    ds_read_b128 a[20:23], v225 offset:35856
    v_mfma_f32_16x16x32_bf16 v[176:179], a[100:103], a[84:87], v[176:179]
    ds_read_b128 a[24:27], v225 offset:36880
    v_mfma_f32_16x16x32_bf16 v[180:183], a[104:107], a[84:87], v[180:183]
    v_mfma_f32_16x16x32_bf16 v[184:187], a[108:111], a[84:87], v[184:187]
    buffer_load_dwordx4 v233, s[12:15], s31 offen offset:3072  lds
    v_mfma_f32_16x16x32_bf16 v[188:191], a[112:115], a[84:87], v[188:191]
    v_mfma_f32_16x16x32_bf16 v[192:195], a[116:119], a[84:87], v[192:195]
    ds_read_b128 a[28:31], v225 offset:37904
    v_mfma_f32_16x16x32_bf16 v[220:223], a[116:119], a[88:91], v[220:223]
    v_mfma_f32_16x16x32_bf16 v[216:219], a[112:115], a[88:91], v[216:219]
    v_mfma_f32_16x16x32_bf16 v[212:215], a[108:111], a[88:91], v[212:215]
    s_bfe_u32 s47, s2, 0x20001
    s_add_u32 s47, s47, 0
    s_and_b32 s47, s47, 3
    s_lshl_b32 s47, s47, 21
    v_mfma_f32_16x16x32_bf16 v[208:211], a[104:107], a[88:91], v[208:211]
    buffer_load_dword v247, v239, s[52:55], s47 offen
    v_mfma_f32_16x16x32_bf16 v[204:207], a[100:103], a[88:91], v[204:207]
    v_mfma_f32_16x16x32_bf16 v[200:203], a[96:99], a[88:91], v[200:203]
    v_mfma_f32_16x16x32_bf16 v[196:199], a[92:95], a[88:91], v[196:199]
    s_waitcnt vmcnt(18) lgkmcnt(0)
    s_barrier
    v_mfma_f32_16x16x32_bf16 v[0:3], a[32:35], a[0:3], v[0:3]
    ds_read_b128 a[60:63], v226 offset:0
    v_mfma_f32_16x16x32_bf16 v[4:7], a[36:39], a[0:3], v[4:7]
    v_mfma_f32_16x16x32_bf16 v[8:11], a[40:43], a[0:3], v[8:11]
    ds_read_b64_tr_b16 a[92:93], v229 offset:0
    v_mfma_f32_16x16x32_bf16 v[12:15], a[44:47], a[0:3], v[12:15]
    v_mfma_f32_16x16x32_bf16 v[16:19], a[48:51], a[0:3], v[16:19]
    ds_read_b64_tr_b16 a[94:95], v229 offset:3584
    v_mfma_f32_16x16x32_bf16 v[20:23], a[52:55], a[0:3], v[20:23]
    v_mfma_f32_16x16x32_bf16 v[24:27], a[56:59], a[0:3], v[24:27]
    ds_read_b64_tr_b16 a[96:97], v229 offset:32
    v_mfma_f32_16x16x32_bf16 v[52:55], a[56:59], a[4:7], v[52:55]
    v_mfma_f32_16x16x32_bf16 v[48:51], a[52:55], a[4:7], v[48:51]
    v_mfma_f32_16x16x32_bf16 v[44:47], a[48:51], a[4:7], v[44:47]
    ds_read_b64_tr_b16 a[98:99], v229 offset:3616
    v_mfma_f32_16x16x32_bf16 v[40:43], a[44:47], a[4:7], v[40:43]
    v_mfma_f32_16x16x32_bf16 v[36:39], a[40:43], a[4:7], v[36:39]
    ds_read_b64_tr_b16 a[100:101], v229 offset:64
    v_mfma_f32_16x16x32_bf16 v[32:35], a[36:39], a[4:7], v[32:35]
    v_mfma_f32_16x16x32_bf16 v[28:31], a[32:35], a[4:7], v[28:31]
    ds_read_b64_tr_b16 a[102:103], v229 offset:3648
    v_mfma_f32_16x16x32_bf16 v[56:59], a[32:35], a[8:11], v[56:59]
    v_mfma_f32_16x16x32_bf16 v[60:63], a[36:39], a[8:11], v[60:63]
    v_mfma_f32_16x16x32_bf16 v[64:67], a[40:43], a[8:11], v[64:67]
    ds_read_b64_tr_b16 a[104:105], v229 offset:7184
    v_mfma_f32_16x16x32_bf16 v[68:71], a[44:47], a[8:11], v[68:71]
    v_mfma_f32_16x16x32_bf16 v[72:75], a[48:51], a[8:11], v[72:75]
    ds_read_b64_tr_b16 a[106:107], v229 offset:10768
    v_mfma_f32_16x16x32_bf16 v[76:79], a[52:55], a[8:11], v[76:79]
    v_mfma_f32_16x16x32_bf16 v[80:83], a[56:59], a[8:11], v[80:83]
    ds_read_b64_tr_b16 a[108:109], v229 offset:7216
    v_mfma_f32_16x16x32_bf16 v[108:111], a[56:59], a[12:15], v[108:111]
    v_mfma_f32_16x16x32_bf16 v[104:107], a[52:55], a[12:15], v[104:107]
    ds_read_b64_tr_b16 a[110:111], v229 offset:10800
    v_mfma_f32_16x16x32_bf16 v[100:103], a[48:51], a[12:15], v[100:103]
    v_mfma_f32_16x16x32_bf16 v[96:99], a[44:47], a[12:15], v[96:99]
    v_mfma_f32_16x16x32_bf16 v[92:95], a[40:43], a[12:15], v[92:95]
    ds_read_b64_tr_b16 a[112:113], v229 offset:7248
    v_mfma_f32_16x16x32_bf16 v[88:91], a[36:39], a[12:15], v[88:91]
    v_mfma_f32_16x16x32_bf16 v[84:87], a[32:35], a[12:15], v[84:87]
    ds_read_b64_tr_b16 a[114:115], v229 offset:10832
    v_mfma_f32_16x16x32_bf16 v[112:115], a[32:35], a[16:19], v[112:115]
    v_mfma_f32_16x16x32_bf16 v[116:119], a[36:39], a[16:19], v[116:119]
    ds_read_b64_tr_b16 a[116:117], v232 offset:0
    v_mfma_f32_16x16x32_bf16 v[120:123], a[40:43], a[16:19], v[120:123]
    v_mfma_f32_16x16x32_bf16 v[124:127], a[44:47], a[16:19], v[124:127]
    v_mfma_f32_16x16x32_bf16 v[128:131], a[48:51], a[16:19], v[128:131]
    ds_read_b64_tr_b16 a[118:119], v232 offset:3584
    v_mfma_f32_16x16x32_bf16 v[132:135], a[52:55], a[16:19], v[132:135]
    v_mfma_f32_16x16x32_bf16 v[136:139], a[56:59], a[16:19], v[136:139]
    ds_read_b128 a[64:67], v226 offset:1024
    v_mfma_f32_16x16x32_bf16 v[164:167], a[56:59], a[20:23], v[164:167]
    v_mfma_f32_16x16x32_bf16 v[160:163], a[52:55], a[20:23], v[160:163]
    ds_read_b128 a[68:71], v226 offset:2048
    v_mfma_f32_16x16x32_bf16 v[156:159], a[48:51], a[20:23], v[156:159]
    v_mfma_f32_16x16x32_bf16 v[152:155], a[44:47], a[20:23], v[152:155]
    ds_read_b128 a[72:75], v226 offset:3072
    v_mfma_f32_16x16x32_bf16 v[148:151], a[40:43], a[20:23], v[148:151]
    v_mfma_f32_16x16x32_bf16 v[144:147], a[36:39], a[20:23], v[144:147]
    v_mfma_f32_16x16x32_bf16 v[140:143], a[32:35], a[20:23], v[140:143]
    ds_read_b128 a[76:79], v226 offset:4096
    v_mfma_f32_16x16x32_bf16 v[168:171], a[32:35], a[24:27], v[168:171]
    v_mfma_f32_16x16x32_bf16 v[172:175], a[36:39], a[24:27], v[172:175]
    ds_read_b128 a[80:83], v226 offset:5120
    v_mfma_f32_16x16x32_bf16 v[176:179], a[40:43], a[24:27], v[176:179]
    v_mfma_f32_16x16x32_bf16 v[180:183], a[44:47], a[24:27], v[180:183]
    ds_read_b128 a[84:87], v226 offset:6144
    v_mfma_f32_16x16x32_bf16 v[184:187], a[48:51], a[24:27], v[184:187]
    v_mfma_f32_16x16x32_bf16 v[188:191], a[52:55], a[24:27], v[188:191]
    v_mfma_f32_16x16x32_bf16 v[192:195], a[56:59], a[24:27], v[192:195]
    ds_read_b128 a[88:91], v226 offset:7168
    v_mfma_f32_16x16x32_bf16 v[220:223], a[56:59], a[28:31], v[220:223]
    v_mfma_f32_16x16x32_bf16 v[216:219], a[52:55], a[28:31], v[216:219]
    v_mfma_f32_16x16x32_bf16 v[212:215], a[48:51], a[28:31], v[212:215]
    v_mfma_f32_16x16x32_bf16 v[208:211], a[44:47], a[28:31], v[208:211]
    v_mfma_f32_16x16x32_bf16 v[204:207], a[40:43], a[28:31], v[204:207]
    v_mfma_f32_16x16x32_bf16 v[200:203], a[36:39], a[28:31], v[200:203]
    v_mfma_f32_16x16x32_bf16 v[196:199], a[32:35], a[28:31], v[196:199]
    s_waitcnt vmcnt(10) lgkmcnt(0)
    s_barrier
    v_mfma_f32_16x16x32_bf16 v[0:3], a[92:95], a[60:63], v[0:3]
    ds_read_b128 a[0:3], v224 offset:0
    v_mfma_f32_16x16x32_bf16 v[4:7], a[96:99], a[60:63], v[4:7]
    v_mfma_f32_16x16x32_bf16 v[8:11], a[100:103], a[60:63], v[8:11]
    ds_read_b64_tr_b16 a[32:33], v227 offset:0
    v_mfma_f32_16x16x32_bf16 v[12:15], a[104:107], a[60:63], v[12:15]
    v_mfma_f32_16x16x32_bf16 v[16:19], a[108:111], a[60:63], v[16:19]
    ds_read_b64_tr_b16 a[34:35], v227 offset:3584
    v_mfma_f32_16x16x32_bf16 v[20:23], a[112:115], a[60:63], v[20:23]
    v_mfma_f32_16x16x32_bf16 v[24:27], a[116:119], a[60:63], v[24:27]
    ds_read_b64_tr_b16 a[36:37], v227 offset:32
    v_mfma_f32_16x16x32_bf16 v[52:55], a[116:119], a[64:67], v[52:55]
    v_mfma_f32_16x16x32_bf16 v[48:51], a[112:115], a[64:67], v[48:51]
    ds_read_b64_tr_b16 a[38:39], v227 offset:3616
    v_mfma_f32_16x16x32_bf16 v[44:47], a[108:111], a[64:67], v[44:47]
    v_mfma_f32_16x16x32_bf16 v[40:43], a[104:107], a[64:67], v[40:43]
    ds_read_b64_tr_b16 a[40:41], v227 offset:64
    v_mfma_f32_16x16x32_bf16 v[36:39], a[100:103], a[64:67], v[36:39]
    v_mfma_f32_16x16x32_bf16 v[32:35], a[96:99], a[64:67], v[32:35]
    v_mfma_f32_16x16x32_bf16 v[28:31], a[92:95], a[64:67], v[28:31]
    ds_read_b64_tr_b16 a[42:43], v227 offset:3648
    v_mfma_f32_16x16x32_bf16 v[56:59], a[92:95], a[68:71], v[56:59]
    v_mfma_f32_16x16x32_bf16 v[60:63], a[96:99], a[68:71], v[60:63]
    ds_read_b64_tr_b16 a[44:45], v227 offset:7184
    v_mfma_f32_16x16x32_bf16 v[64:67], a[100:103], a[68:71], v[64:67]
    v_mfma_f32_16x16x32_bf16 v[68:71], a[104:107], a[68:71], v[68:71]
    ds_read_b64_tr_b16 a[46:47], v227 offset:10768
    v_mfma_f32_16x16x32_bf16 v[72:75], a[108:111], a[68:71], v[72:75]
    v_mfma_f32_16x16x32_bf16 v[76:79], a[112:115], a[68:71], v[76:79]
    ds_read_b64_tr_b16 a[48:49], v227 offset:7216
    v_mfma_f32_16x16x32_bf16 v[80:83], a[116:119], a[68:71], v[80:83]
    v_mfma_f32_16x16x32_bf16 v[108:111], a[116:119], a[72:75], v[108:111]
    ds_read_b64_tr_b16 a[50:51], v227 offset:10800
    v_mfma_f32_16x16x32_bf16 v[104:107], a[112:115], a[72:75], v[104:107]
    v_mfma_f32_16x16x32_bf16 v[100:103], a[108:111], a[72:75], v[100:103]
    ds_read_b64_tr_b16 a[52:53], v227 offset:7248
    v_mfma_f32_16x16x32_bf16 v[96:99], a[104:107], a[72:75], v[96:99]
    v_mfma_f32_16x16x32_bf16 v[92:95], a[100:103], a[72:75], v[92:95]
    v_mfma_f32_16x16x32_bf16 v[88:91], a[96:99], a[72:75], v[88:91]
    ds_read_b64_tr_b16 a[54:55], v227 offset:10832
    v_mfma_f32_16x16x32_bf16 v[84:87], a[92:95], a[72:75], v[84:87]
    s_bfe_u32 s47, s2, 0x20001
    s_add_u32 s47, s47, 1
    s_and_b32 s47, s47, 3
    s_lshl_b32 s47, s47, 21
    v_mfma_f32_16x16x32_bf16 v[112:115], a[92:95], a[76:79], v[112:115]
    buffer_load_dword v247, v239, s[52:55], s47 offen
    v_mfma_f32_16x16x32_bf16 v[116:119], a[96:99], a[76:79], v[116:119]
    v_mfma_f32_16x16x32_bf16 v[120:123], a[100:103], a[76:79], v[120:123]
    v_mfma_f32_16x16x32_bf16 v[124:127], a[104:107], a[76:79], v[124:127]
    ds_read_b64_tr_b16 a[56:57], v230 offset:0
    v_mfma_f32_16x16x32_bf16 v[128:131], a[108:111], a[76:79], v[128:131]
    v_mfma_f32_16x16x32_bf16 v[132:135], a[112:115], a[76:79], v[132:135]
    ds_read_b64_tr_b16 a[58:59], v230 offset:3584
    v_mfma_f32_16x16x32_bf16 v[136:139], a[116:119], a[76:79], v[136:139]
    v_mfma_f32_16x16x32_bf16 v[164:167], a[116:119], a[80:83], v[164:167]
    ds_read_b128 a[4:7], v224 offset:1024
    v_mfma_f32_16x16x32_bf16 v[160:163], a[112:115], a[80:83], v[160:163]
    v_mfma_f32_16x16x32_bf16 v[156:159], a[108:111], a[80:83], v[156:159]
    ds_read_b128 a[8:11], v224 offset:2048
    v_mfma_f32_16x16x32_bf16 v[152:155], a[104:107], a[80:83], v[152:155]
    v_mfma_f32_16x16x32_bf16 v[148:151], a[100:103], a[80:83], v[148:151]
    ds_read_b128 a[12:15], v224 offset:3072
    v_mfma_f32_16x16x32_bf16 v[144:147], a[96:99], a[80:83], v[144:147]
    v_mfma_f32_16x16x32_bf16 v[140:143], a[92:95], a[80:83], v[140:143]
    v_mfma_f32_16x16x32_bf16 v[168:171], a[92:95], a[84:87], v[168:171]
    ds_read_b128 a[16:19], v224 offset:4096
    v_mfma_f32_16x16x32_bf16 v[172:175], a[96:99], a[84:87], v[172:175]
    v_mfma_f32_16x16x32_bf16 v[176:179], a[100:103], a[84:87], v[176:179]
    ds_read_b128 a[20:23], v224 offset:5120
    v_mfma_f32_16x16x32_bf16 v[180:183], a[104:107], a[84:87], v[180:183]
    v_mfma_f32_16x16x32_bf16 v[184:187], a[108:111], a[84:87], v[184:187]
    ds_read_b128 a[24:27], v224 offset:6144
    v_mfma_f32_16x16x32_bf16 v[188:191], a[112:115], a[84:87], v[188:191]
    v_mfma_f32_16x16x32_bf16 v[192:195], a[116:119], a[84:87], v[192:195]
    ds_read_b128 a[28:31], v224 offset:7168
    v_mfma_f32_16x16x32_bf16 v[220:223], a[116:119], a[88:91], v[220:223]
    v_mfma_f32_16x16x32_bf16 v[216:219], a[112:115], a[88:91], v[216:219]
    v_mfma_f32_16x16x32_bf16 v[212:215], a[108:111], a[88:91], v[212:215]
    v_mfma_f32_16x16x32_bf16 v[208:211], a[104:107], a[88:91], v[208:211]
    v_mfma_f32_16x16x32_bf16 v[204:207], a[100:103], a[88:91], v[204:207]
    v_mfma_f32_16x16x32_bf16 v[200:203], a[96:99], a[88:91], v[200:203]
    v_mfma_f32_16x16x32_bf16 v[196:199], a[92:95], a[88:91], v[196:199]
    s_waitcnt vmcnt(2) lgkmcnt(0)
    s_barrier
    v_mfma_f32_16x16x32_bf16 v[0:3], a[32:35], a[0:3], v[0:3]
    ds_read_b128 a[60:63], v224 offset:30736
    v_mfma_f32_16x16x32_bf16 v[4:7], a[36:39], a[0:3], v[4:7]
    v_mfma_f32_16x16x32_bf16 v[8:11], a[40:43], a[0:3], v[8:11]
    ds_read_b64_tr_b16 a[92:93], v227 offset:30736
    v_mfma_f32_16x16x32_bf16 v[12:15], a[44:47], a[0:3], v[12:15]
    v_mfma_f32_16x16x32_bf16 v[16:19], a[48:51], a[0:3], v[16:19]
    ds_read_b64_tr_b16 a[94:95], v227 offset:34320
    v_mfma_f32_16x16x32_bf16 v[20:23], a[52:55], a[0:3], v[20:23]
    v_mfma_f32_16x16x32_bf16 v[24:27], a[56:59], a[0:3], v[24:27]
    ds_read_b64_tr_b16 a[96:97], v227 offset:30768
    v_mfma_f32_16x16x32_bf16 v[52:55], a[56:59], a[4:7], v[52:55]
    v_mfma_f32_16x16x32_bf16 v[48:51], a[52:55], a[4:7], v[48:51]
    v_mfma_f32_16x16x32_bf16 v[44:47], a[48:51], a[4:7], v[44:47]
    ds_read_b64_tr_b16 a[98:99], v227 offset:34352
    v_mfma_f32_16x16x32_bf16 v[40:43], a[44:47], a[4:7], v[40:43]
    v_mfma_f32_16x16x32_bf16 v[36:39], a[40:43], a[4:7], v[36:39]
    ds_read_b64_tr_b16 a[100:101], v227 offset:30800
    v_and_b32 v240, 15, v238
    v_mfma_f32_16x16x32_bf16 v[32:35], a[36:39], a[4:7], v[32:35]
    v_lshrrev_b32 v241, 4, v238
    v_mfma_f32_16x16x32_bf16 v[28:31], a[32:35], a[4:7], v[28:31]
    ds_read_b64_tr_b16 a[102:103], v227 offset:34384
    s_mul_i32 s41, s30, 14
    v_mfma_f32_16x16x32_bf16 v[56:59], a[32:35], a[8:11], v[56:59]
    s_mul_i32 s45, s43, 7
    v_mfma_f32_16x16x32_bf16 v[60:63], a[36:39], a[8:11], v[60:63]
    s_add_u32 s41, s41, s45
    v_mfma_f32_16x16x32_bf16 v[64:67], a[40:43], a[8:11], v[64:67]
    ds_read_b64_tr_b16 a[104:105], v227 offset:37920
    s_lshl_b32 s46, s29, 1
    v_mfma_f32_16x16x32_bf16 v[68:71], a[44:47], a[8:11], v[68:71]
    s_add_u32 s46, s46, s44
    v_mfma_f32_16x16x32_bf16 v[72:75], a[48:51], a[8:11], v[72:75]
    ds_read_b64_tr_b16 a[106:107], v227 offset:41504
    s_mul_i32 s46, s46, 917504
    v_mfma_f32_16x16x32_bf16 v[76:79], a[52:55], a[8:11], v[76:79]
    v_and_b32 v245, 1, v241
    v_mfma_f32_16x16x32_bf16 v[80:83], a[56:59], a[8:11], v[80:83]
    ds_read_b64_tr_b16 a[108:109], v227 offset:37952
    v_lshrrev_b32 v246, 1, v241
    v_mfma_f32_16x16x32_bf16 v[108:111], a[56:59], a[12:15], v[108:111]
    v_lshl_add_u32 v248, v245, 1, v246
    v_mfma_f32_16x16x32_bf16 v[104:107], a[52:55], a[12:15], v[104:107]
    ds_read_b64_tr_b16 a[110:111], v227 offset:41536
    v_add_u32 v254, s41, v248
    v_mfma_f32_16x16x32_bf16 v[100:103], a[48:51], a[12:15], v[100:103]
    v_lshrrev_b32 v255, 2, v254
    v_mfma_f32_16x16x32_bf16 v[96:99], a[44:47], a[12:15], v[96:99]
    v_lshlrev_b32 v255, 13, v255
    v_mfma_f32_16x16x32_bf16 v[92:95], a[40:43], a[12:15], v[92:95]
    ds_read_b64_tr_b16 a[112:113], v227 offset:37984
    v_and_b32 v254, 3, v254
    v_mfma_f32_16x16x32_bf16 v[88:91], a[36:39], a[12:15], v[88:91]
    v_lshl_add_u32 v254, v254, 4, v240
    v_mfma_f32_16x16x32_bf16 v[84:87], a[32:35], a[12:15], v[84:87]
    ds_read_b64_tr_b16 a[114:115], v227 offset:41568
    v_lshl_add_u32 v254, v254, 4, v255
    v_mfma_f32_16x16x32_bf16 v[112:115], a[32:35], a[16:19], v[112:115]
    v_add_u32 v242, s46, v254
    v_mfma_f32_16x16x32_bf16 v[116:119], a[36:39], a[16:19], v[116:119]
    ds_read_b64_tr_b16 a[116:117], v230 offset:30736
    v_add_u32 v248, 4, v246
    v_mfma_f32_16x16x32_bf16 v[120:123], a[40:43], a[16:19], v[120:123]
    v_add_u32 v254, s41, v248
    v_mfma_f32_16x16x32_bf16 v[124:127], a[44:47], a[16:19], v[124:127]
    v_mfma_f32_16x16x32_bf16 v[128:131], a[48:51], a[16:19], v[128:131]
    ds_read_b64_tr_b16 a[118:119], v230 offset:34320
    v_lshrrev_b32 v255, 2, v254
    v_mfma_f32_16x16x32_bf16 v[132:135], a[52:55], a[16:19], v[132:135]
    v_lshlrev_b32 v255, 13, v255
    v_mfma_f32_16x16x32_bf16 v[136:139], a[56:59], a[16:19], v[136:139]
    ds_read_b128 a[64:67], v224 offset:31760
    v_and_b32 v254, 3, v254
    v_mfma_f32_16x16x32_bf16 v[164:167], a[56:59], a[20:23], v[164:167]
    v_lshl_add_u32 v254, v254, 4, v240
    v_mfma_f32_16x16x32_bf16 v[160:163], a[52:55], a[20:23], v[160:163]
    ds_read_b128 a[68:71], v224 offset:32784
    v_lshl_add_u32 v254, v254, 4, v255
    v_mfma_f32_16x16x32_bf16 v[156:159], a[48:51], a[20:23], v[156:159]
    v_lshl_add_u32 v254, v245, 10, v254
    v_mfma_f32_16x16x32_bf16 v[152:155], a[44:47], a[20:23], v[152:155]
    ds_read_b128 a[72:75], v224 offset:33808
    v_add_u32 v243, s46, v254
    v_mfma_f32_16x16x32_bf16 v[148:151], a[40:43], a[20:23], v[148:151]
    v_mov_b32 v248, 6
    v_mfma_f32_16x16x32_bf16 v[144:147], a[36:39], a[20:23], v[144:147]
    v_add_u32 v254, s41, v248
    v_mfma_f32_16x16x32_bf16 v[140:143], a[32:35], a[20:23], v[140:143]
    ds_read_b128 a[76:79], v224 offset:34832
    v_lshrrev_b32 v255, 2, v254
    v_mfma_f32_16x16x32_bf16 v[168:171], a[32:35], a[24:27], v[168:171]
    v_lshlrev_b32 v255, 13, v255
    v_mfma_f32_16x16x32_bf16 v[172:175], a[36:39], a[24:27], v[172:175]
    ds_read_b128 a[80:83], v224 offset:35856
    v_and_b32 v254, 3, v254
    v_mfma_f32_16x16x32_bf16 v[176:179], a[40:43], a[24:27], v[176:179]
    v_lshl_add_u32 v254, v254, 4, v240
    v_mfma_f32_16x16x32_bf16 v[180:183], a[44:47], a[24:27], v[180:183]
    ds_read_b128 a[84:87], v224 offset:36880
    v_lshl_add_u32 v254, v254, 4, v255
    v_mfma_f32_16x16x32_bf16 v[184:187], a[48:51], a[24:27], v[184:187]
    v_lshl_add_u32 v254, v241, 10, v254
    v_mfma_f32_16x16x32_bf16 v[188:191], a[52:55], a[24:27], v[188:191]
    v_add_u32 v244, s46, v254
    v_mfma_f32_16x16x32_bf16 v[192:195], a[56:59], a[24:27], v[192:195]
    ds_read_b128 a[88:91], v224 offset:37904
    s_mul_i32 s45, s44, 2048
    v_mfma_f32_16x16x32_bf16 v[220:223], a[56:59], a[28:31], v[220:223]
    s_add_u32 s45, s45, 153680
    v_mfma_f32_16x16x32_bf16 v[216:219], a[52:55], a[28:31], v[216:219]
    v_lshlrev_b32 v254, 4, v240
    v_mfma_f32_16x16x32_bf16 v[212:215], a[48:51], a[28:31], v[212:215]
    v_lshl_add_u32 v246, v245, 8, v254
    v_mfma_f32_16x16x32_bf16 v[208:211], a[44:47], a[28:31], v[208:211]
    v_add_u32 v245, s45, v254
    v_mfma_f32_16x16x32_bf16 v[204:207], a[40:43], a[28:31], v[204:207]
    v_add_u32 v246, s45, v246
    v_mfma_f32_16x16x32_bf16 v[200:203], a[36:39], a[28:31], v[200:203]
    v_mfma_f32_16x16x32_bf16 v[196:199], a[32:35], a[28:31], v[196:199]
    s_waitcnt lgkmcnt(0)
    v_mfma_f32_16x16x32_bf16 v[0:3], a[92:95], a[60:63], v[0:3]
    v_mfma_f32_16x16x32_bf16 v[4:7], a[96:99], a[60:63], v[4:7]
    v_mfma_f32_16x16x32_bf16 v[8:11], a[100:103], a[60:63], v[8:11]
    v_mfma_f32_16x16x32_bf16 v[12:15], a[104:107], a[60:63], v[12:15]
    v_mfma_f32_16x16x32_bf16 v[16:19], a[108:111], a[60:63], v[16:19]
    v_mfma_f32_16x16x32_bf16 v[20:23], a[112:115], a[60:63], v[20:23]
    v_mfma_f32_16x16x32_bf16 v[24:27], a[116:119], a[60:63], v[24:27]
    v_mfma_f32_16x16x32_bf16 v[28:31], a[92:95], a[64:67], v[28:31]
    v_mfma_f32_16x16x32_bf16 v[32:35], a[96:99], a[64:67], v[32:35]
    v_mfma_f32_16x16x32_bf16 v[36:39], a[100:103], a[64:67], v[36:39]
    v_mfma_f32_16x16x32_bf16 v[40:43], a[104:107], a[64:67], v[40:43]
    v_mfma_f32_16x16x32_bf16 v[44:47], a[108:111], a[64:67], v[44:47]
    v_mfma_f32_16x16x32_bf16 v[48:51], a[112:115], a[64:67], v[48:51]
    v_mfma_f32_16x16x32_bf16 v[52:55], a[116:119], a[64:67], v[52:55]
    v_mfma_f32_16x16x32_bf16 v[56:59], a[92:95], a[68:71], v[56:59]
    v_mfma_f32_16x16x32_bf16 v[60:63], a[96:99], a[68:71], v[60:63]
    v_mfma_f32_16x16x32_bf16 v[64:67], a[100:103], a[68:71], v[64:67]
    v_mfma_f32_16x16x32_bf16 v[68:71], a[104:107], a[68:71], v[68:71]
    v_mfma_f32_16x16x32_bf16 v[72:75], a[108:111], a[68:71], v[72:75]
    v_mfma_f32_16x16x32_bf16 v[76:79], a[112:115], a[68:71], v[76:79]
    v_mfma_f32_16x16x32_bf16 v[80:83], a[116:119], a[68:71], v[80:83]
    v_mfma_f32_16x16x32_bf16 v[84:87], a[92:95], a[72:75], v[84:87]
    v_mfma_f32_16x16x32_bf16 v[88:91], a[96:99], a[72:75], v[88:91]
    v_mfma_f32_16x16x32_bf16 v[92:95], a[100:103], a[72:75], v[92:95]
    v_mfma_f32_16x16x32_bf16 v[96:99], a[104:107], a[72:75], v[96:99]
    v_mfma_f32_16x16x32_bf16 v[100:103], a[108:111], a[72:75], v[100:103]
    v_mfma_f32_16x16x32_bf16 v[104:107], a[112:115], a[72:75], v[104:107]
    v_mfma_f32_16x16x32_bf16 v[108:111], a[116:119], a[72:75], v[108:111]
    v_mfma_f32_16x16x32_bf16 v[112:115], a[92:95], a[76:79], v[112:115]
    v_mfma_f32_16x16x32_bf16 v[116:119], a[96:99], a[76:79], v[116:119]
    v_mfma_f32_16x16x32_bf16 v[120:123], a[100:103], a[76:79], v[120:123]
    v_mfma_f32_16x16x32_bf16 v[124:127], a[104:107], a[76:79], v[124:127]
    v_mfma_f32_16x16x32_bf16 v[128:131], a[108:111], a[76:79], v[128:131]
    v_mfma_f32_16x16x32_bf16 v[132:135], a[112:115], a[76:79], v[132:135]
    v_mfma_f32_16x16x32_bf16 v[136:139], a[116:119], a[76:79], v[136:139]
    v_mfma_f32_16x16x32_bf16 v[140:143], a[92:95], a[80:83], v[140:143]
    v_mfma_f32_16x16x32_bf16 v[144:147], a[96:99], a[80:83], v[144:147]
    v_mfma_f32_16x16x32_bf16 v[148:151], a[100:103], a[80:83], v[148:151]
    v_mfma_f32_16x16x32_bf16 v[152:155], a[104:107], a[80:83], v[152:155]
    v_mfma_f32_16x16x32_bf16 v[156:159], a[108:111], a[80:83], v[156:159]
    v_mfma_f32_16x16x32_bf16 v[160:163], a[112:115], a[80:83], v[160:163]
    v_mfma_f32_16x16x32_bf16 v[164:167], a[116:119], a[80:83], v[164:167]
    v_mfma_f32_16x16x32_bf16 v[168:171], a[92:95], a[84:87], v[168:171]
    v_mfma_f32_16x16x32_bf16 v[172:175], a[96:99], a[84:87], v[172:175]
    v_mfma_f32_16x16x32_bf16 v[176:179], a[100:103], a[84:87], v[176:179]
    v_mfma_f32_16x16x32_bf16 v[180:183], a[104:107], a[84:87], v[180:183]
    v_mfma_f32_16x16x32_bf16 v[184:187], a[108:111], a[84:87], v[184:187]
    v_mfma_f32_16x16x32_bf16 v[188:191], a[112:115], a[84:87], v[188:191]
    v_mfma_f32_16x16x32_bf16 v[192:195], a[116:119], a[84:87], v[192:195]
    v_mfma_f32_16x16x32_bf16 v[196:199], a[92:95], a[88:91], v[196:199]
    v_mfma_f32_16x16x32_bf16 v[200:203], a[96:99], a[88:91], v[200:203]
    v_mfma_f32_16x16x32_bf16 v[204:207], a[100:103], a[88:91], v[204:207]
    v_mfma_f32_16x16x32_bf16 v[208:211], a[104:107], a[88:91], v[208:211]
    v_mfma_f32_16x16x32_bf16 v[212:215], a[108:111], a[88:91], v[212:215]
    v_mfma_f32_16x16x32_bf16 v[216:219], a[112:115], a[88:91], v[216:219]
    v_mfma_f32_16x16x32_bf16 v[220:223], a[116:119], a[88:91], v[220:223]
    s_nop 7
    ds_read_b128 v[228:231], v245 offset:0
    ds_read_b128 v[232:235], v245 offset:256
    ds_read_b128 v[248:251], v246 offset:0
    s_waitcnt lgkmcnt(0)
    v_pk_mul_f32 v[224:225], v[0:1], v[228:229]
    v_pk_mul_f32 v[226:227], v[2:3], v[228:229]
    v_exp_f32 v224, v224
    v_exp_f32 v225, v225
    v_exp_f32 v226, v226
    v_exp_f32 v227, v227
    v_pk_mul_f32 v[0:1], v[0:1], v[12:13]
    v_pk_fma_f32 v[224:225], v[224:225], v[230:231], v[230:231]
    v_pk_fma_f32 v[226:227], v[226:227], v[230:231], v[230:231]
    v_rcp_f32 v224, v224
    v_rcp_f32 v225, v225
    v_rcp_f32 v226, v226
    v_rcp_f32 v227, v227
    v_pk_mul_f32 v[2:3], v[2:3], v[14:15]
    v_pk_mul_f32 v[0:1], v[0:1], v[224:225]
    v_pk_mul_f32 v[2:3], v[2:3], v[226:227]
    v_pk_mul_f32 v[224:225], v[4:5], v[228:229]
    v_pk_mul_f32 v[226:227], v[6:7], v[228:229]
    v_exp_f32 v224, v224
    v_exp_f32 v225, v225
    v_exp_f32 v226, v226
    v_exp_f32 v227, v227
    v_pk_mul_f32 v[4:5], v[4:5], v[16:17]
    v_pk_fma_f32 v[224:225], v[224:225], v[230:231], v[230:231]
    v_pk_fma_f32 v[226:227], v[226:227], v[230:231], v[230:231]
    v_rcp_f32 v224, v224
    v_rcp_f32 v225, v225
    v_rcp_f32 v226, v226
    v_rcp_f32 v227, v227
    v_pk_mul_f32 v[6:7], v[6:7], v[18:19]
    v_pk_mul_f32 v[4:5], v[4:5], v[224:225]
    v_pk_mul_f32 v[6:7], v[6:7], v[226:227]
    v_pk_mul_f32 v[224:225], v[8:9], v[228:229]
    v_pk_mul_f32 v[226:227], v[10:11], v[228:229]
    v_exp_f32 v224, v224
    v_exp_f32 v225, v225
    v_exp_f32 v226, v226
    v_exp_f32 v227, v227
    v_pk_mul_f32 v[8:9], v[8:9], v[20:21]
    v_pk_fma_f32 v[224:225], v[224:225], v[230:231], v[230:231]
    v_pk_fma_f32 v[226:227], v[226:227], v[230:231], v[230:231]
    v_rcp_f32 v224, v224
    v_rcp_f32 v225, v225
    v_rcp_f32 v226, v226
    v_rcp_f32 v227, v227
    v_pk_mul_f32 v[10:11], v[10:11], v[22:23]
    v_pk_mul_f32 v[8:9], v[8:9], v[224:225]
    v_pk_mul_f32 v[10:11], v[10:11], v[226:227]
    v_permlane16_swap_b32 v24, v52
    v_permlane16_swap_b32 v25, v53
    v_permlane16_swap_b32 v26, v54
    v_permlane16_swap_b32 v27, v55
    v_cvt_pk_bf16_f32 v12, v0, v1
    v_cvt_pk_bf16_f32 v13, v2, v3
    v_cvt_pk_bf16_f32 v14, v4, v5
    v_cvt_pk_bf16_f32 v15, v6, v7
    v_cvt_pk_bf16_f32 v16, v8, v9
    v_cvt_pk_bf16_f32 v17, v10, v11
    v_permlane16_swap_b32 v12, v14
    v_permlane16_swap_b32 v13, v15
    buffer_store_dwordx4 v[12:15], v242, s[20:23], 0 offen offset:0 sc1
    v_pk_mul_f32 v[224:225], v[28:29], v[232:233]
    v_pk_mul_f32 v[226:227], v[30:31], v[232:233]
    v_exp_f32 v224, v224
    v_exp_f32 v225, v225
    v_exp_f32 v226, v226
    v_exp_f32 v227, v227
    v_pk_mul_f32 v[28:29], v[28:29], v[40:41]
    v_pk_fma_f32 v[224:225], v[224:225], v[234:235], v[234:235]
    v_pk_fma_f32 v[226:227], v[226:227], v[234:235], v[234:235]
    v_rcp_f32 v224, v224
    v_rcp_f32 v225, v225
    v_rcp_f32 v226, v226
    v_rcp_f32 v227, v227
    v_pk_mul_f32 v[30:31], v[30:31], v[42:43]
    v_pk_mul_f32 v[28:29], v[28:29], v[224:225]
    v_pk_mul_f32 v[30:31], v[30:31], v[226:227]
    v_pk_mul_f32 v[224:225], v[32:33], v[232:233]
    v_pk_mul_f32 v[226:227], v[34:35], v[232:233]
    v_exp_f32 v224, v224
    v_exp_f32 v225, v225
    v_exp_f32 v226, v226
    v_exp_f32 v227, v227
    v_pk_mul_f32 v[32:33], v[32:33], v[44:45]
    v_pk_fma_f32 v[224:225], v[224:225], v[234:235], v[234:235]
    v_pk_fma_f32 v[226:227], v[226:227], v[234:235], v[234:235]
    v_rcp_f32 v224, v224
    v_rcp_f32 v225, v225
    v_rcp_f32 v226, v226
    v_rcp_f32 v227, v227
    v_pk_mul_f32 v[34:35], v[34:35], v[46:47]
    v_pk_mul_f32 v[32:33], v[32:33], v[224:225]
    v_pk_mul_f32 v[34:35], v[34:35], v[226:227]
    v_pk_mul_f32 v[224:225], v[36:37], v[232:233]
    v_pk_mul_f32 v[226:227], v[38:39], v[232:233]
    v_exp_f32 v224, v224
    v_exp_f32 v225, v225
    v_exp_f32 v226, v226
    v_exp_f32 v227, v227
    v_pk_mul_f32 v[36:37], v[36:37], v[48:49]
    v_pk_fma_f32 v[224:225], v[224:225], v[234:235], v[234:235]
    v_pk_fma_f32 v[226:227], v[226:227], v[234:235], v[234:235]
    v_rcp_f32 v224, v224
    v_rcp_f32 v225, v225
    v_rcp_f32 v226, v226
    v_rcp_f32 v227, v227
    v_pk_mul_f32 v[38:39], v[38:39], v[50:51]
    v_pk_mul_f32 v[36:37], v[36:37], v[224:225]
    v_pk_mul_f32 v[38:39], v[38:39], v[226:227]
    v_cvt_pk_bf16_f32 v40, v28, v29
    v_cvt_pk_bf16_f32 v41, v30, v31
    v_cvt_pk_bf16_f32 v42, v32, v33
    v_cvt_pk_bf16_f32 v43, v34, v35
    v_cvt_pk_bf16_f32 v18, v36, v37
    v_cvt_pk_bf16_f32 v19, v38, v39
    v_permlane16_swap_b32 v40, v42
    v_permlane16_swap_b32 v41, v43
    buffer_store_dwordx4 v[40:43], v242, s[20:23], 0 offen offset:1024 sc1
    v_pk_mul_f32 v[224:225], v[24:25], v[248:249]
    v_pk_mul_f32 v[226:227], v[26:27], v[248:249]
    v_exp_f32 v224, v224
    v_exp_f32 v225, v225
    v_exp_f32 v226, v226
    v_exp_f32 v227, v227
    v_pk_mul_f32 v[24:25], v[24:25], v[52:53]
    v_pk_fma_f32 v[224:225], v[224:225], v[250:251], v[250:251]
    v_pk_fma_f32 v[226:227], v[226:227], v[250:251], v[250:251]
    v_rcp_f32 v224, v224
    v_rcp_f32 v225, v225
    v_rcp_f32 v226, v226
    v_rcp_f32 v227, v227
    v_pk_mul_f32 v[26:27], v[26:27], v[54:55]
    v_pk_mul_f32 v[24:25], v[24:25], v[224:225]
    v_pk_mul_f32 v[26:27], v[26:27], v[226:227]
    v_permlane16_swap_b32 v16, v18
    v_permlane16_swap_b32 v17, v19
    buffer_store_dwordx4 v[16:19], v243, s[20:23], 0 offen offset:0 sc1
    v_cvt_pk_bf16_f32 v20, v24, v25
    v_cvt_pk_bf16_f32 v21, v26, v27
    ds_read_b128 v[228:231], v245 offset:512
    ds_read_b128 v[232:235], v245 offset:768
    ds_read_b128 v[248:251], v246 offset:512
    s_waitcnt lgkmcnt(0)
    v_pk_mul_f32 v[224:225], v[56:57], v[228:229]
    v_pk_mul_f32 v[226:227], v[58:59], v[228:229]
    v_exp_f32 v224, v224
    v_exp_f32 v225, v225
    v_exp_f32 v226, v226
    v_exp_f32 v227, v227
    v_pk_mul_f32 v[56:57], v[56:57], v[68:69]
    v_pk_fma_f32 v[224:225], v[224:225], v[230:231], v[230:231]
    v_pk_fma_f32 v[226:227], v[226:227], v[230:231], v[230:231]
    v_rcp_f32 v224, v224
    v_rcp_f32 v225, v225
    v_rcp_f32 v226, v226
    v_rcp_f32 v227, v227
    v_pk_mul_f32 v[58:59], v[58:59], v[70:71]
    v_pk_mul_f32 v[56:57], v[56:57], v[224:225]
    v_pk_mul_f32 v[58:59], v[58:59], v[226:227]
    v_pk_mul_f32 v[224:225], v[60:61], v[228:229]
    v_pk_mul_f32 v[226:227], v[62:63], v[228:229]
    v_exp_f32 v224, v224
    v_exp_f32 v225, v225
    v_exp_f32 v226, v226
    v_exp_f32 v227, v227
    v_pk_mul_f32 v[60:61], v[60:61], v[72:73]
    v_pk_fma_f32 v[224:225], v[224:225], v[230:231], v[230:231]
    v_pk_fma_f32 v[226:227], v[226:227], v[230:231], v[230:231]
    v_rcp_f32 v224, v224
    v_rcp_f32 v225, v225
    v_rcp_f32 v226, v226
    v_rcp_f32 v227, v227
    v_pk_mul_f32 v[62:63], v[62:63], v[74:75]
    v_pk_mul_f32 v[60:61], v[60:61], v[224:225]
    v_pk_mul_f32 v[62:63], v[62:63], v[226:227]
    v_pk_mul_f32 v[224:225], v[64:65], v[228:229]
    v_pk_mul_f32 v[226:227], v[66:67], v[228:229]
    v_exp_f32 v224, v224
    v_exp_f32 v225, v225
    v_exp_f32 v226, v226
    v_exp_f32 v227, v227
    v_pk_mul_f32 v[64:65], v[64:65], v[76:77]
    v_pk_fma_f32 v[224:225], v[224:225], v[230:231], v[230:231]
    v_pk_fma_f32 v[226:227], v[226:227], v[230:231], v[230:231]
    v_rcp_f32 v224, v224
    v_rcp_f32 v225, v225
    v_rcp_f32 v226, v226
    v_rcp_f32 v227, v227
    v_pk_mul_f32 v[66:67], v[66:67], v[78:79]
    v_pk_mul_f32 v[64:65], v[64:65], v[224:225]
    v_pk_mul_f32 v[66:67], v[66:67], v[226:227]
    v_permlane16_swap_b32 v80, v108
    v_permlane16_swap_b32 v81, v109
    v_permlane16_swap_b32 v82, v110
    v_permlane16_swap_b32 v83, v111
    v_cvt_pk_bf16_f32 v68, v56, v57
    v_cvt_pk_bf16_f32 v69, v58, v59
    v_cvt_pk_bf16_f32 v70, v60, v61
    v_cvt_pk_bf16_f32 v71, v62, v63
    v_cvt_pk_bf16_f32 v72, v64, v65
    v_cvt_pk_bf16_f32 v73, v66, v67
    v_permlane16_swap_b32 v68, v70
    v_permlane16_swap_b32 v69, v71
    buffer_store_dwordx4 v[68:71], v242, s[20:23], 0 offen offset:2048 sc1
    v_pk_mul_f32 v[224:225], v[84:85], v[232:233]
    v_pk_mul_f32 v[226:227], v[86:87], v[232:233]
    v_exp_f32 v224, v224
    v_exp_f32 v225, v225
    v_exp_f32 v226, v226
    v_exp_f32 v227, v227
    v_pk_mul_f32 v[84:85], v[84:85], v[96:97]
    v_pk_fma_f32 v[224:225], v[224:225], v[234:235], v[234:235]
    v_pk_fma_f32 v[226:227], v[226:227], v[234:235], v[234:235]
    v_rcp_f32 v224, v224
    v_rcp_f32 v225, v225
    v_rcp_f32 v226, v226
    v_rcp_f32 v227, v227
    v_pk_mul_f32 v[86:87], v[86:87], v[98:99]
    v_pk_mul_f32 v[84:85], v[84:85], v[224:225]
    v_pk_mul_f32 v[86:87], v[86:87], v[226:227]
    v_pk_mul_f32 v[224:225], v[88:89], v[232:233]
    v_pk_mul_f32 v[226:227], v[90:91], v[232:233]
    v_exp_f32 v224, v224
    v_exp_f32 v225, v225
    v_exp_f32 v226, v226
    v_exp_f32 v227, v227
    v_pk_mul_f32 v[88:89], v[88:89], v[100:101]
    v_pk_fma_f32 v[224:225], v[224:225], v[234:235], v[234:235]
    v_pk_fma_f32 v[226:227], v[226:227], v[234:235], v[234:235]
    v_rcp_f32 v224, v224
    v_rcp_f32 v225, v225
    v_rcp_f32 v226, v226
    v_rcp_f32 v227, v227
    v_pk_mul_f32 v[90:91], v[90:91], v[102:103]
    v_pk_mul_f32 v[88:89], v[88:89], v[224:225]
    v_pk_mul_f32 v[90:91], v[90:91], v[226:227]
    v_pk_mul_f32 v[224:225], v[92:93], v[232:233]
    v_pk_mul_f32 v[226:227], v[94:95], v[232:233]
    v_exp_f32 v224, v224
    v_exp_f32 v225, v225
    v_exp_f32 v226, v226
    v_exp_f32 v227, v227
    v_pk_mul_f32 v[92:93], v[92:93], v[104:105]
    v_pk_fma_f32 v[224:225], v[224:225], v[234:235], v[234:235]
    v_pk_fma_f32 v[226:227], v[226:227], v[234:235], v[234:235]
    v_rcp_f32 v224, v224
    v_rcp_f32 v225, v225
    v_rcp_f32 v226, v226
    v_rcp_f32 v227, v227
    v_pk_mul_f32 v[94:95], v[94:95], v[106:107]
    v_pk_mul_f32 v[92:93], v[92:93], v[224:225]
    v_pk_mul_f32 v[94:95], v[94:95], v[226:227]
    v_cvt_pk_bf16_f32 v96, v84, v85
    v_cvt_pk_bf16_f32 v97, v86, v87
    v_cvt_pk_bf16_f32 v98, v88, v89
    v_cvt_pk_bf16_f32 v99, v90, v91
    v_cvt_pk_bf16_f32 v74, v92, v93
    v_cvt_pk_bf16_f32 v75, v94, v95
    v_permlane16_swap_b32 v96, v98
    v_permlane16_swap_b32 v97, v99
    buffer_store_dwordx4 v[96:99], v242, s[20:23], 0 offen offset:3072 sc1
    v_pk_mul_f32 v[224:225], v[80:81], v[248:249]
    v_pk_mul_f32 v[226:227], v[82:83], v[248:249]
    v_exp_f32 v224, v224
    v_exp_f32 v225, v225
    v_exp_f32 v226, v226
    v_exp_f32 v227, v227
    v_pk_mul_f32 v[80:81], v[80:81], v[108:109]
    v_pk_fma_f32 v[224:225], v[224:225], v[250:251], v[250:251]
    v_pk_fma_f32 v[226:227], v[226:227], v[250:251], v[250:251]
    v_rcp_f32 v224, v224
    v_rcp_f32 v225, v225
    v_rcp_f32 v226, v226
    v_rcp_f32 v227, v227
    v_pk_mul_f32 v[82:83], v[82:83], v[110:111]
    v_pk_mul_f32 v[80:81], v[80:81], v[224:225]
    v_pk_mul_f32 v[82:83], v[82:83], v[226:227]
    v_permlane16_swap_b32 v72, v74
    v_permlane16_swap_b32 v73, v75
    buffer_store_dwordx4 v[72:75], v243, s[20:23], 0 offen offset:2048 sc1
    v_cvt_pk_bf16_f32 v22, v80, v81
    v_cvt_pk_bf16_f32 v23, v82, v83
    s_nop 1
    v_permlane32_swap_b32 v20, v22
    v_permlane32_swap_b32 v21, v23
    buffer_store_dwordx4 v[20:23], v244, s[20:23], 0 offen offset:0 sc1
    ds_read_b128 v[228:231], v245 offset:1024
    ds_read_b128 v[232:235], v245 offset:1280
    ds_read_b128 v[248:251], v246 offset:1024
    s_waitcnt lgkmcnt(0)
    v_pk_mul_f32 v[224:225], v[112:113], v[228:229]
    v_pk_mul_f32 v[226:227], v[114:115], v[228:229]
    v_exp_f32 v224, v224
    v_exp_f32 v225, v225
    v_exp_f32 v226, v226
    v_exp_f32 v227, v227
    v_pk_mul_f32 v[112:113], v[112:113], v[124:125]
    v_pk_fma_f32 v[224:225], v[224:225], v[230:231], v[230:231]
    v_pk_fma_f32 v[226:227], v[226:227], v[230:231], v[230:231]
    v_rcp_f32 v224, v224
    v_rcp_f32 v225, v225
    v_rcp_f32 v226, v226
    v_rcp_f32 v227, v227
    v_pk_mul_f32 v[114:115], v[114:115], v[126:127]
    v_pk_mul_f32 v[112:113], v[112:113], v[224:225]
    v_pk_mul_f32 v[114:115], v[114:115], v[226:227]
    v_pk_mul_f32 v[224:225], v[116:117], v[228:229]
    v_pk_mul_f32 v[226:227], v[118:119], v[228:229]
    v_exp_f32 v224, v224
    v_exp_f32 v225, v225
    v_exp_f32 v226, v226
    v_exp_f32 v227, v227
    v_pk_mul_f32 v[116:117], v[116:117], v[128:129]
    v_pk_fma_f32 v[224:225], v[224:225], v[230:231], v[230:231]
    v_pk_fma_f32 v[226:227], v[226:227], v[230:231], v[230:231]
    v_rcp_f32 v224, v224
    v_rcp_f32 v225, v225
    v_rcp_f32 v226, v226
    v_rcp_f32 v227, v227
    v_pk_mul_f32 v[118:119], v[118:119], v[130:131]
    v_pk_mul_f32 v[116:117], v[116:117], v[224:225]
    v_pk_mul_f32 v[118:119], v[118:119], v[226:227]
    v_pk_mul_f32 v[224:225], v[120:121], v[228:229]
    v_pk_mul_f32 v[226:227], v[122:123], v[228:229]
    v_exp_f32 v224, v224
    v_exp_f32 v225, v225
    v_exp_f32 v226, v226
    v_exp_f32 v227, v227
    v_pk_mul_f32 v[120:121], v[120:121], v[132:133]
    v_pk_fma_f32 v[224:225], v[224:225], v[230:231], v[230:231]
    v_pk_fma_f32 v[226:227], v[226:227], v[230:231], v[230:231]
    v_rcp_f32 v224, v224
    v_rcp_f32 v225, v225
    v_rcp_f32 v226, v226
    v_rcp_f32 v227, v227
    v_pk_mul_f32 v[122:123], v[122:123], v[134:135]
    v_pk_mul_f32 v[120:121], v[120:121], v[224:225]
    v_pk_mul_f32 v[122:123], v[122:123], v[226:227]
    v_permlane16_swap_b32 v136, v164
    v_permlane16_swap_b32 v137, v165
    v_permlane16_swap_b32 v138, v166
    v_permlane16_swap_b32 v139, v167
    v_cvt_pk_bf16_f32 v124, v112, v113
    v_cvt_pk_bf16_f32 v125, v114, v115
    v_cvt_pk_bf16_f32 v126, v116, v117
    v_cvt_pk_bf16_f32 v127, v118, v119
    v_cvt_pk_bf16_f32 v128, v120, v121
    v_cvt_pk_bf16_f32 v129, v122, v123
    v_permlane16_swap_b32 v124, v126
    v_permlane16_swap_b32 v125, v127
    buffer_store_dwordx4 v[124:127], v242, s[20:23], s40 offen offset:0 sc1
    v_pk_mul_f32 v[224:225], v[140:141], v[232:233]
    v_pk_mul_f32 v[226:227], v[142:143], v[232:233]
    v_exp_f32 v224, v224
    v_exp_f32 v225, v225
    v_exp_f32 v226, v226
    v_exp_f32 v227, v227
    v_pk_mul_f32 v[140:141], v[140:141], v[152:153]
    v_pk_fma_f32 v[224:225], v[224:225], v[234:235], v[234:235]
    v_pk_fma_f32 v[226:227], v[226:227], v[234:235], v[234:235]
    v_rcp_f32 v224, v224
    v_rcp_f32 v225, v225
    v_rcp_f32 v226, v226
    v_rcp_f32 v227, v227
    v_pk_mul_f32 v[142:143], v[142:143], v[154:155]
    v_pk_mul_f32 v[140:141], v[140:141], v[224:225]
    v_pk_mul_f32 v[142:143], v[142:143], v[226:227]
    v_pk_mul_f32 v[224:225], v[144:145], v[232:233]
    v_pk_mul_f32 v[226:227], v[146:147], v[232:233]
    v_exp_f32 v224, v224
    v_exp_f32 v225, v225
    v_exp_f32 v226, v226
    v_exp_f32 v227, v227
    v_pk_mul_f32 v[144:145], v[144:145], v[156:157]
    v_pk_fma_f32 v[224:225], v[224:225], v[234:235], v[234:235]
    v_pk_fma_f32 v[226:227], v[226:227], v[234:235], v[234:235]
    v_rcp_f32 v224, v224
    v_rcp_f32 v225, v225
    v_rcp_f32 v226, v226
    v_rcp_f32 v227, v227
    v_pk_mul_f32 v[146:147], v[146:147], v[158:159]
    v_pk_mul_f32 v[144:145], v[144:145], v[224:225]
    v_pk_mul_f32 v[146:147], v[146:147], v[226:227]
    v_pk_mul_f32 v[224:225], v[148:149], v[232:233]
    v_pk_mul_f32 v[226:227], v[150:151], v[232:233]
    v_exp_f32 v224, v224
    v_exp_f32 v225, v225
    v_exp_f32 v226, v226
    v_exp_f32 v227, v227
    v_pk_mul_f32 v[148:149], v[148:149], v[160:161]
    v_pk_fma_f32 v[224:225], v[224:225], v[234:235], v[234:235]
    v_pk_fma_f32 v[226:227], v[226:227], v[234:235], v[234:235]
    v_rcp_f32 v224, v224
    v_rcp_f32 v225, v225
    v_rcp_f32 v226, v226
    v_rcp_f32 v227, v227
    v_pk_mul_f32 v[150:151], v[150:151], v[162:163]
    v_pk_mul_f32 v[148:149], v[148:149], v[224:225]
    v_pk_mul_f32 v[150:151], v[150:151], v[226:227]
    v_cvt_pk_bf16_f32 v152, v140, v141
    v_cvt_pk_bf16_f32 v153, v142, v143
    v_cvt_pk_bf16_f32 v154, v144, v145
    v_cvt_pk_bf16_f32 v155, v146, v147
    v_cvt_pk_bf16_f32 v130, v148, v149
    v_cvt_pk_bf16_f32 v131, v150, v151
    v_permlane16_swap_b32 v152, v154
    v_permlane16_swap_b32 v153, v155
    buffer_store_dwordx4 v[152:155], v242, s[20:23], s40 offen offset:1024 sc1
    v_pk_mul_f32 v[224:225], v[136:137], v[248:249]
    v_pk_mul_f32 v[226:227], v[138:139], v[248:249]
    v_exp_f32 v224, v224
    v_exp_f32 v225, v225
    v_exp_f32 v226, v226
    v_exp_f32 v227, v227
    v_pk_mul_f32 v[136:137], v[136:137], v[164:165]
    v_pk_fma_f32 v[224:225], v[224:225], v[250:251], v[250:251]
    v_pk_fma_f32 v[226:227], v[226:227], v[250:251], v[250:251]
    v_rcp_f32 v224, v224
    v_rcp_f32 v225, v225
    v_rcp_f32 v226, v226
    v_rcp_f32 v227, v227
    v_pk_mul_f32 v[138:139], v[138:139], v[166:167]
    v_pk_mul_f32 v[136:137], v[136:137], v[224:225]
    v_pk_mul_f32 v[138:139], v[138:139], v[226:227]
    v_permlane16_swap_b32 v128, v130
    v_permlane16_swap_b32 v129, v131
    buffer_store_dwordx4 v[128:131], v243, s[20:23], s40 offen offset:0 sc1
    v_cvt_pk_bf16_f32 v132, v136, v137
    v_cvt_pk_bf16_f32 v133, v138, v139
    ds_read_b128 v[228:231], v245 offset:1536
    ds_read_b128 v[232:235], v245 offset:1792
    ds_read_b128 v[248:251], v246 offset:1536
    s_waitcnt lgkmcnt(0)
    v_pk_mul_f32 v[224:225], v[168:169], v[228:229]
    v_pk_mul_f32 v[226:227], v[170:171], v[228:229]
    v_exp_f32 v224, v224
    v_exp_f32 v225, v225
    v_exp_f32 v226, v226
    v_exp_f32 v227, v227
    v_pk_mul_f32 v[168:169], v[168:169], v[180:181]
    v_pk_fma_f32 v[224:225], v[224:225], v[230:231], v[230:231]
    v_pk_fma_f32 v[226:227], v[226:227], v[230:231], v[230:231]
    v_rcp_f32 v224, v224
    v_rcp_f32 v225, v225
    v_rcp_f32 v226, v226
    v_rcp_f32 v227, v227
    v_pk_mul_f32 v[170:171], v[170:171], v[182:183]
    v_pk_mul_f32 v[168:169], v[168:169], v[224:225]
    v_pk_mul_f32 v[170:171], v[170:171], v[226:227]
    v_pk_mul_f32 v[224:225], v[172:173], v[228:229]
    v_pk_mul_f32 v[226:227], v[174:175], v[228:229]
    v_exp_f32 v224, v224
    v_exp_f32 v225, v225
    v_exp_f32 v226, v226
    v_exp_f32 v227, v227
    v_pk_mul_f32 v[172:173], v[172:173], v[184:185]
    v_pk_fma_f32 v[224:225], v[224:225], v[230:231], v[230:231]
    v_pk_fma_f32 v[226:227], v[226:227], v[230:231], v[230:231]
    v_rcp_f32 v224, v224
    v_rcp_f32 v225, v225
    v_rcp_f32 v226, v226
    v_rcp_f32 v227, v227
    v_pk_mul_f32 v[174:175], v[174:175], v[186:187]
    v_pk_mul_f32 v[172:173], v[172:173], v[224:225]
    v_pk_mul_f32 v[174:175], v[174:175], v[226:227]
    v_pk_mul_f32 v[224:225], v[176:177], v[228:229]
    v_pk_mul_f32 v[226:227], v[178:179], v[228:229]
    v_exp_f32 v224, v224
    v_exp_f32 v225, v225
    v_exp_f32 v226, v226
    v_exp_f32 v227, v227
    v_pk_mul_f32 v[176:177], v[176:177], v[188:189]
    v_pk_fma_f32 v[224:225], v[224:225], v[230:231], v[230:231]
    v_pk_fma_f32 v[226:227], v[226:227], v[230:231], v[230:231]
    v_rcp_f32 v224, v224
    v_rcp_f32 v225, v225
    v_rcp_f32 v226, v226
    v_rcp_f32 v227, v227
    v_pk_mul_f32 v[178:179], v[178:179], v[190:191]
    v_pk_mul_f32 v[176:177], v[176:177], v[224:225]
    v_pk_mul_f32 v[178:179], v[178:179], v[226:227]
    v_permlane16_swap_b32 v192, v220
    v_permlane16_swap_b32 v193, v221
    v_permlane16_swap_b32 v194, v222
    v_permlane16_swap_b32 v195, v223
    v_cvt_pk_bf16_f32 v180, v168, v169
    v_cvt_pk_bf16_f32 v181, v170, v171
    v_cvt_pk_bf16_f32 v182, v172, v173
    v_cvt_pk_bf16_f32 v183, v174, v175
    v_cvt_pk_bf16_f32 v184, v176, v177
    v_cvt_pk_bf16_f32 v185, v178, v179
    v_permlane16_swap_b32 v180, v182
    v_permlane16_swap_b32 v181, v183
    buffer_store_dwordx4 v[180:183], v242, s[20:23], s40 offen offset:2048 sc1
    v_pk_mul_f32 v[224:225], v[196:197], v[232:233]
    v_pk_mul_f32 v[226:227], v[198:199], v[232:233]
    v_exp_f32 v224, v224
    v_exp_f32 v225, v225
    v_exp_f32 v226, v226
    v_exp_f32 v227, v227
    v_pk_mul_f32 v[196:197], v[196:197], v[208:209]
    v_pk_fma_f32 v[224:225], v[224:225], v[234:235], v[234:235]
    v_pk_fma_f32 v[226:227], v[226:227], v[234:235], v[234:235]
    v_rcp_f32 v224, v224
    v_rcp_f32 v225, v225
    v_rcp_f32 v226, v226
    v_rcp_f32 v227, v227
    v_pk_mul_f32 v[198:199], v[198:199], v[210:211]
    v_pk_mul_f32 v[196:197], v[196:197], v[224:225]
    v_pk_mul_f32 v[198:199], v[198:199], v[226:227]
    v_pk_mul_f32 v[224:225], v[200:201], v[232:233]
    v_pk_mul_f32 v[226:227], v[202:203], v[232:233]
    v_exp_f32 v224, v224
    v_exp_f32 v225, v225
    v_exp_f32 v226, v226
    v_exp_f32 v227, v227
    v_pk_mul_f32 v[200:201], v[200:201], v[212:213]
    v_pk_fma_f32 v[224:225], v[224:225], v[234:235], v[234:235]
    v_pk_fma_f32 v[226:227], v[226:227], v[234:235], v[234:235]
    v_rcp_f32 v224, v224
    v_rcp_f32 v225, v225
    v_rcp_f32 v226, v226
    v_rcp_f32 v227, v227
    v_pk_mul_f32 v[202:203], v[202:203], v[214:215]
    v_pk_mul_f32 v[200:201], v[200:201], v[224:225]
    v_pk_mul_f32 v[202:203], v[202:203], v[226:227]
    v_pk_mul_f32 v[224:225], v[204:205], v[232:233]
    v_pk_mul_f32 v[226:227], v[206:207], v[232:233]
    v_exp_f32 v224, v224
    v_exp_f32 v225, v225
    v_exp_f32 v226, v226
    v_exp_f32 v227, v227
    v_pk_mul_f32 v[204:205], v[204:205], v[216:217]
    v_pk_fma_f32 v[224:225], v[224:225], v[234:235], v[234:235]
    v_pk_fma_f32 v[226:227], v[226:227], v[234:235], v[234:235]
    v_rcp_f32 v224, v224
    v_rcp_f32 v225, v225
    v_rcp_f32 v226, v226
    v_rcp_f32 v227, v227
    v_pk_mul_f32 v[206:207], v[206:207], v[218:219]
    v_pk_mul_f32 v[204:205], v[204:205], v[224:225]
    v_pk_mul_f32 v[206:207], v[206:207], v[226:227]
    v_cvt_pk_bf16_f32 v208, v196, v197
    v_cvt_pk_bf16_f32 v209, v198, v199
    v_cvt_pk_bf16_f32 v210, v200, v201
    v_cvt_pk_bf16_f32 v211, v202, v203
    v_cvt_pk_bf16_f32 v186, v204, v205
    v_cvt_pk_bf16_f32 v187, v206, v207
    v_permlane16_swap_b32 v208, v210
    v_permlane16_swap_b32 v209, v211
    buffer_store_dwordx4 v[208:211], v242, s[20:23], s40 offen offset:3072 sc1
    v_pk_mul_f32 v[224:225], v[192:193], v[248:249]
    v_pk_mul_f32 v[226:227], v[194:195], v[248:249]
    v_exp_f32 v224, v224
    v_exp_f32 v225, v225
    v_exp_f32 v226, v226
    v_exp_f32 v227, v227
    v_pk_mul_f32 v[192:193], v[192:193], v[220:221]
    v_pk_fma_f32 v[224:225], v[224:225], v[250:251], v[250:251]
    v_pk_fma_f32 v[226:227], v[226:227], v[250:251], v[250:251]
    v_rcp_f32 v224, v224
    v_rcp_f32 v225, v225
    v_rcp_f32 v226, v226
    v_rcp_f32 v227, v227
    v_pk_mul_f32 v[194:195], v[194:195], v[222:223]
    v_pk_mul_f32 v[192:193], v[192:193], v[224:225]
    v_pk_mul_f32 v[194:195], v[194:195], v[226:227]
    v_permlane16_swap_b32 v184, v186
    v_permlane16_swap_b32 v185, v187
    buffer_store_dwordx4 v[184:187], v243, s[20:23], s40 offen offset:2048 sc1
    v_cvt_pk_bf16_f32 v134, v192, v193
    v_cvt_pk_bf16_f32 v135, v194, v195
    s_nop 1
    v_permlane32_swap_b32 v132, v134
    v_permlane32_swap_b32 v133, v135
    buffer_store_dwordx4 v[132:135], v244, s[20:23], s40 offen offset:0 sc1
L_kc_kernel_done_1:
    s_endpgm
.section .rodata,"a"
.p2align 6
.amdhsa_kernel kc_kernel
  .amdhsa_next_free_vgpr 420
  .amdhsa_next_free_sgpr 102
  .amdhsa_accum_offset 256
  .amdhsa_group_segment_fixed_size 0
  .amdhsa_kernarg_size 96
  .amdhsa_user_sgpr_count 2
  .amdhsa_user_sgpr_kernarg_segment_ptr 1
  .amdhsa_system_sgpr_workgroup_id_x 1
  .amdhsa_float_denorm_mode_32 3
  .amdhsa_float_denorm_mode_16_64 3
.end_amdhsa_kernel
.text
.globl kd_kernel
.p2align 8
.type kd_kernel,@function
kd_kernel:
    s_cmp_ge_u32 s2, 256
    s_cbranch_scc1 L_kd_kernel_done_1
    s_load_dwordx4 s[8:11], s[0:1], 64
    s_load_dwordx2 s[4:5], s[0:1], 88
    v_and_b32 v140, 63, v0
    v_lshrrev_b32 v148, 6, v0
    s_and_b32 s40, s2, 7
    v_readfirstlane_b32 s28, v148
    s_lshr_b32 s41, s2, 3
    s_lshr_b32 s42, s40, 1
    s_lshl_b32 s42, s42, 2
    s_lshr_b32 s43, s41, 3
    s_add_u32 s29, s42, s43
    s_and_b32 s42, s40, 1
    s_lshl_b32 s42, s42, 3
    s_and_b32 s43, s41, 7
    s_add_u32 s30, s42, s43
    s_lshl_b32 s42, s29, 1
    s_add_u32 s42, s42, s30
    s_and_b32 s42, s42, 7
    s_mov_b32 s44, 0x3030303
    s_mov_b32 s45, 0x3030303
    s_lshl_b64 s[44:45], s[44:45], s42
    s_and_b32 s45, s45, 0x0fffffff
    v_mov_b32 v149, s45
    v_lshrrev_b32 v148, v140, v149
    v_and_b32 v148, 1, v148
    v_cmp_eq_u32 vcc, 1, v148
    v_subrev_u32 v150, 2, v140
    v_max_i32 v150, 0, v150
    v_add_u32 v151, 3, v140
    v_min_u32 v151, 28, v151
    v_cndmask_b32 v150, v140, v150, vcc
    v_cndmask_b32 v151, v151, v140, vcc
    v_bfm_b32 v152, v150, 0
    v_and_b32 v152, v152, v149
    v_bcnt_u32_b32 v152, v152, 0
    v_sub_u32 v150, v150, v152
    v_bfm_b32 v152, v151, 0
    v_and_b32 v152, v152, v149
    v_bcnt_u32_b32 v150, v152, v150
    v_cmp_gt_u32 vcc, 28, v140
    s_nop 1
    v_cndmask_b32 v150, v140, v150, vcc
    v_lshlrev_b32 v150, 2, v150
    ds_permute_b32 v141, v150, v140
    v_lshlrev_b32 v148, 4, v140
    s_add_u32 s42, s28, 1
    s_and_b32 s42, s42, 3
    s_lshl_b32 s43, s42, 11
    v_add_u32 v128, s43, v148
    s_mul_i32 s43, s42, 24576
    s_add_u32 s43, s43, 65536
    v_add_u32 v142, s43, v148
    s_add_u32 s42, s28, 2
    s_and_b32 s42, s42, 3
    s_lshl_b32 s43, s42, 11
    v_add_u32 v129, s43, v148
    s_mul_i32 s43, s42, 24576
    s_add_u32 s43, s43, 73728
    v_add_u32 v143, s43, v148
    s_add_u32 s42, s28, 3
    s_and_b32 s42, s42, 3
    s_lshl_b32 s43, s42, 11
    v_add_u32 v130, s43, v148
    s_mul_i32 s43, s42, 24576
    s_add_u32 s43, s43, 81920
    v_add_u32 v144, s43, v148
    s_add_u32 s42, s28, 4
    s_and_b32 s42, s42, 3
    s_lshl_b32 s43, s42, 11
    v_add_u32 v131, s43, v148
    s_mul_i32 s43, s42, 24576
    s_add_u32 s43, s43, 65536
    v_add_u32 v145, s43, v148
    v_lshrrev_b32 v148, 3, v140
    v_and_b32 v149, 6, v148
    v_and_b32 v150, 7, v140
    v_xor_b32 v150, v150, v149
    v_and_b32 v151, 3, v148
    v_lshrrev_b32 v152, 2, v148
    v_lshl_add_u32 v151, v152, 3, v151
    v_lshlrev_b32 v151, 11, v151
    v_lshl_add_u32 v151, v150, 4, v151
    s_lshl_b32 s42, s30, 7
    v_add_u32 v151, s42, v151
    v_add_u32 v132, 4096, v151
    v_add_u32 v133, 35840, v151
    v_add_u32 v134, 10240, v151
    v_add_u32 v135, 41984, v151
    s_lshl_b32 s34, s28, 14
    s_mul_i32 s40, s29, 917504
    s_add_u32 s40, s40, 0x2000000
    s_waitcnt lgkmcnt(0)
    s_bfe_u32 s42, s2, 0x20001
    s_lshl_b32 s42, s42, 3
    v_add_u32 v141, s42, v141
    v_subrev_u32 v148, 28, v141
    v_min_u32 v141, v141, v148
    v_lshlrev_b32 v141, 2, v141
    v_add_u32 v141, s28, v141
    v_lshlrev_b32 v141, 13, v141
    s_add_u32 s12, s4, s40
    v_readlane_b32 s36, v141, 0
    s_addc_u32 s13, s5, 0
    s_mov_b32 s14, 0xe0000
    s_mov_b32 s15, 0x20000
    s_sub_u32 s16, s8, 0x1000
    s_subb_u32 s17, s9, 0
    s_mov_b32 s18, 0x701000
    s_mov_b32 s19, 0x20000
    s_lshl_b32 s32, s36, 3
    s_add_u32 m0, s34, 0
    s_nop 0
    buffer_load_dwordx4 v132, s[16:19], s32 offen offset:0  lds
    buffer_load_dwordx4 v133, s[16:19], s32 offen offset:1024  lds
    buffer_load_dwordx4 v134, s[16:19], s32 offen offset:2048  lds
    buffer_load_dwordx4 v135, s[16:19], s32 offen offset:3072  lds
    s_mov_b32 s31, s36
    v_readlane_b32 s36, v141, 1
    s_nop 2
    s_lshl_b32 s32, s36, 3
    s_add_u32 m0, s34, 4096
    s_nop 0
    buffer_load_dwordx4 v132, s[16:19], s32 offen offset:0  lds
    buffer_load_dwordx4 v133, s[16:19], s32 offen offset:1024  lds
    buffer_load_dwordx4 a[0:3], v128, s[12:15], s31 offen offset:0
    buffer_load_dwordx4 v134, s[16:19], s32 offen offset:2048  lds
    buffer_load_dwordx4 v135, s[16:19], s32 offen offset:3072  lds
    buffer_load_dwordx4 a[4:7], v128, s[12:15], s31 offen offset:1024
    buffer_load_dwordx4 a[8:11], v129, s[12:15], s31 offen offset:0
    buffer_load_dwordx4 a[12:15], v129, s[12:15], s31 offen offset:1024
    buffer_load_dwordx4 a[16:19], v130, s[12:15], s31 offen offset:0
    buffer_load_dwordx4 a[20:23], v130, s[12:15], s31 offen offset:1024
    buffer_load_dwordx4 a[24:27], v131, s[12:15], s31 offen offset:0
    buffer_load_dwordx4 a[28:31], v131, s[12:15], s31 offen offset:1024
    s_mov_b32 s31, s36
    v_readlane_b32 s36, v141, 2
    s_nop 2
    s_lshl_b32 s32, s36, 3
    s_add_u32 m0, s34, 8192
    s_nop 0
    buffer_load_dwordx4 v132, s[16:19], s32 offen offset:0  lds
    buffer_load_dwordx4 v133, s[16:19], s32 offen offset:1024  lds
    buffer_load_dwordx4 a[32:35], v128, s[12:15], s31 offen offset:0
    buffer_load_dwordx4 v134, s[16:19], s32 offen offset:2048  lds
    buffer_load_dwordx4 v135, s[16:19], s32 offen offset:3072  lds
    buffer_load_dwordx4 a[36:39], v128, s[12:15], s31 offen offset:1024
    buffer_load_dwordx4 a[40:43], v129, s[12:15], s31 offen offset:0
    buffer_load_dwordx4 a[44:47], v129, s[12:15], s31 offen offset:1024
    buffer_load_dwordx4 a[48:51], v130, s[12:15], s31 offen offset:0
    buffer_load_dwordx4 a[52:55], v130, s[12:15], s31 offen offset:1024
    buffer_load_dwordx4 a[56:59], v131, s[12:15], s31 offen offset:0
    buffer_load_dwordx4 a[60:63], v131, s[12:15], s31 offen offset:1024
    s_mov_b32 s31, s36
    v_readlane_b32 s36, v141, 3
    s_nop 2
    s_lshl_b32 s32, s36, 3
    v_lshrrev_b32 v148, 2, v140
    v_and_b32 v149, 6, v148
    v_and_b32 v150, 3, v140
    v_lshlrev_b32 v150, 3, v150
    v_lshl_add_u32 v150, v148, 7, v150
    v_add_u32 v150, s34, v150
    v_xor_b32 v151, 0, v149
    v_lshl_add_u32 v136, v151, 4, v150
    v_xor_b32 v151, 2, v149
    v_lshl_add_u32 v137, v151, 4, v150
    v_xor_b32 v151, 4, v149
    v_lshl_add_u32 v138, v151, 4, v150
    v_xor_b32 v151, 6, v149
    v_lshl_add_u32 v139, v151, 4, v150
    s_mov_b32 s20, s10
    s_mov_b32 s21, s11
    s_mov_b32 s22, 0x400000
    s_mov_b32 s23, 0x20000
    s_add_u32 s24, s4, 0x1000000
    s_addc_u32 s25, s5, 0
    s_mov_b32 s26, 0x400000
    s_mov_b32 s27, 0x20000
    s_add_u32 s52, s4, 0x1850000
    s_addc_u32 s53, s5, 0
    s_mov_b32 s54, 0x4000
    s_mov_b32 s55, 0x20000
    v_and_b32 v148, 15, v140
    v_lshrrev_b32 v149, 4, v140
    v_and_b32 v152, 1, v149
    v_lshrrev_b32 v153, 1, v149
    v_lshl_add_u32 v150, v152, 1, v153
    s_lshl_b32 s42, s29, 3
    s_lshl_b32 s43, s28, 1
    s_add_u32 s42, s42, s43
    s_lshl_b32 s43, s42, 6
    s_lshr_b32 s44, s30, 3
    s_lshl_b32 s44, s44, 13
    s_add_u32 s43, s43, s44
    v_lshlrev_b32 v177, 2, v148
    v_add_u32 v177, s43, v177
    s_lshr_b32 s43, s42, 4
    s_lshl_b32 s43, s43, 4
    s_add_u32 s43, s43, s30
    s_lshl_b32 s43, s43, 15
    s_and_b32 s44, s42, 15
    s_lshl_b32 s44, s44, 10
    s_add_u32 s43, s43, s44
    s_add_u32 s44, s43, 0x4000
    v_lshl_add_u32 v151, v150, 4, v148
    v_lshlrev_b32 v151, 4, v151
    s_lshl_b32 s45, s28, 20
    s_lshl_b32 s46, s29, 11
    s_add_u32 s45, s45, s46
    s_lshl_b32 s46, s30, 7
    s_add_u32 s45, s45, s46
    s_add_u32 s46, s45, 0x80000
    v_and_b32 v152, 7, v148
    v_xor_b32 v152, v152, v150
    v_lshlrev_b32 v156, 7, v148
    v_lshl_add_u32 v156, v152, 4, v156
    v_add_u32 v156, s34, v156
    v_xor_b32 v158, 64, v156
    v_lshrrev_b32 v152, 3, v140
    v_and_b32 v153, 7, v140
    v_lshlrev_b32 v146, 15, v152
    v_lshl_add_u32 v146, v153, 4, v146
    v_xor_b32 v153, v153, v152
    v_lshlrev_b32 v157, 7, v152
    v_lshl_add_u32 v157, v153, 4, v157
    v_add_u32 v157, s34, v157
    s_add_u32 s46, s45, 0x40000
    s_add_u32 s47, s45, 0x80000
    s_add_u32 s48, s45, 0xc0000
    s_waitcnt vmcnt(24)
    ds_read_b64_tr_b16 a[96:97], v136 offset:0
    ds_read_b64_tr_b16 a[98:99], v136 offset:2048
    ds_read_b64_tr_b16 a[100:101], v137 offset:0
    ds_read_b64_tr_b16 a[102:103], v137 offset:2048
    ds_read_b64_tr_b16 a[104:105], v138 offset:0
    ds_read_b64_tr_b16 a[106:107], v138 offset:2048
    ds_read_b64_tr_b16 a[108:109], v139 offset:0
    ds_read_b64_tr_b16 a[110:111], v139 offset:2048
    s_waitcnt vmcnt(21) lgkmcnt(0)
    v_mfma_f32_16x16x32_bf16 v[0:3], a[96:99], a[0:3], 0
    s_add_u32 m0, s34, 12288
    s_nop 0
    buffer_load_dwordx4 v132, s[16:19], s32 offen offset:0  lds
    v_mfma_f32_16x16x32_bf16 v[4:7], a[100:103], a[0:3], 0
    buffer_load_dwordx4 v133, s[16:19], s32 offen offset:1024  lds
    v_mfma_f32_16x16x32_bf16 v[8:11], a[104:107], a[0:3], 0
    buffer_load_dwordx4 a[64:67], v128, s[12:15], s31 offen offset:0
    v_mfma_f32_16x16x32_bf16 v[12:15], a[108:111], a[0:3], 0
    s_waitcnt vmcnt(21)
    v_mfma_f32_16x16x32_bf16 v[16:19], a[96:99], a[4:7], 0
    buffer_load_dwordx4 v134, s[16:19], s32 offen offset:2048  lds
    v_mfma_f32_16x16x32_bf16 v[20:23], a[100:103], a[4:7], 0
    buffer_load_dwordx4 v135, s[16:19], s32 offen offset:3072  lds
    v_mfma_f32_16x16x32_bf16 v[24:27], a[104:107], a[4:7], 0
    buffer_load_dwordx4 a[68:71], v128, s[12:15], s31 offen offset:1024
    v_mfma_f32_16x16x32_bf16 v[28:31], a[108:111], a[4:7], 0
    s_waitcnt vmcnt(23)
    v_mfma_f32_16x16x32_bf16 v[32:35], a[96:99], a[8:11], 0
    buffer_load_dwordx4 a[72:75], v129, s[12:15], s31 offen offset:0
    v_mfma_f32_16x16x32_bf16 v[36:39], a[100:103], a[8:11], 0
    ds_read_b64_tr_b16 a[112:113], v136 offset:4096
    v_mfma_f32_16x16x32_bf16 v[40:43], a[104:107], a[8:11], 0
    ds_read_b64_tr_b16 a[114:115], v136 offset:6144
    v_mfma_f32_16x16x32_bf16 v[44:47], a[108:111], a[8:11], 0
    s_waitcnt vmcnt(23)
    v_mfma_f32_16x16x32_bf16 v[48:51], a[96:99], a[12:15], 0
    buffer_load_dwordx4 a[76:79], v129, s[12:15], s31 offen offset:1024
    v_mfma_f32_16x16x32_bf16 v[52:55], a[100:103], a[12:15], 0
    ds_read_b64_tr_b16 a[116:117], v137 offset:4096
    v_mfma_f32_16x16x32_bf16 v[56:59], a[104:107], a[12:15], 0
    ds_read_b64_tr_b16 a[118:119], v137 offset:6144
    v_mfma_f32_16x16x32_bf16 v[60:63], a[108:111], a[12:15], 0
    s_waitcnt vmcnt(23)
    v_mfma_f32_16x16x32_bf16 v[64:67], a[96:99], a[16:19], 0
    buffer_load_dwordx4 a[80:83], v130, s[12:15], s31 offen offset:0
    v_mfma_f32_16x16x32_bf16 v[68:71], a[100:103], a[16:19], 0
    ds_read_b64_tr_b16 a[120:121], v138 offset:4096
    v_mfma_f32_16x16x32_bf16 v[72:75], a[104:107], a[16:19], 0
    ds_read_b64_tr_b16 a[122:123], v138 offset:6144
    v_mfma_f32_16x16x32_bf16 v[76:79], a[108:111], a[16:19], 0
    s_waitcnt vmcnt(23)
    v_mfma_f32_16x16x32_bf16 v[80:83], a[96:99], a[20:23], 0
    buffer_load_dwordx4 a[84:87], v130, s[12:15], s31 offen offset:1024
    v_mfma_f32_16x16x32_bf16 v[84:87], a[100:103], a[20:23], 0
    ds_read_b64_tr_b16 a[124:125], v139 offset:4096
    v_mfma_f32_16x16x32_bf16 v[88:91], a[104:107], a[20:23], 0
    ds_read_b64_tr_b16 a[126:127], v139 offset:6144
    v_mfma_f32_16x16x32_bf16 v[92:95], a[108:111], a[20:23], 0
    s_waitcnt vmcnt(23)
    v_mfma_f32_16x16x32_bf16 v[96:99], a[96:99], a[24:27], 0
    buffer_load_dwordx4 a[88:91], v131, s[12:15], s31 offen offset:0
    v_mfma_f32_16x16x32_bf16 v[100:103], a[100:103], a[24:27], 0
    v_mfma_f32_16x16x32_bf16 v[104:107], a[104:107], a[24:27], 0
    v_mfma_f32_16x16x32_bf16 v[108:111], a[108:111], a[24:27], 0
    s_waitcnt vmcnt(23)
    v_mfma_f32_16x16x32_bf16 v[112:115], a[96:99], a[28:31], 0
    buffer_load_dwordx4 a[92:95], v131, s[12:15], s31 offen offset:1024
    s_mov_b32 s31, s36
    v_readlane_b32 s36, v141, 4
    s_nop 2
    s_lshl_b32 s32, s36, 3
    v_mfma_f32_16x16x32_bf16 v[116:119], a[100:103], a[28:31], 0
    v_mfma_f32_16x16x32_bf16 v[120:123], a[104:107], a[28:31], 0
    v_mfma_f32_16x16x32_bf16 v[124:127], a[108:111], a[28:31], 0
    s_waitcnt vmcnt(21) lgkmcnt(0)
    v_mfma_f32_16x16x32_bf16 v[0:3], a[112:115], a[32:35], v[0:3]
    s_add_u32 m0, s34, 0
    s_nop 0
    buffer_load_dwordx4 v132, s[16:19], s32 offen offset:0  lds
    v_mfma_f32_16x16x32_bf16 v[4:7], a[116:119], a[32:35], v[4:7]
    buffer_load_dwordx4 v133, s[16:19], s32 offen offset:1024  lds
    v_mfma_f32_16x16x32_bf16 v[8:11], a[120:123], a[32:35], v[8:11]
    buffer_load_dwordx4 a[0:3], v128, s[12:15], s31 offen offset:0
    v_mfma_f32_16x16x32_bf16 v[12:15], a[124:127], a[32:35], v[12:15]
    s_waitcnt vmcnt(21)
    v_mfma_f32_16x16x32_bf16 v[16:19], a[112:115], a[36:39], v[16:19]
    buffer_load_dwordx4 v134, s[16:19], s32 offen offset:2048  lds
    v_mfma_f32_16x16x32_bf16 v[20:23], a[116:119], a[36:39], v[20:23]
    buffer_load_dwordx4 v135, s[16:19], s32 offen offset:3072  lds
    v_mfma_f32_16x16x32_bf16 v[24:27], a[120:123], a[36:39], v[24:27]
    buffer_load_dwordx4 a[4:7], v128, s[12:15], s31 offen offset:1024
    v_mfma_f32_16x16x32_bf16 v[28:31], a[124:127], a[36:39], v[28:31]
    s_waitcnt vmcnt(23)
    v_mfma_f32_16x16x32_bf16 v[32:35], a[112:115], a[40:43], v[32:35]
    buffer_load_dwordx4 a[8:11], v129, s[12:15], s31 offen offset:0
    v_mfma_f32_16x16x32_bf16 v[36:39], a[116:119], a[40:43], v[36:39]
    ds_read_b64_tr_b16 a[96:97], v136 offset:8192
    v_mfma_f32_16x16x32_bf16 v[40:43], a[120:123], a[40:43], v[40:43]
    ds_read_b64_tr_b16 a[98:99], v136 offset:10240
    v_mfma_f32_16x16x32_bf16 v[44:47], a[124:127], a[40:43], v[44:47]
    s_waitcnt vmcnt(23)
    v_mfma_f32_16x16x32_bf16 v[48:51], a[112:115], a[44:47], v[48:51]
    buffer_load_dwordx4 a[12:15], v129, s[12:15], s31 offen offset:1024
    v_mfma_f32_16x16x32_bf16 v[52:55], a[116:119], a[44:47], v[52:55]
    ds_read_b64_tr_b16 a[100:101], v137 offset:8192
    v_mfma_f32_16x16x32_bf16 v[56:59], a[120:123], a[44:47], v[56:59]
    ds_read_b64_tr_b16 a[102:103], v137 offset:10240
    v_mfma_f32_16x16x32_bf16 v[60:63], a[124:127], a[44:47], v[60:63]
    s_waitcnt vmcnt(23)
    v_mfma_f32_16x16x32_bf16 v[64:67], a[112:115], a[48:51], v[64:67]
    buffer_load_dwordx4 a[16:19], v130, s[12:15], s31 offen offset:0
    v_mfma_f32_16x16x32_bf16 v[68:71], a[116:119], a[48:51], v[68:71]
    ds_read_b64_tr_b16 a[104:105], v138 offset:8192
    v_mfma_f32_16x16x32_bf16 v[72:75], a[120:123], a[48:51], v[72:75]
    ds_read_b64_tr_b16 a[106:107], v138 offset:10240
    v_mfma_f32_16x16x32_bf16 v[76:79], a[124:127], a[48:51], v[76:79]
    s_waitcnt vmcnt(23)
    v_mfma_f32_16x16x32_bf16 v[80:83], a[112:115], a[52:55], v[80:83]
    buffer_load_dwordx4 a[20:23], v130, s[12:15], s31 offen offset:1024
    v_mfma_f32_16x16x32_bf16 v[84:87], a[116:119], a[52:55], v[84:87]
    ds_read_b64_tr_b16 a[108:109], v139 offset:8192
    v_mfma_f32_16x16x32_bf16 v[88:91], a[120:123], a[52:55], v[88:91]
    ds_read_b64_tr_b16 a[110:111], v139 offset:10240
    v_mfma_f32_16x16x32_bf16 v[92:95], a[124:127], a[52:55], v[92:95]
    s_waitcnt vmcnt(23)
    v_mfma_f32_16x16x32_bf16 v[96:99], a[112:115], a[56:59], v[96:99]
    buffer_load_dwordx4 a[24:27], v131, s[12:15], s31 offen offset:0
    v_mfma_f32_16x16x32_bf16 v[100:103], a[116:119], a[56:59], v[100:103]
    v_mfma_f32_16x16x32_bf16 v[104:107], a[120:123], a[56:59], v[104:107]
    v_mfma_f32_16x16x32_bf16 v[108:111], a[124:127], a[56:59], v[108:111]
    s_waitcnt vmcnt(23)
    v_mfma_f32_16x16x32_bf16 v[112:115], a[112:115], a[60:63], v[112:115]
    buffer_load_dwordx4 a[28:31], v131, s[12:15], s31 offen offset:1024
    s_mov_b32 s31, s36
    v_readlane_b32 s36, v141, 5
    s_nop 2
    s_lshl_b32 s32, s36, 3
    v_mfma_f32_16x16x32_bf16 v[116:119], a[116:119], a[60:63], v[116:119]
    v_mfma_f32_16x16x32_bf16 v[120:123], a[120:123], a[60:63], v[120:123]
    v_mfma_f32_16x16x32_bf16 v[124:127], a[124:127], a[60:63], v[124:127]
    s_waitcnt vmcnt(21) lgkmcnt(0)
    v_mfma_f32_16x16x32_bf16 v[0:3], a[96:99], a[64:67], v[0:3]
    s_add_u32 m0, s34, 4096
    s_nop 0
    buffer_load_dwordx4 v132, s[16:19], s32 offen offset:0  lds
    v_mfma_f32_16x16x32_bf16 v[4:7], a[100:103], a[64:67], v[4:7]
    buffer_load_dwordx4 v133, s[16:19], s32 offen offset:1024  lds
    v_mfma_f32_16x16x32_bf16 v[8:11], a[104:107], a[64:67], v[8:11]
    buffer_load_dwordx4 a[32:35], v128, s[12:15], s31 offen offset:0
    v_mfma_f32_16x16x32_bf16 v[12:15], a[108:111], a[64:67], v[12:15]
    s_waitcnt vmcnt(21)
    v_mfma_f32_16x16x32_bf16 v[16:19], a[96:99], a[68:71], v[16:19]
    buffer_load_dwordx4 v134, s[16:19], s32 offen offset:2048  lds
    v_mfma_f32_16x16x32_bf16 v[20:23], a[100:103], a[68:71], v[20:23]
    buffer_load_dwordx4 v135, s[16:19], s32 offen offset:3072  lds
    v_mfma_f32_16x16x32_bf16 v[24:27], a[104:107], a[68:71], v[24:27]
    buffer_load_dwordx4 a[36:39], v128, s[12:15], s31 offen offset:1024
    v_mfma_f32_16x16x32_bf16 v[28:31], a[108:111], a[68:71], v[28:31]
    s_waitcnt vmcnt(23)
    v_mfma_f32_16x16x32_bf16 v[32:35], a[96:99], a[72:75], v[32:35]
    buffer_load_dwordx4 a[40:43], v129, s[12:15], s31 offen offset:0
    v_mfma_f32_16x16x32_bf16 v[36:39], a[100:103], a[72:75], v[36:39]
    ds_read_b64_tr_b16 a[112:113], v136 offset:12288
    v_mfma_f32_16x16x32_bf16 v[40:43], a[104:107], a[72:75], v[40:43]
    ds_read_b64_tr_b16 a[114:115], v136 offset:14336
    v_mfma_f32_16x16x32_bf16 v[44:47], a[108:111], a[72:75], v[44:47]
    s_waitcnt vmcnt(23)
    v_mfma_f32_16x16x32_bf16 v[48:51], a[96:99], a[76:79], v[48:51]
    buffer_load_dwordx4 a[44:47], v129, s[12:15], s31 offen offset:1024
    v_mfma_f32_16x16x32_bf16 v[52:55], a[100:103], a[76:79], v[52:55]
    ds_read_b64_tr_b16 a[116:117], v137 offset:12288
    v_mfma_f32_16x16x32_bf16 v[56:59], a[104:107], a[76:79], v[56:59]
    ds_read_b64_tr_b16 a[118:119], v137 offset:14336
    v_mfma_f32_16x16x32_bf16 v[60:63], a[108:111], a[76:79], v[60:63]
    s_waitcnt vmcnt(23)
    v_mfma_f32_16x16x32_bf16 v[64:67], a[96:99], a[80:83], v[64:67]
    buffer_load_dwordx4 a[48:51], v130, s[12:15], s31 offen offset:0
    v_mfma_f32_16x16x32_bf16 v[68:71], a[100:103], a[80:83], v[68:71]
    ds_read_b64_tr_b16 a[120:121], v138 offset:12288
    v_mfma_f32_16x16x32_bf16 v[72:75], a[104:107], a[80:83], v[72:75]
    ds_read_b64_tr_b16 a[122:123], v138 offset:14336
    v_mfma_f32_16x16x32_bf16 v[76:79], a[108:111], a[80:83], v[76:79]
    s_waitcnt vmcnt(23)
    v_mfma_f32_16x16x32_bf16 v[80:83], a[96:99], a[84:87], v[80:83]
    buffer_load_dwordx4 a[52:55], v130, s[12:15], s31 offen offset:1024
    v_mfma_f32_16x16x32_bf16 v[84:87], a[100:103], a[84:87], v[84:87]
    ds_read_b64_tr_b16 a[124:125], v139 offset:12288
    v_mfma_f32_16x16x32_bf16 v[88:91], a[104:107], a[84:87], v[88:91]
    ds_read_b64_tr_b16 a[126:127], v139 offset:14336
    v_mfma_f32_16x16x32_bf16 v[92:95], a[108:111], a[84:87], v[92:95]
    s_waitcnt vmcnt(23)
    v_mfma_f32_16x16x32_bf16 v[96:99], a[96:99], a[88:91], v[96:99]
    buffer_load_dwordx4 a[56:59], v131, s[12:15], s31 offen offset:0
    v_mfma_f32_16x16x32_bf16 v[100:103], a[100:103], a[88:91], v[100:103]
    v_mfma_f32_16x16x32_bf16 v[104:107], a[104:107], a[88:91], v[104:107]
    v_mfma_f32_16x16x32_bf16 v[108:111], a[108:111], a[88:91], v[108:111]
    s_waitcnt vmcnt(23)
    v_mfma_f32_16x16x32_bf16 v[112:115], a[96:99], a[92:95], v[112:115]
    buffer_load_dwordx4 a[60:63], v131, s[12:15], s31 offen offset:1024
    s_mov_b32 s31, s36
    v_readlane_b32 s36, v141, 6
    s_nop 2
    s_lshl_b32 s32, s36, 3
    v_mfma_f32_16x16x32_bf16 v[116:119], a[100:103], a[92:95], v[116:119]
    v_mfma_f32_16x16x32_bf16 v[120:123], a[104:107], a[92:95], v[120:123]
    v_mfma_f32_16x16x32_bf16 v[124:127], a[108:111], a[92:95], v[124:127]
    s_waitcnt vmcnt(21) lgkmcnt(0)
    v_mfma_f32_16x16x32_bf16 v[0:3], a[112:115], a[0:3], v[0:3]
    s_add_u32 m0, s34, 8192
    s_nop 0
    buffer_load_dwordx4 v132, s[16:19], s32 offen offset:0  lds
    v_mfma_f32_16x16x32_bf16 v[4:7], a[116:119], a[0:3], v[4:7]
    buffer_load_dwordx4 v133, s[16:19], s32 offen offset:1024  lds
    v_mfma_f32_16x16x32_bf16 v[8:11], a[120:123], a[0:3], v[8:11]
    buffer_load_dwordx4 a[64:67], v128, s[12:15], s31 offen offset:0
    v_mfma_f32_16x16x32_bf16 v[12:15], a[124:127], a[0:3], v[12:15]
    s_waitcnt vmcnt(21)
    v_mfma_f32_16x16x32_bf16 v[16:19], a[112:115], a[4:7], v[16:19]
    buffer_load_dwordx4 v134, s[16:19], s32 offen offset:2048  lds
    v_mfma_f32_16x16x32_bf16 v[20:23], a[116:119], a[4:7], v[20:23]
    buffer_load_dwordx4 v135, s[16:19], s32 offen offset:3072  lds
    v_mfma_f32_16x16x32_bf16 v[24:27], a[120:123], a[4:7], v[24:27]
    buffer_load_dwordx4 a[68:71], v128, s[12:15], s31 offen offset:1024
    v_mfma_f32_16x16x32_bf16 v[28:31], a[124:127], a[4:7], v[28:31]
    s_waitcnt vmcnt(23)
    v_mfma_f32_16x16x32_bf16 v[32:35], a[112:115], a[8:11], v[32:35]
    buffer_load_dwordx4 a[72:75], v129, s[12:15], s31 offen offset:0
    v_mfma_f32_16x16x32_bf16 v[36:39], a[116:119], a[8:11], v[36:39]
    ds_read_b64_tr_b16 a[96:97], v136 offset:0
    v_mfma_f32_16x16x32_bf16 v[40:43], a[120:123], a[8:11], v[40:43]
    ds_read_b64_tr_b16 a[98:99], v136 offset:2048
    v_mfma_f32_16x16x32_bf16 v[44:47], a[124:127], a[8:11], v[44:47]
    s_waitcnt vmcnt(23)
    v_mfma_f32_16x16x32_bf16 v[48:51], a[112:115], a[12:15], v[48:51]
    buffer_load_dwordx4 a[76:79], v129, s[12:15], s31 offen offset:1024
    v_mfma_f32_16x16x32_bf16 v[52:55], a[116:119], a[12:15], v[52:55]
    ds_read_b64_tr_b16 a[100:101], v137 offset:0
    v_mfma_f32_16x16x32_bf16 v[56:59], a[120:123], a[12:15], v[56:59]
    ds_read_b64_tr_b16 a[102:103], v137 offset:2048
    v_mfma_f32_16x16x32_bf16 v[60:63], a[124:127], a[12:15], v[60:63]
    s_waitcnt vmcnt(23)
    v_mfma_f32_16x16x32_bf16 v[64:67], a[112:115], a[16:19], v[64:67]
    buffer_load_dwordx4 a[80:83], v130, s[12:15], s31 offen offset:0
    v_mfma_f32_16x16x32_bf16 v[68:71], a[116:119], a[16:19], v[68:71]
    ds_read_b64_tr_b16 a[104:105], v138 offset:0
    v_mfma_f32_16x16x32_bf16 v[72:75], a[120:123], a[16:19], v[72:75]
    ds_read_b64_tr_b16 a[106:107], v138 offset:2048
    v_mfma_f32_16x16x32_bf16 v[76:79], a[124:127], a[16:19], v[76:79]
    s_waitcnt vmcnt(23)
    v_mfma_f32_16x16x32_bf16 v[80:83], a[112:115], a[20:23], v[80:83]
    buffer_load_dwordx4 a[84:87], v130, s[12:15], s31 offen offset:1024
    v_mfma_f32_16x16x32_bf16 v[84:87], a[116:119], a[20:23], v[84:87]
    ds_read_b64_tr_b16 a[108:109], v139 offset:0
    v_mfma_f32_16x16x32_bf16 v[88:91], a[120:123], a[20:23], v[88:91]
    ds_read_b64_tr_b16 a[110:111], v139 offset:2048
    v_mfma_f32_16x16x32_bf16 v[92:95], a[124:127], a[20:23], v[92:95]
    s_waitcnt vmcnt(23)
    v_mfma_f32_16x16x32_bf16 v[96:99], a[112:115], a[24:27], v[96:99]
    buffer_load_dwordx4 a[88:91], v131, s[12:15], s31 offen offset:0
    v_mfma_f32_16x16x32_bf16 v[100:103], a[116:119], a[24:27], v[100:103]
    v_mfma_f32_16x16x32_bf16 v[104:107], a[120:123], a[24:27], v[104:107]
    v_mfma_f32_16x16x32_bf16 v[108:111], a[124:127], a[24:27], v[108:111]
    s_waitcnt vmcnt(23)
    v_mfma_f32_16x16x32_bf16 v[112:115], a[112:115], a[28:31], v[112:115]
    buffer_load_dwordx4 a[92:95], v131, s[12:15], s31 offen offset:1024
    s_mov_b32 s31, s36
    v_readlane_b32 s36, v141, 7
    s_nop 2
    s_lshl_b32 s32, s36, 3
    v_mfma_f32_16x16x32_bf16 v[116:119], a[116:119], a[28:31], v[116:119]
    v_mfma_f32_16x16x32_bf16 v[120:123], a[120:123], a[28:31], v[120:123]
    v_mfma_f32_16x16x32_bf16 v[124:127], a[124:127], a[28:31], v[124:127]
    s_waitcnt vmcnt(21) lgkmcnt(0)
    v_mfma_f32_16x16x32_bf16 v[0:3], a[96:99], a[32:35], v[0:3]
    s_add_u32 m0, s34, 12288
    s_nop 0
    buffer_load_dwordx4 v132, s[16:19], s32 offen offset:0  lds
    v_mfma_f32_16x16x32_bf16 v[4:7], a[100:103], a[32:35], v[4:7]
    buffer_load_dwordx4 v133, s[16:19], s32 offen offset:1024  lds
    v_mfma_f32_16x16x32_bf16 v[8:11], a[104:107], a[32:35], v[8:11]
    buffer_load_dwordx4 a[0:3], v128, s[12:15], s31 offen offset:0
    v_mfma_f32_16x16x32_bf16 v[12:15], a[108:111], a[32:35], v[12:15]
    s_waitcnt vmcnt(21)
    v_mfma_f32_16x16x32_bf16 v[16:19], a[96:99], a[36:39], v[16:19]
    buffer_load_dwordx4 v134, s[16:19], s32 offen offset:2048  lds
    v_mfma_f32_16x16x32_bf16 v[20:23], a[100:103], a[36:39], v[20:23]
    buffer_load_dwordx4 v135, s[16:19], s32 offen offset:3072  lds
    v_mfma_f32_16x16x32_bf16 v[24:27], a[104:107], a[36:39], v[24:27]
    buffer_load_dwordx4 a[4:7], v128, s[12:15], s31 offen offset:1024
    v_mfma_f32_16x16x32_bf16 v[28:31], a[108:111], a[36:39], v[28:31]
    s_waitcnt vmcnt(23)
    v_mfma_f32_16x16x32_bf16 v[32:35], a[96:99], a[40:43], v[32:35]
    buffer_load_dwordx4 a[8:11], v129, s[12:15], s31 offen offset:0
    v_mfma_f32_16x16x32_bf16 v[36:39], a[100:103], a[40:43], v[36:39]
    ds_read_b64_tr_b16 a[112:113], v136 offset:4096
    v_mfma_f32_16x16x32_bf16 v[40:43], a[104:107], a[40:43], v[40:43]
    ds_read_b64_tr_b16 a[114:115], v136 offset:6144
    v_mfma_f32_16x16x32_bf16 v[44:47], a[108:111], a[40:43], v[44:47]
    s_waitcnt vmcnt(23)
    v_mfma_f32_16x16x32_bf16 v[48:51], a[96:99], a[44:47], v[48:51]
    buffer_load_dwordx4 a[12:15], v129, s[12:15], s31 offen offset:1024
    v_mfma_f32_16x16x32_bf16 v[52:55], a[100:103], a[44:47], v[52:55]
    ds_read_b64_tr_b16 a[116:117], v137 offset:4096
    v_mfma_f32_16x16x32_bf16 v[56:59], a[104:107], a[44:47], v[56:59]
    ds_read_b64_tr_b16 a[118:119], v137 offset:6144
    v_mfma_f32_16x16x32_bf16 v[60:63], a[108:111], a[44:47], v[60:63]
    s_waitcnt vmcnt(23)
    v_mfma_f32_16x16x32_bf16 v[64:67], a[96:99], a[48:51], v[64:67]
    buffer_load_dwordx4 a[16:19], v130, s[12:15], s31 offen offset:0
    v_mfma_f32_16x16x32_bf16 v[68:71], a[100:103], a[48:51], v[68:71]
    ds_read_b64_tr_b16 a[120:121], v138 offset:4096
    v_mfma_f32_16x16x32_bf16 v[72:75], a[104:107], a[48:51], v[72:75]
    ds_read_b64_tr_b16 a[122:123], v138 offset:6144
    v_mfma_f32_16x16x32_bf16 v[76:79], a[108:111], a[48:51], v[76:79]
    s_waitcnt vmcnt(23)
    v_mfma_f32_16x16x32_bf16 v[80:83], a[96:99], a[52:55], v[80:83]
    buffer_load_dwordx4 a[20:23], v130, s[12:15], s31 offen offset:1024
    v_mfma_f32_16x16x32_bf16 v[84:87], a[100:103], a[52:55], v[84:87]
    ds_read_b64_tr_b16 a[124:125], v139 offset:4096
    v_mfma_f32_16x16x32_bf16 v[88:91], a[104:107], a[52:55], v[88:91]
    ds_read_b64_tr_b16 a[126:127], v139 offset:6144
    v_mfma_f32_16x16x32_bf16 v[92:95], a[108:111], a[52:55], v[92:95]
    s_waitcnt vmcnt(23)
    v_mfma_f32_16x16x32_bf16 v[96:99], a[96:99], a[56:59], v[96:99]
    buffer_load_dwordx4 a[24:27], v131, s[12:15], s31 offen offset:0
    v_mfma_f32_16x16x32_bf16 v[100:103], a[100:103], a[56:59], v[100:103]
    v_mfma_f32_16x16x32_bf16 v[104:107], a[104:107], a[56:59], v[104:107]
    v_mfma_f32_16x16x32_bf16 v[108:111], a[108:111], a[56:59], v[108:111]
    s_waitcnt vmcnt(23)
    v_mfma_f32_16x16x32_bf16 v[112:115], a[96:99], a[60:63], v[112:115]
    buffer_load_dwordx4 a[28:31], v131, s[12:15], s31 offen offset:1024
    s_mov_b32 s31, s36
    v_readlane_b32 s36, v141, 8
    s_nop 2
    s_lshl_b32 s32, s36, 3
    v_mfma_f32_16x16x32_bf16 v[116:119], a[100:103], a[60:63], v[116:119]
    v_mfma_f32_16x16x32_bf16 v[120:123], a[104:107], a[60:63], v[120:123]
    v_mfma_f32_16x16x32_bf16 v[124:127], a[108:111], a[60:63], v[124:127]
    s_waitcnt vmcnt(21) lgkmcnt(0)
    v_mfma_f32_16x16x32_bf16 v[0:3], a[112:115], a[64:67], v[0:3]
    s_add_u32 m0, s34, 0
    s_nop 0
    buffer_load_dwordx4 v132, s[16:19], s32 offen offset:0  lds
    v_mfma_f32_16x16x32_bf16 v[4:7], a[116:119], a[64:67], v[4:7]
    buffer_load_dwordx4 v133, s[16:19], s32 offen offset:1024  lds
    v_mfma_f32_16x16x32_bf16 v[8:11], a[120:123], a[64:67], v[8:11]
    buffer_load_dwordx4 a[32:35], v128, s[12:15], s31 offen offset:0
    v_mfma_f32_16x16x32_bf16 v[12:15], a[124:127], a[64:67], v[12:15]
    s_waitcnt vmcnt(21)
    v_mfma_f32_16x16x32_bf16 v[16:19], a[112:115], a[68:71], v[16:19]
    buffer_load_dwordx4 v134, s[16:19], s32 offen offset:2048  lds
    v_mfma_f32_16x16x32_bf16 v[20:23], a[116:119], a[68:71], v[20:23]
    buffer_load_dwordx4 v135, s[16:19], s32 offen offset:3072  lds
    v_mfma_f32_16x16x32_bf16 v[24:27], a[120:123], a[68:71], v[24:27]
    buffer_load_dwordx4 a[36:39], v128, s[12:15], s31 offen offset:1024
    v_mfma_f32_16x16x32_bf16 v[28:31], a[124:127], a[68:71], v[28:31]
    s_waitcnt vmcnt(23)
    v_mfma_f32_16x16x32_bf16 v[32:35], a[112:115], a[72:75], v[32:35]
    buffer_load_dwordx4 a[40:43], v129, s[12:15], s31 offen offset:0
    v_mfma_f32_16x16x32_bf16 v[36:39], a[116:119], a[72:75], v[36:39]
    ds_read_b64_tr_b16 a[96:97], v136 offset:8192
    v_mfma_f32_16x16x32_bf16 v[40:43], a[120:123], a[72:75], v[40:43]
    ds_read_b64_tr_b16 a[98:99], v136 offset:10240
    v_mfma_f32_16x16x32_bf16 v[44:47], a[124:127], a[72:75], v[44:47]
    s_waitcnt vmcnt(23)
    v_mfma_f32_16x16x32_bf16 v[48:51], a[112:115], a[76:79], v[48:51]
    buffer_load_dwordx4 a[44:47], v129, s[12:15], s31 offen offset:1024
    v_mfma_f32_16x16x32_bf16 v[52:55], a[116:119], a[76:79], v[52:55]
    ds_read_b64_tr_b16 a[100:101], v137 offset:8192
    v_mfma_f32_16x16x32_bf16 v[56:59], a[120:123], a[76:79], v[56:59]
    ds_read_b64_tr_b16 a[102:103], v137 offset:10240
    v_mfma_f32_16x16x32_bf16 v[60:63], a[124:127], a[76:79], v[60:63]
    s_waitcnt vmcnt(23)
    v_mfma_f32_16x16x32_bf16 v[64:67], a[112:115], a[80:83], v[64:67]
    buffer_load_dwordx4 a[48:51], v130, s[12:15], s31 offen offset:0
    v_mfma_f32_16x16x32_bf16 v[68:71], a[116:119], a[80:83], v[68:71]
    ds_read_b64_tr_b16 a[104:105], v138 offset:8192
    v_mfma_f32_16x16x32_bf16 v[72:75], a[120:123], a[80:83], v[72:75]
    ds_read_b64_tr_b16 a[106:107], v138 offset:10240
    v_mfma_f32_16x16x32_bf16 v[76:79], a[124:127], a[80:83], v[76:79]
    s_waitcnt vmcnt(23)
    v_mfma_f32_16x16x32_bf16 v[80:83], a[112:115], a[84:87], v[80:83]
    buffer_load_dwordx4 a[52:55], v130, s[12:15], s31 offen offset:1024
    v_mfma_f32_16x16x32_bf16 v[84:87], a[116:119], a[84:87], v[84:87]
    ds_read_b64_tr_b16 a[108:109], v139 offset:8192
    v_mfma_f32_16x16x32_bf16 v[88:91], a[120:123], a[84:87], v[88:91]
    ds_read_b64_tr_b16 a[110:111], v139 offset:10240
    v_mfma_f32_16x16x32_bf16 v[92:95], a[124:127], a[84:87], v[92:95]
    s_waitcnt vmcnt(23)
    v_mfma_f32_16x16x32_bf16 v[96:99], a[112:115], a[88:91], v[96:99]
    buffer_load_dwordx4 a[56:59], v131, s[12:15], s31 offen offset:0
    v_mfma_f32_16x16x32_bf16 v[100:103], a[116:119], a[88:91], v[100:103]
    v_mfma_f32_16x16x32_bf16 v[104:107], a[120:123], a[88:91], v[104:107]
    v_mfma_f32_16x16x32_bf16 v[108:111], a[124:127], a[88:91], v[108:111]
    s_waitcnt vmcnt(23)
    v_mfma_f32_16x16x32_bf16 v[112:115], a[112:115], a[92:95], v[112:115]
    buffer_load_dwordx4 a[60:63], v131, s[12:15], s31 offen offset:1024
    s_mov_b32 s31, s36
    v_readlane_b32 s36, v141, 9
    s_nop 2
    s_lshl_b32 s32, s36, 3
    v_mfma_f32_16x16x32_bf16 v[116:119], a[116:119], a[92:95], v[116:119]
    v_mfma_f32_16x16x32_bf16 v[120:123], a[120:123], a[92:95], v[120:123]
    v_mfma_f32_16x16x32_bf16 v[124:127], a[124:127], a[92:95], v[124:127]
    s_waitcnt vmcnt(21) lgkmcnt(0)
    v_mfma_f32_16x16x32_bf16 v[0:3], a[96:99], a[0:3], v[0:3]
    s_add_u32 m0, s34, 4096
    s_nop 0
    buffer_load_dwordx4 v132, s[16:19], s32 offen offset:0  lds
    v_mfma_f32_16x16x32_bf16 v[4:7], a[100:103], a[0:3], v[4:7]
    buffer_load_dwordx4 v133, s[16:19], s32 offen offset:1024  lds
    v_mfma_f32_16x16x32_bf16 v[8:11], a[104:107], a[0:3], v[8:11]
    buffer_load_dwordx4 a[64:67], v128, s[12:15], s31 offen offset:0
    v_mfma_f32_16x16x32_bf16 v[12:15], a[108:111], a[0:3], v[12:15]
    s_waitcnt vmcnt(21)
    v_mfma_f32_16x16x32_bf16 v[16:19], a[96:99], a[4:7], v[16:19]
    buffer_load_dwordx4 v134, s[16:19], s32 offen offset:2048  lds
    v_mfma_f32_16x16x32_bf16 v[20:23], a[100:103], a[4:7], v[20:23]
    buffer_load_dwordx4 v135, s[16:19], s32 offen offset:3072  lds
    v_mfma_f32_16x16x32_bf16 v[24:27], a[104:107], a[4:7], v[24:27]
    buffer_load_dwordx4 a[68:71], v128, s[12:15], s31 offen offset:1024
    v_mfma_f32_16x16x32_bf16 v[28:31], a[108:111], a[4:7], v[28:31]
    s_waitcnt vmcnt(23)
    v_mfma_f32_16x16x32_bf16 v[32:35], a[96:99], a[8:11], v[32:35]
    buffer_load_dwordx4 a[72:75], v129, s[12:15], s31 offen offset:0
    v_mfma_f32_16x16x32_bf16 v[36:39], a[100:103], a[8:11], v[36:39]
    ds_read_b64_tr_b16 a[112:113], v136 offset:12288
    v_mfma_f32_16x16x32_bf16 v[40:43], a[104:107], a[8:11], v[40:43]
    ds_read_b64_tr_b16 a[114:115], v136 offset:14336
    v_mfma_f32_16x16x32_bf16 v[44:47], a[108:111], a[8:11], v[44:47]
    s_waitcnt vmcnt(23)
    v_mfma_f32_16x16x32_bf16 v[48:51], a[96:99], a[12:15], v[48:51]
    buffer_load_dwordx4 a[76:79], v129, s[12:15], s31 offen offset:1024
    v_mfma_f32_16x16x32_bf16 v[52:55], a[100:103], a[12:15], v[52:55]
    ds_read_b64_tr_b16 a[116:117], v137 offset:12288
    v_mfma_f32_16x16x32_bf16 v[56:59], a[104:107], a[12:15], v[56:59]
    ds_read_b64_tr_b16 a[118:119], v137 offset:14336
    v_mfma_f32_16x16x32_bf16 v[60:63], a[108:111], a[12:15], v[60:63]
    s_waitcnt vmcnt(23)
    v_mfma_f32_16x16x32_bf16 v[64:67], a[96:99], a[16:19], v[64:67]
    buffer_load_dwordx4 a[80:83], v130, s[12:15], s31 offen offset:0
    v_mfma_f32_16x16x32_bf16 v[68:71], a[100:103], a[16:19], v[68:71]
    ds_read_b64_tr_b16 a[120:121], v138 offset:12288
    v_mfma_f32_16x16x32_bf16 v[72:75], a[104:107], a[16:19], v[72:75]
    ds_read_b64_tr_b16 a[122:123], v138 offset:14336
    v_mfma_f32_16x16x32_bf16 v[76:79], a[108:111], a[16:19], v[76:79]
    s_waitcnt vmcnt(23)
    v_mfma_f32_16x16x32_bf16 v[80:83], a[96:99], a[20:23], v[80:83]
    buffer_load_dwordx4 a[84:87], v130, s[12:15], s31 offen offset:1024
    v_mfma_f32_16x16x32_bf16 v[84:87], a[100:103], a[20:23], v[84:87]
    ds_read_b64_tr_b16 a[124:125], v139 offset:12288
    v_mfma_f32_16x16x32_bf16 v[88:91], a[104:107], a[20:23], v[88:91]
    ds_read_b64_tr_b16 a[126:127], v139 offset:14336
    v_mfma_f32_16x16x32_bf16 v[92:95], a[108:111], a[20:23], v[92:95]
    s_waitcnt vmcnt(23)
    v_mfma_f32_16x16x32_bf16 v[96:99], a[96:99], a[24:27], v[96:99]
    buffer_load_dwordx4 a[88:91], v131, s[12:15], s31 offen offset:0
    v_mfma_f32_16x16x32_bf16 v[100:103], a[100:103], a[24:27], v[100:103]
    v_mfma_f32_16x16x32_bf16 v[104:107], a[104:107], a[24:27], v[104:107]
    v_mfma_f32_16x16x32_bf16 v[108:111], a[108:111], a[24:27], v[108:111]
    s_waitcnt vmcnt(23)
    v_mfma_f32_16x16x32_bf16 v[112:115], a[96:99], a[28:31], v[112:115]
    buffer_load_dwordx4 a[92:95], v131, s[12:15], s31 offen offset:1024
    s_mov_b32 s31, s36
    v_readlane_b32 s36, v141, 10
    s_nop 2
    s_lshl_b32 s32, s36, 3
    v_mfma_f32_16x16x32_bf16 v[116:119], a[100:103], a[28:31], v[116:119]
    v_mfma_f32_16x16x32_bf16 v[120:123], a[104:107], a[28:31], v[120:123]
    v_mfma_f32_16x16x32_bf16 v[124:127], a[108:111], a[28:31], v[124:127]
    s_waitcnt vmcnt(21) lgkmcnt(0)
    v_mfma_f32_16x16x32_bf16 v[0:3], a[112:115], a[32:35], v[0:3]
    s_add_u32 m0, s34, 8192
    s_nop 0
    buffer_load_dwordx4 v132, s[16:19], s32 offen offset:0  lds
    v_mfma_f32_16x16x32_bf16 v[4:7], a[116:119], a[32:35], v[4:7]
    buffer_load_dwordx4 v133, s[16:19], s32 offen offset:1024  lds
    v_mfma_f32_16x16x32_bf16 v[8:11], a[120:123], a[32:35], v[8:11]
    buffer_load_dwordx4 a[0:3], v128, s[12:15], s31 offen offset:0
    v_mfma_f32_16x16x32_bf16 v[12:15], a[124:127], a[32:35], v[12:15]
    s_waitcnt vmcnt(21)
    v_mfma_f32_16x16x32_bf16 v[16:19], a[112:115], a[36:39], v[16:19]
    buffer_load_dwordx4 v134, s[16:19], s32 offen offset:2048  lds
    v_mfma_f32_16x16x32_bf16 v[20:23], a[116:119], a[36:39], v[20:23]
    buffer_load_dwordx4 v135, s[16:19], s32 offen offset:3072  lds
    v_mfma_f32_16x16x32_bf16 v[24:27], a[120:123], a[36:39], v[24:27]
    buffer_load_dwordx4 a[4:7], v128, s[12:15], s31 offen offset:1024
    v_mfma_f32_16x16x32_bf16 v[28:31], a[124:127], a[36:39], v[28:31]
    s_waitcnt vmcnt(23)
    v_mfma_f32_16x16x32_bf16 v[32:35], a[112:115], a[40:43], v[32:35]
    buffer_load_dwordx4 a[8:11], v129, s[12:15], s31 offen offset:0
    v_mfma_f32_16x16x32_bf16 v[36:39], a[116:119], a[40:43], v[36:39]
    ds_read_b64_tr_b16 a[96:97], v136 offset:0
    v_mfma_f32_16x16x32_bf16 v[40:43], a[120:123], a[40:43], v[40:43]
    ds_read_b64_tr_b16 a[98:99], v136 offset:2048
    v_mfma_f32_16x16x32_bf16 v[44:47], a[124:127], a[40:43], v[44:47]
    s_waitcnt vmcnt(23)
    v_mfma_f32_16x16x32_bf16 v[48:51], a[112:115], a[44:47], v[48:51]
    buffer_load_dwordx4 a[12:15], v129, s[12:15], s31 offen offset:1024
    v_mfma_f32_16x16x32_bf16 v[52:55], a[116:119], a[44:47], v[52:55]
    ds_read_b64_tr_b16 a[100:101], v137 offset:0
    v_mfma_f32_16x16x32_bf16 v[56:59], a[120:123], a[44:47], v[56:59]
    ds_read_b64_tr_b16 a[102:103], v137 offset:2048
    v_mfma_f32_16x16x32_bf16 v[60:63], a[124:127], a[44:47], v[60:63]
    s_waitcnt vmcnt(23)
    v_mfma_f32_16x16x32_bf16 v[64:67], a[112:115], a[48:51], v[64:67]
    buffer_load_dwordx4 a[16:19], v130, s[12:15], s31 offen offset:0
    v_mfma_f32_16x16x32_bf16 v[68:71], a[116:119], a[48:51], v[68:71]
    ds_read_b64_tr_b16 a[104:105], v138 offset:0
    v_mfma_f32_16x16x32_bf16 v[72:75], a[120:123], a[48:51], v[72:75]
    ds_read_b64_tr_b16 a[106:107], v138 offset:2048
    v_mfma_f32_16x16x32_bf16 v[76:79], a[124:127], a[48:51], v[76:79]
    s_waitcnt vmcnt(23)
    v_mfma_f32_16x16x32_bf16 v[80:83], a[112:115], a[52:55], v[80:83]
    buffer_load_dwordx4 a[20:23], v130, s[12:15], s31 offen offset:1024
    v_mfma_f32_16x16x32_bf16 v[84:87], a[116:119], a[52:55], v[84:87]
    ds_read_b64_tr_b16 a[108:109], v139 offset:0
    v_mfma_f32_16x16x32_bf16 v[88:91], a[120:123], a[52:55], v[88:91]
    ds_read_b64_tr_b16 a[110:111], v139 offset:2048
    v_mfma_f32_16x16x32_bf16 v[92:95], a[124:127], a[52:55], v[92:95]
    s_waitcnt vmcnt(23)
    v_mfma_f32_16x16x32_bf16 v[96:99], a[112:115], a[56:59], v[96:99]
    buffer_load_dwordx4 a[24:27], v131, s[12:15], s31 offen offset:0
    v_mfma_f32_16x16x32_bf16 v[100:103], a[116:119], a[56:59], v[100:103]
    v_mfma_f32_16x16x32_bf16 v[104:107], a[120:123], a[56:59], v[104:107]
    v_mfma_f32_16x16x32_bf16 v[108:111], a[124:127], a[56:59], v[108:111]
    s_waitcnt vmcnt(23)
    v_mfma_f32_16x16x32_bf16 v[112:115], a[112:115], a[60:63], v[112:115]
    buffer_load_dwordx4 a[28:31], v131, s[12:15], s31 offen offset:1024
    s_mov_b32 s31, s36
    v_readlane_b32 s36, v141, 11
    s_nop 2
    s_lshl_b32 s32, s36, 3
    v_mfma_f32_16x16x32_bf16 v[116:119], a[116:119], a[60:63], v[116:119]
    v_mfma_f32_16x16x32_bf16 v[120:123], a[120:123], a[60:63], v[120:123]
    v_mfma_f32_16x16x32_bf16 v[124:127], a[124:127], a[60:63], v[124:127]
    s_waitcnt vmcnt(21) lgkmcnt(0)
    v_mfma_f32_16x16x32_bf16 v[0:3], a[96:99], a[64:67], v[0:3]
    s_add_u32 m0, s34, 12288
    s_nop 0
    buffer_load_dwordx4 v132, s[16:19], s32 offen offset:0  lds
    v_mfma_f32_16x16x32_bf16 v[4:7], a[100:103], a[64:67], v[4:7]
    buffer_load_dwordx4 v133, s[16:19], s32 offen offset:1024  lds
    v_mfma_f32_16x16x32_bf16 v[8:11], a[104:107], a[64:67], v[8:11]
    buffer_load_dwordx4 a[32:35], v128, s[12:15], s31 offen offset:0
    v_mfma_f32_16x16x32_bf16 v[12:15], a[108:111], a[64:67], v[12:15]
    s_waitcnt vmcnt(21)
    v_mfma_f32_16x16x32_bf16 v[16:19], a[96:99], a[68:71], v[16:19]
    buffer_load_dwordx4 v134, s[16:19], s32 offen offset:2048  lds
    v_mfma_f32_16x16x32_bf16 v[20:23], a[100:103], a[68:71], v[20:23]
    buffer_load_dwordx4 v135, s[16:19], s32 offen offset:3072  lds
    v_mfma_f32_16x16x32_bf16 v[24:27], a[104:107], a[68:71], v[24:27]
    buffer_load_dwordx4 a[36:39], v128, s[12:15], s31 offen offset:1024
    v_mfma_f32_16x16x32_bf16 v[28:31], a[108:111], a[68:71], v[28:31]
    s_waitcnt vmcnt(23)
    v_mfma_f32_16x16x32_bf16 v[32:35], a[96:99], a[72:75], v[32:35]
    buffer_load_dwordx4 a[40:43], v129, s[12:15], s31 offen offset:0
    v_mfma_f32_16x16x32_bf16 v[36:39], a[100:103], a[72:75], v[36:39]
    ds_read_b64_tr_b16 a[112:113], v136 offset:4096
    v_mfma_f32_16x16x32_bf16 v[40:43], a[104:107], a[72:75], v[40:43]
    ds_read_b64_tr_b16 a[114:115], v136 offset:6144
    v_mfma_f32_16x16x32_bf16 v[44:47], a[108:111], a[72:75], v[44:47]
    s_waitcnt vmcnt(23)
    v_mfma_f32_16x16x32_bf16 v[48:51], a[96:99], a[76:79], v[48:51]
    buffer_load_dwordx4 a[44:47], v129, s[12:15], s31 offen offset:1024
    v_mfma_f32_16x16x32_bf16 v[52:55], a[100:103], a[76:79], v[52:55]
    ds_read_b64_tr_b16 a[116:117], v137 offset:4096
    v_mfma_f32_16x16x32_bf16 v[56:59], a[104:107], a[76:79], v[56:59]
    ds_read_b64_tr_b16 a[118:119], v137 offset:6144
    v_mfma_f32_16x16x32_bf16 v[60:63], a[108:111], a[76:79], v[60:63]
    s_waitcnt vmcnt(23)
    v_mfma_f32_16x16x32_bf16 v[64:67], a[96:99], a[80:83], v[64:67]
    buffer_load_dwordx4 a[48:51], v130, s[12:15], s31 offen offset:0
    v_mfma_f32_16x16x32_bf16 v[68:71], a[100:103], a[80:83], v[68:71]
    ds_read_b64_tr_b16 a[120:121], v138 offset:4096
    v_mfma_f32_16x16x32_bf16 v[72:75], a[104:107], a[80:83], v[72:75]
    ds_read_b64_tr_b16 a[122:123], v138 offset:6144
    v_mfma_f32_16x16x32_bf16 v[76:79], a[108:111], a[80:83], v[76:79]
    s_waitcnt vmcnt(23)
    v_mfma_f32_16x16x32_bf16 v[80:83], a[96:99], a[84:87], v[80:83]
    buffer_load_dwordx4 a[52:55], v130, s[12:15], s31 offen offset:1024
    v_mfma_f32_16x16x32_bf16 v[84:87], a[100:103], a[84:87], v[84:87]
    ds_read_b64_tr_b16 a[124:125], v139 offset:4096
    v_mfma_f32_16x16x32_bf16 v[88:91], a[104:107], a[84:87], v[88:91]
    ds_read_b64_tr_b16 a[126:127], v139 offset:6144
    v_mfma_f32_16x16x32_bf16 v[92:95], a[108:111], a[84:87], v[92:95]
    s_waitcnt vmcnt(23)
    v_mfma_f32_16x16x32_bf16 v[96:99], a[96:99], a[88:91], v[96:99]
    buffer_load_dwordx4 a[56:59], v131, s[12:15], s31 offen offset:0
    v_mfma_f32_16x16x32_bf16 v[100:103], a[100:103], a[88:91], v[100:103]
    v_mfma_f32_16x16x32_bf16 v[104:107], a[104:107], a[88:91], v[104:107]
    v_mfma_f32_16x16x32_bf16 v[108:111], a[108:111], a[88:91], v[108:111]
    s_waitcnt vmcnt(23)
    v_mfma_f32_16x16x32_bf16 v[112:115], a[96:99], a[92:95], v[112:115]
    buffer_load_dwordx4 a[60:63], v131, s[12:15], s31 offen offset:1024
    s_mov_b32 s31, s36
    v_readlane_b32 s36, v141, 12
    s_nop 2
    s_lshl_b32 s32, s36, 3
    v_mfma_f32_16x16x32_bf16 v[116:119], a[100:103], a[92:95], v[116:119]
    v_mfma_f32_16x16x32_bf16 v[120:123], a[104:107], a[92:95], v[120:123]
    v_mfma_f32_16x16x32_bf16 v[124:127], a[108:111], a[92:95], v[124:127]
    s_waitcnt vmcnt(21) lgkmcnt(0)
    v_mfma_f32_16x16x32_bf16 v[0:3], a[112:115], a[0:3], v[0:3]
    s_add_u32 m0, s34, 0
    s_nop 0
    buffer_load_dwordx4 v132, s[16:19], s32 offen offset:0  lds
    v_mfma_f32_16x16x32_bf16 v[4:7], a[116:119], a[0:3], v[4:7]
    buffer_load_dwordx4 v133, s[16:19], s32 offen offset:1024  lds
    v_mfma_f32_16x16x32_bf16 v[8:11], a[120:123], a[0:3], v[8:11]
    buffer_load_dwordx4 a[64:67], v128, s[12:15], s31 offen offset:0
    v_mfma_f32_16x16x32_bf16 v[12:15], a[124:127], a[0:3], v[12:15]
    s_waitcnt vmcnt(21)
    v_mfma_f32_16x16x32_bf16 v[16:19], a[112:115], a[4:7], v[16:19]
    buffer_load_dwordx4 v134, s[16:19], s32 offen offset:2048  lds
    v_mfma_f32_16x16x32_bf16 v[20:23], a[116:119], a[4:7], v[20:23]
    buffer_load_dwordx4 v135, s[16:19], s32 offen offset:3072  lds
    v_mfma_f32_16x16x32_bf16 v[24:27], a[120:123], a[4:7], v[24:27]
    buffer_load_dwordx4 a[68:71], v128, s[12:15], s31 offen offset:1024
    v_mfma_f32_16x16x32_bf16 v[28:31], a[124:127], a[4:7], v[28:31]
    s_waitcnt vmcnt(23)
    v_mfma_f32_16x16x32_bf16 v[32:35], a[112:115], a[8:11], v[32:35]
    buffer_load_dwordx4 a[72:75], v129, s[12:15], s31 offen offset:0
    v_mfma_f32_16x16x32_bf16 v[36:39], a[116:119], a[8:11], v[36:39]
    ds_read_b64_tr_b16 a[96:97], v136 offset:8192
    v_mfma_f32_16x16x32_bf16 v[40:43], a[120:123], a[8:11], v[40:43]
    ds_read_b64_tr_b16 a[98:99], v136 offset:10240
    v_mfma_f32_16x16x32_bf16 v[44:47], a[124:127], a[8:11], v[44:47]
    s_waitcnt vmcnt(23)
    v_mfma_f32_16x16x32_bf16 v[48:51], a[112:115], a[12:15], v[48:51]
    buffer_load_dwordx4 a[76:79], v129, s[12:15], s31 offen offset:1024
    v_mfma_f32_16x16x32_bf16 v[52:55], a[116:119], a[12:15], v[52:55]
    ds_read_b64_tr_b16 a[100:101], v137 offset:8192
    v_mfma_f32_16x16x32_bf16 v[56:59], a[120:123], a[12:15], v[56:59]
    ds_read_b64_tr_b16 a[102:103], v137 offset:10240
    v_mfma_f32_16x16x32_bf16 v[60:63], a[124:127], a[12:15], v[60:63]
    s_waitcnt vmcnt(23)
    v_mfma_f32_16x16x32_bf16 v[64:67], a[112:115], a[16:19], v[64:67]
    buffer_load_dwordx4 a[80:83], v130, s[12:15], s31 offen offset:0
    v_mfma_f32_16x16x32_bf16 v[68:71], a[116:119], a[16:19], v[68:71]
    ds_read_b64_tr_b16 a[104:105], v138 offset:8192
    v_mfma_f32_16x16x32_bf16 v[72:75], a[120:123], a[16:19], v[72:75]
    ds_read_b64_tr_b16 a[106:107], v138 offset:10240
    v_mfma_f32_16x16x32_bf16 v[76:79], a[124:127], a[16:19], v[76:79]
    s_waitcnt vmcnt(23)
    v_mfma_f32_16x16x32_bf16 v[80:83], a[112:115], a[20:23], v[80:83]
    buffer_load_dwordx4 a[84:87], v130, s[12:15], s31 offen offset:1024
    v_mfma_f32_16x16x32_bf16 v[84:87], a[116:119], a[20:23], v[84:87]
    ds_read_b64_tr_b16 a[108:109], v139 offset:8192
    v_mfma_f32_16x16x32_bf16 v[88:91], a[120:123], a[20:23], v[88:91]
    ds_read_b64_tr_b16 a[110:111], v139 offset:10240
    v_mfma_f32_16x16x32_bf16 v[92:95], a[124:127], a[20:23], v[92:95]
    s_waitcnt vmcnt(23)
    v_mfma_f32_16x16x32_bf16 v[96:99], a[112:115], a[24:27], v[96:99]
    buffer_load_dwordx4 a[88:91], v131, s[12:15], s31 offen offset:0
    v_mfma_f32_16x16x32_bf16 v[100:103], a[116:119], a[24:27], v[100:103]
    v_mfma_f32_16x16x32_bf16 v[104:107], a[120:123], a[24:27], v[104:107]
    v_mfma_f32_16x16x32_bf16 v[108:111], a[124:127], a[24:27], v[108:111]
    s_waitcnt vmcnt(23)
    v_mfma_f32_16x16x32_bf16 v[112:115], a[112:115], a[28:31], v[112:115]
    buffer_load_dwordx4 a[92:95], v131, s[12:15], s31 offen offset:1024
    s_mov_b32 s31, s36
    v_readlane_b32 s36, v141, 13
    s_nop 2
    s_lshl_b32 s32, s36, 3
    v_mfma_f32_16x16x32_bf16 v[116:119], a[116:119], a[28:31], v[116:119]
    v_mfma_f32_16x16x32_bf16 v[120:123], a[120:123], a[28:31], v[120:123]
    v_mfma_f32_16x16x32_bf16 v[124:127], a[124:127], a[28:31], v[124:127]
    s_waitcnt vmcnt(21) lgkmcnt(0)
    v_mfma_f32_16x16x32_bf16 v[0:3], a[96:99], a[32:35], v[0:3]
    s_add_u32 m0, s34, 4096
    s_nop 0
    buffer_load_dwordx4 v132, s[16:19], s32 offen offset:0  lds
    v_mfma_f32_16x16x32_bf16 v[4:7], a[100:103], a[32:35], v[4:7]
    buffer_load_dwordx4 v133, s[16:19], s32 offen offset:1024  lds
    v_mfma_f32_16x16x32_bf16 v[8:11], a[104:107], a[32:35], v[8:11]
    buffer_load_dwordx4 a[0:3], v128, s[12:15], s31 offen offset:0
    v_mfma_f32_16x16x32_bf16 v[12:15], a[108:111], a[32:35], v[12:15]
    s_waitcnt vmcnt(21)
    v_mfma_f32_16x16x32_bf16 v[16:19], a[96:99], a[36:39], v[16:19]
    buffer_load_dwordx4 v134, s[16:19], s32 offen offset:2048  lds
    v_mfma_f32_16x16x32_bf16 v[20:23], a[100:103], a[36:39], v[20:23]
    buffer_load_dwordx4 v135, s[16:19], s32 offen offset:3072  lds
    v_mfma_f32_16x16x32_bf16 v[24:27], a[104:107], a[36:39], v[24:27]
    buffer_load_dwordx4 a[4:7], v128, s[12:15], s31 offen offset:1024
    v_mfma_f32_16x16x32_bf16 v[28:31], a[108:111], a[36:39], v[28:31]
    s_waitcnt vmcnt(23)
    v_mfma_f32_16x16x32_bf16 v[32:35], a[96:99], a[40:43], v[32:35]
    buffer_load_dwordx4 a[8:11], v129, s[12:15], s31 offen offset:0
    v_mfma_f32_16x16x32_bf16 v[36:39], a[100:103], a[40:43], v[36:39]
    ds_read_b64_tr_b16 a[112:113], v136 offset:12288
    v_mfma_f32_16x16x32_bf16 v[40:43], a[104:107], a[40:43], v[40:43]
    ds_read_b64_tr_b16 a[114:115], v136 offset:14336
    v_mfma_f32_16x16x32_bf16 v[44:47], a[108:111], a[40:43], v[44:47]
    s_waitcnt vmcnt(23)
    v_mfma_f32_16x16x32_bf16 v[48:51], a[96:99], a[44:47], v[48:51]
    buffer_load_dwordx4 a[12:15], v129, s[12:15], s31 offen offset:1024
    v_mfma_f32_16x16x32_bf16 v[52:55], a[100:103], a[44:47], v[52:55]
    ds_read_b64_tr_b16 a[116:117], v137 offset:12288
    v_mfma_f32_16x16x32_bf16 v[56:59], a[104:107], a[44:47], v[56:59]
    ds_read_b64_tr_b16 a[118:119], v137 offset:14336
    v_mfma_f32_16x16x32_bf16 v[60:63], a[108:111], a[44:47], v[60:63]
    s_waitcnt vmcnt(23)
    v_mfma_f32_16x16x32_bf16 v[64:67], a[96:99], a[48:51], v[64:67]
    buffer_load_dwordx4 a[16:19], v130, s[12:15], s31 offen offset:0
    v_mfma_f32_16x16x32_bf16 v[68:71], a[100:103], a[48:51], v[68:71]
    ds_read_b64_tr_b16 a[120:121], v138 offset:12288
    v_mfma_f32_16x16x32_bf16 v[72:75], a[104:107], a[48:51], v[72:75]
    ds_read_b64_tr_b16 a[122:123], v138 offset:14336
    v_mfma_f32_16x16x32_bf16 v[76:79], a[108:111], a[48:51], v[76:79]
    s_waitcnt vmcnt(23)
    v_mfma_f32_16x16x32_bf16 v[80:83], a[96:99], a[52:55], v[80:83]
    buffer_load_dwordx4 a[20:23], v130, s[12:15], s31 offen offset:1024
    v_mfma_f32_16x16x32_bf16 v[84:87], a[100:103], a[52:55], v[84:87]
    ds_read_b64_tr_b16 a[124:125], v139 offset:12288
    v_mfma_f32_16x16x32_bf16 v[88:91], a[104:107], a[52:55], v[88:91]
    ds_read_b64_tr_b16 a[126:127], v139 offset:14336
    v_mfma_f32_16x16x32_bf16 v[92:95], a[108:111], a[52:55], v[92:95]
    s_waitcnt vmcnt(23)
    v_mfma_f32_16x16x32_bf16 v[96:99], a[96:99], a[56:59], v[96:99]
    buffer_load_dwordx4 a[24:27], v131, s[12:15], s31 offen offset:0
    v_mfma_f32_16x16x32_bf16 v[100:103], a[100:103], a[56:59], v[100:103]
    v_mfma_f32_16x16x32_bf16 v[104:107], a[104:107], a[56:59], v[104:107]
    v_mfma_f32_16x16x32_bf16 v[108:111], a[108:111], a[56:59], v[108:111]
    s_waitcnt vmcnt(23)
    v_mfma_f32_16x16x32_bf16 v[112:115], a[96:99], a[60:63], v[112:115]
    buffer_load_dwordx4 a[28:31], v131, s[12:15], s31 offen offset:1024
    s_mov_b32 s31, s36
    v_readlane_b32 s36, v141, 14
    s_nop 2
    s_lshl_b32 s32, s36, 3
    v_mfma_f32_16x16x32_bf16 v[116:119], a[100:103], a[60:63], v[116:119]
    v_mfma_f32_16x16x32_bf16 v[120:123], a[104:107], a[60:63], v[120:123]
    v_mfma_f32_16x16x32_bf16 v[124:127], a[108:111], a[60:63], v[124:127]
    s_waitcnt vmcnt(21) lgkmcnt(0)
    v_mfma_f32_16x16x32_bf16 v[0:3], a[112:115], a[64:67], v[0:3]
    s_add_u32 m0, s34, 8192
    s_nop 0
    buffer_load_dwordx4 v132, s[16:19], s32 offen offset:0  lds
    v_mfma_f32_16x16x32_bf16 v[4:7], a[116:119], a[64:67], v[4:7]
    buffer_load_dwordx4 v133, s[16:19], s32 offen offset:1024  lds
    v_mfma_f32_16x16x32_bf16 v[8:11], a[120:123], a[64:67], v[8:11]
    buffer_load_dwordx4 a[32:35], v128, s[12:15], s31 offen offset:0
    v_mfma_f32_16x16x32_bf16 v[12:15], a[124:127], a[64:67], v[12:15]
    s_waitcnt vmcnt(21)
    v_mfma_f32_16x16x32_bf16 v[16:19], a[112:115], a[68:71], v[16:19]
    buffer_load_dwordx4 v134, s[16:19], s32 offen offset:2048  lds
    v_mfma_f32_16x16x32_bf16 v[20:23], a[116:119], a[68:71], v[20:23]
    buffer_load_dwordx4 v135, s[16:19], s32 offen offset:3072  lds
    v_mfma_f32_16x16x32_bf16 v[24:27], a[120:123], a[68:71], v[24:27]
    buffer_load_dwordx4 a[36:39], v128, s[12:15], s31 offen offset:1024
    v_mfma_f32_16x16x32_bf16 v[28:31], a[124:127], a[68:71], v[28:31]
    s_waitcnt vmcnt(23)
    v_mfma_f32_16x16x32_bf16 v[32:35], a[112:115], a[72:75], v[32:35]
    buffer_load_dwordx4 a[40:43], v129, s[12:15], s31 offen offset:0
    v_mfma_f32_16x16x32_bf16 v[36:39], a[116:119], a[72:75], v[36:39]
    ds_read_b64_tr_b16 a[96:97], v136 offset:0
    v_mfma_f32_16x16x32_bf16 v[40:43], a[120:123], a[72:75], v[40:43]
    ds_read_b64_tr_b16 a[98:99], v136 offset:2048
    v_mfma_f32_16x16x32_bf16 v[44:47], a[124:127], a[72:75], v[44:47]
    s_waitcnt vmcnt(23)
    v_mfma_f32_16x16x32_bf16 v[48:51], a[112:115], a[76:79], v[48:51]
    buffer_load_dwordx4 a[44:47], v129, s[12:15], s31 offen offset:1024
    v_mfma_f32_16x16x32_bf16 v[52:55], a[116:119], a[76:79], v[52:55]
    ds_read_b64_tr_b16 a[100:101], v137 offset:0
    v_mfma_f32_16x16x32_bf16 v[56:59], a[120:123], a[76:79], v[56:59]
    ds_read_b64_tr_b16 a[102:103], v137 offset:2048
    v_mfma_f32_16x16x32_bf16 v[60:63], a[124:127], a[76:79], v[60:63]
    s_waitcnt vmcnt(23)
    v_mfma_f32_16x16x32_bf16 v[64:67], a[112:115], a[80:83], v[64:67]
    buffer_load_dwordx4 a[48:51], v130, s[12:15], s31 offen offset:0
    v_mfma_f32_16x16x32_bf16 v[68:71], a[116:119], a[80:83], v[68:71]
    ds_read_b64_tr_b16 a[104:105], v138 offset:0
    v_mfma_f32_16x16x32_bf16 v[72:75], a[120:123], a[80:83], v[72:75]
    ds_read_b64_tr_b16 a[106:107], v138 offset:2048
    v_mfma_f32_16x16x32_bf16 v[76:79], a[124:127], a[80:83], v[76:79]
    s_waitcnt vmcnt(23)
    v_mfma_f32_16x16x32_bf16 v[80:83], a[112:115], a[84:87], v[80:83]
    buffer_load_dwordx4 a[52:55], v130, s[12:15], s31 offen offset:1024
    v_mfma_f32_16x16x32_bf16 v[84:87], a[116:119], a[84:87], v[84:87]
    ds_read_b64_tr_b16 a[108:109], v139 offset:0
    v_mfma_f32_16x16x32_bf16 v[88:91], a[120:123], a[84:87], v[88:91]
    ds_read_b64_tr_b16 a[110:111], v139 offset:2048
    v_mfma_f32_16x16x32_bf16 v[92:95], a[124:127], a[84:87], v[92:95]
    s_waitcnt vmcnt(23)
    v_mfma_f32_16x16x32_bf16 v[96:99], a[112:115], a[88:91], v[96:99]
    buffer_load_dwordx4 a[56:59], v131, s[12:15], s31 offen offset:0
    v_mfma_f32_16x16x32_bf16 v[100:103], a[116:119], a[88:91], v[100:103]
    v_mfma_f32_16x16x32_bf16 v[104:107], a[120:123], a[88:91], v[104:107]
    v_mfma_f32_16x16x32_bf16 v[108:111], a[124:127], a[88:91], v[108:111]
    s_waitcnt vmcnt(23)
    v_mfma_f32_16x16x32_bf16 v[112:115], a[112:115], a[92:95], v[112:115]
    buffer_load_dwordx4 a[60:63], v131, s[12:15], s31 offen offset:1024
    s_mov_b32 s31, s36
    v_readlane_b32 s36, v141, 15
    s_nop 2
    s_lshl_b32 s32, s36, 3
    v_mfma_f32_16x16x32_bf16 v[116:119], a[116:119], a[92:95], v[116:119]
    v_mfma_f32_16x16x32_bf16 v[120:123], a[120:123], a[92:95], v[120:123]
    v_mfma_f32_16x16x32_bf16 v[124:127], a[124:127], a[92:95], v[124:127]
    s_waitcnt vmcnt(21) lgkmcnt(0)
    v_mfma_f32_16x16x32_bf16 v[0:3], a[96:99], a[0:3], v[0:3]
    s_add_u32 m0, s34, 12288
    s_nop 0
    buffer_load_dwordx4 v132, s[16:19], s32 offen offset:0  lds
    v_mfma_f32_16x16x32_bf16 v[4:7], a[100:103], a[0:3], v[4:7]
    buffer_load_dwordx4 v133, s[16:19], s32 offen offset:1024  lds
    v_mfma_f32_16x16x32_bf16 v[8:11], a[104:107], a[0:3], v[8:11]
    buffer_load_dwordx4 a[64:67], v128, s[12:15], s31 offen offset:0
    v_mfma_f32_16x16x32_bf16 v[12:15], a[108:111], a[0:3], v[12:15]
    s_waitcnt vmcnt(21)
    v_mfma_f32_16x16x32_bf16 v[16:19], a[96:99], a[4:7], v[16:19]
    buffer_load_dwordx4 v134, s[16:19], s32 offen offset:2048  lds
    v_mfma_f32_16x16x32_bf16 v[20:23], a[100:103], a[4:7], v[20:23]
    buffer_load_dwordx4 v135, s[16:19], s32 offen offset:3072  lds
    v_mfma_f32_16x16x32_bf16 v[24:27], a[104:107], a[4:7], v[24:27]
    buffer_load_dwordx4 a[68:71], v128, s[12:15], s31 offen offset:1024
    v_mfma_f32_16x16x32_bf16 v[28:31], a[108:111], a[4:7], v[28:31]
    s_waitcnt vmcnt(23)
    v_mfma_f32_16x16x32_bf16 v[32:35], a[96:99], a[8:11], v[32:35]
    buffer_load_dwordx4 a[72:75], v129, s[12:15], s31 offen offset:0
    v_mfma_f32_16x16x32_bf16 v[36:39], a[100:103], a[8:11], v[36:39]
    ds_read_b64_tr_b16 a[112:113], v136 offset:4096
    v_mfma_f32_16x16x32_bf16 v[40:43], a[104:107], a[8:11], v[40:43]
    ds_read_b64_tr_b16 a[114:115], v136 offset:6144
    v_mfma_f32_16x16x32_bf16 v[44:47], a[108:111], a[8:11], v[44:47]
    s_waitcnt vmcnt(23)
    v_mfma_f32_16x16x32_bf16 v[48:51], a[96:99], a[12:15], v[48:51]
    buffer_load_dwordx4 a[76:79], v129, s[12:15], s31 offen offset:1024
    v_mfma_f32_16x16x32_bf16 v[52:55], a[100:103], a[12:15], v[52:55]
    ds_read_b64_tr_b16 a[116:117], v137 offset:4096
    v_mfma_f32_16x16x32_bf16 v[56:59], a[104:107], a[12:15], v[56:59]
    ds_read_b64_tr_b16 a[118:119], v137 offset:6144
    v_mfma_f32_16x16x32_bf16 v[60:63], a[108:111], a[12:15], v[60:63]
    s_waitcnt vmcnt(23)
    v_mfma_f32_16x16x32_bf16 v[64:67], a[96:99], a[16:19], v[64:67]
    buffer_load_dwordx4 a[80:83], v130, s[12:15], s31 offen offset:0
    v_mfma_f32_16x16x32_bf16 v[68:71], a[100:103], a[16:19], v[68:71]
    ds_read_b64_tr_b16 a[120:121], v138 offset:4096
    v_mfma_f32_16x16x32_bf16 v[72:75], a[104:107], a[16:19], v[72:75]
    ds_read_b64_tr_b16 a[122:123], v138 offset:6144
    v_mfma_f32_16x16x32_bf16 v[76:79], a[108:111], a[16:19], v[76:79]
    s_waitcnt vmcnt(23)
    v_mfma_f32_16x16x32_bf16 v[80:83], a[96:99], a[20:23], v[80:83]
    buffer_load_dwordx4 a[84:87], v130, s[12:15], s31 offen offset:1024
    v_mfma_f32_16x16x32_bf16 v[84:87], a[100:103], a[20:23], v[84:87]
    ds_read_b64_tr_b16 a[124:125], v139 offset:4096
    v_mfma_f32_16x16x32_bf16 v[88:91], a[104:107], a[20:23], v[88:91]
    ds_read_b64_tr_b16 a[126:127], v139 offset:6144
    v_mfma_f32_16x16x32_bf16 v[92:95], a[108:111], a[20:23], v[92:95]
    s_waitcnt vmcnt(23)
    v_mfma_f32_16x16x32_bf16 v[96:99], a[96:99], a[24:27], v[96:99]
    buffer_load_dwordx4 a[88:91], v131, s[12:15], s31 offen offset:0
    v_mfma_f32_16x16x32_bf16 v[100:103], a[100:103], a[24:27], v[100:103]
    v_mfma_f32_16x16x32_bf16 v[104:107], a[104:107], a[24:27], v[104:107]
    v_mfma_f32_16x16x32_bf16 v[108:111], a[108:111], a[24:27], v[108:111]
    s_waitcnt vmcnt(23)
    v_mfma_f32_16x16x32_bf16 v[112:115], a[96:99], a[28:31], v[112:115]
    buffer_load_dwordx4 a[92:95], v131, s[12:15], s31 offen offset:1024
    s_mov_b32 s31, s36
    v_readlane_b32 s36, v141, 16
    s_nop 2
    s_lshl_b32 s32, s36, 3
    v_mfma_f32_16x16x32_bf16 v[116:119], a[100:103], a[28:31], v[116:119]
    v_mfma_f32_16x16x32_bf16 v[120:123], a[104:107], a[28:31], v[120:123]
    v_mfma_f32_16x16x32_bf16 v[124:127], a[108:111], a[28:31], v[124:127]
    s_waitcnt vmcnt(21) lgkmcnt(0)
    v_mfma_f32_16x16x32_bf16 v[0:3], a[112:115], a[32:35], v[0:3]
    s_add_u32 m0, s34, 0
    s_nop 0
    buffer_load_dwordx4 v132, s[16:19], s32 offen offset:0  lds
    v_mfma_f32_16x16x32_bf16 v[4:7], a[116:119], a[32:35], v[4:7]
    buffer_load_dwordx4 v133, s[16:19], s32 offen offset:1024  lds
    v_mfma_f32_16x16x32_bf16 v[8:11], a[120:123], a[32:35], v[8:11]
    buffer_load_dwordx4 a[0:3], v128, s[12:15], s31 offen offset:0
    v_mfma_f32_16x16x32_bf16 v[12:15], a[124:127], a[32:35], v[12:15]
    s_waitcnt vmcnt(21)
    v_mfma_f32_16x16x32_bf16 v[16:19], a[112:115], a[36:39], v[16:19]
    buffer_load_dwordx4 v134, s[16:19], s32 offen offset:2048  lds
    v_mfma_f32_16x16x32_bf16 v[20:23], a[116:119], a[36:39], v[20:23]
    buffer_load_dwordx4 v135, s[16:19], s32 offen offset:3072  lds
    v_mfma_f32_16x16x32_bf16 v[24:27], a[120:123], a[36:39], v[24:27]
    buffer_load_dwordx4 a[4:7], v128, s[12:15], s31 offen offset:1024
    v_mfma_f32_16x16x32_bf16 v[28:31], a[124:127], a[36:39], v[28:31]
    s_waitcnt vmcnt(23)
    v_mfma_f32_16x16x32_bf16 v[32:35], a[112:115], a[40:43], v[32:35]
    buffer_load_dwordx4 a[8:11], v129, s[12:15], s31 offen offset:0
    v_mfma_f32_16x16x32_bf16 v[36:39], a[116:119], a[40:43], v[36:39]
    ds_read_b64_tr_b16 a[96:97], v136 offset:8192
    v_mfma_f32_16x16x32_bf16 v[40:43], a[120:123], a[40:43], v[40:43]
    ds_read_b64_tr_b16 a[98:99], v136 offset:10240
    v_mfma_f32_16x16x32_bf16 v[44:47], a[124:127], a[40:43], v[44:47]
    s_waitcnt vmcnt(23)
    v_mfma_f32_16x16x32_bf16 v[48:51], a[112:115], a[44:47], v[48:51]
    buffer_load_dwordx4 a[12:15], v129, s[12:15], s31 offen offset:1024
    v_mfma_f32_16x16x32_bf16 v[52:55], a[116:119], a[44:47], v[52:55]
    ds_read_b64_tr_b16 a[100:101], v137 offset:8192
    v_mfma_f32_16x16x32_bf16 v[56:59], a[120:123], a[44:47], v[56:59]
    ds_read_b64_tr_b16 a[102:103], v137 offset:10240
    v_mfma_f32_16x16x32_bf16 v[60:63], a[124:127], a[44:47], v[60:63]
    s_waitcnt vmcnt(23)
    v_mfma_f32_16x16x32_bf16 v[64:67], a[112:115], a[48:51], v[64:67]
    buffer_load_dwordx4 a[16:19], v130, s[12:15], s31 offen offset:0
    v_mfma_f32_16x16x32_bf16 v[68:71], a[116:119], a[48:51], v[68:71]
    ds_read_b64_tr_b16 a[104:105], v138 offset:8192
    v_mfma_f32_16x16x32_bf16 v[72:75], a[120:123], a[48:51], v[72:75]
    ds_read_b64_tr_b16 a[106:107], v138 offset:10240
    v_mfma_f32_16x16x32_bf16 v[76:79], a[124:127], a[48:51], v[76:79]
    s_waitcnt vmcnt(23)
    v_mfma_f32_16x16x32_bf16 v[80:83], a[112:115], a[52:55], v[80:83]
    buffer_load_dwordx4 a[20:23], v130, s[12:15], s31 offen offset:1024
    v_mfma_f32_16x16x32_bf16 v[84:87], a[116:119], a[52:55], v[84:87]
    ds_read_b64_tr_b16 a[108:109], v139 offset:8192
    v_mfma_f32_16x16x32_bf16 v[88:91], a[120:123], a[52:55], v[88:91]
    ds_read_b64_tr_b16 a[110:111], v139 offset:10240
    v_mfma_f32_16x16x32_bf16 v[92:95], a[124:127], a[52:55], v[92:95]
    s_waitcnt vmcnt(23)
    v_mfma_f32_16x16x32_bf16 v[96:99], a[112:115], a[56:59], v[96:99]
    buffer_load_dwordx4 a[24:27], v131, s[12:15], s31 offen offset:0
    v_mfma_f32_16x16x32_bf16 v[100:103], a[116:119], a[56:59], v[100:103]
    v_mfma_f32_16x16x32_bf16 v[104:107], a[120:123], a[56:59], v[104:107]
    v_mfma_f32_16x16x32_bf16 v[108:111], a[124:127], a[56:59], v[108:111]
    s_waitcnt vmcnt(23)
    v_mfma_f32_16x16x32_bf16 v[112:115], a[112:115], a[60:63], v[112:115]
    buffer_load_dwordx4 a[28:31], v131, s[12:15], s31 offen offset:1024
    s_mov_b32 s31, s36
    v_readlane_b32 s36, v141, 17
    s_nop 2
    s_lshl_b32 s32, s36, 3
    v_mfma_f32_16x16x32_bf16 v[116:119], a[116:119], a[60:63], v[116:119]
    v_mfma_f32_16x16x32_bf16 v[120:123], a[120:123], a[60:63], v[120:123]
    v_mfma_f32_16x16x32_bf16 v[124:127], a[124:127], a[60:63], v[124:127]
    s_waitcnt vmcnt(21) lgkmcnt(0)
    v_mfma_f32_16x16x32_bf16 v[0:3], a[96:99], a[64:67], v[0:3]
    s_add_u32 m0, s34, 4096
    s_nop 0
    buffer_load_dwordx4 v132, s[16:19], s32 offen offset:0  lds
    v_mfma_f32_16x16x32_bf16 v[4:7], a[100:103], a[64:67], v[4:7]
    buffer_load_dwordx4 v133, s[16:19], s32 offen offset:1024  lds
    v_mfma_f32_16x16x32_bf16 v[8:11], a[104:107], a[64:67], v[8:11]
    buffer_load_dwordx4 a[32:35], v128, s[12:15], s31 offen offset:0
    v_mfma_f32_16x16x32_bf16 v[12:15], a[108:111], a[64:67], v[12:15]
    s_waitcnt vmcnt(21)
    v_mfma_f32_16x16x32_bf16 v[16:19], a[96:99], a[68:71], v[16:19]
    buffer_load_dwordx4 v134, s[16:19], s32 offen offset:2048  lds
    v_mfma_f32_16x16x32_bf16 v[20:23], a[100:103], a[68:71], v[20:23]
    buffer_load_dwordx4 v135, s[16:19], s32 offen offset:3072  lds
    v_mfma_f32_16x16x32_bf16 v[24:27], a[104:107], a[68:71], v[24:27]
    buffer_load_dwordx4 a[36:39], v128, s[12:15], s31 offen offset:1024
    v_mfma_f32_16x16x32_bf16 v[28:31], a[108:111], a[68:71], v[28:31]
    s_waitcnt vmcnt(23)
    v_mfma_f32_16x16x32_bf16 v[32:35], a[96:99], a[72:75], v[32:35]
    buffer_load_dwordx4 a[40:43], v129, s[12:15], s31 offen offset:0
    v_mfma_f32_16x16x32_bf16 v[36:39], a[100:103], a[72:75], v[36:39]
    ds_read_b64_tr_b16 a[112:113], v136 offset:12288
    v_mfma_f32_16x16x32_bf16 v[40:43], a[104:107], a[72:75], v[40:43]
    ds_read_b64_tr_b16 a[114:115], v136 offset:14336
    v_mfma_f32_16x16x32_bf16 v[44:47], a[108:111], a[72:75], v[44:47]
    s_waitcnt vmcnt(23)
    v_mfma_f32_16x16x32_bf16 v[48:51], a[96:99], a[76:79], v[48:51]
    buffer_load_dwordx4 a[44:47], v129, s[12:15], s31 offen offset:1024
    v_mfma_f32_16x16x32_bf16 v[52:55], a[100:103], a[76:79], v[52:55]
    ds_read_b64_tr_b16 a[116:117], v137 offset:12288
    v_mfma_f32_16x16x32_bf16 v[56:59], a[104:107], a[76:79], v[56:59]
    ds_read_b64_tr_b16 a[118:119], v137 offset:14336
    v_mfma_f32_16x16x32_bf16 v[60:63], a[108:111], a[76:79], v[60:63]
    s_waitcnt vmcnt(23)
    v_mfma_f32_16x16x32_bf16 v[64:67], a[96:99], a[80:83], v[64:67]
    buffer_load_dwordx4 a[48:51], v130, s[12:15], s31 offen offset:0
    v_mfma_f32_16x16x32_bf16 v[68:71], a[100:103], a[80:83], v[68:71]
    ds_read_b64_tr_b16 a[120:121], v138 offset:12288
    v_mfma_f32_16x16x32_bf16 v[72:75], a[104:107], a[80:83], v[72:75]
    ds_read_b64_tr_b16 a[122:123], v138 offset:14336
    v_mfma_f32_16x16x32_bf16 v[76:79], a[108:111], a[80:83], v[76:79]
    s_waitcnt vmcnt(23)
    v_mfma_f32_16x16x32_bf16 v[80:83], a[96:99], a[84:87], v[80:83]
    buffer_load_dwordx4 a[52:55], v130, s[12:15], s31 offen offset:1024
    v_mfma_f32_16x16x32_bf16 v[84:87], a[100:103], a[84:87], v[84:87]
    ds_read_b64_tr_b16 a[124:125], v139 offset:12288
    v_mfma_f32_16x16x32_bf16 v[88:91], a[104:107], a[84:87], v[88:91]
    ds_read_b64_tr_b16 a[126:127], v139 offset:14336
    v_mfma_f32_16x16x32_bf16 v[92:95], a[108:111], a[84:87], v[92:95]
    s_waitcnt vmcnt(23)
    v_mfma_f32_16x16x32_bf16 v[96:99], a[96:99], a[88:91], v[96:99]
    buffer_load_dwordx4 a[56:59], v131, s[12:15], s31 offen offset:0
    v_mfma_f32_16x16x32_bf16 v[100:103], a[100:103], a[88:91], v[100:103]
    v_mfma_f32_16x16x32_bf16 v[104:107], a[104:107], a[88:91], v[104:107]
    v_mfma_f32_16x16x32_bf16 v[108:111], a[108:111], a[88:91], v[108:111]
    s_waitcnt vmcnt(23)
    v_mfma_f32_16x16x32_bf16 v[112:115], a[96:99], a[92:95], v[112:115]
    buffer_load_dwordx4 a[60:63], v131, s[12:15], s31 offen offset:1024
    s_mov_b32 s31, s36
    v_readlane_b32 s36, v141, 18
    s_nop 2
    s_lshl_b32 s32, s36, 3
    v_mfma_f32_16x16x32_bf16 v[116:119], a[100:103], a[92:95], v[116:119]
    v_mfma_f32_16x16x32_bf16 v[120:123], a[104:107], a[92:95], v[120:123]
    v_mfma_f32_16x16x32_bf16 v[124:127], a[108:111], a[92:95], v[124:127]
    s_waitcnt vmcnt(21) lgkmcnt(0)
    v_mfma_f32_16x16x32_bf16 v[0:3], a[112:115], a[0:3], v[0:3]
    s_add_u32 m0, s34, 8192
    s_nop 0
    buffer_load_dwordx4 v132, s[16:19], s32 offen offset:0  lds
    v_mfma_f32_16x16x32_bf16 v[4:7], a[116:119], a[0:3], v[4:7]
    buffer_load_dwordx4 v133, s[16:19], s32 offen offset:1024  lds
    v_mfma_f32_16x16x32_bf16 v[8:11], a[120:123], a[0:3], v[8:11]
    buffer_load_dwordx4 a[64:67], v128, s[12:15], s31 offen offset:0
    v_mfma_f32_16x16x32_bf16 v[12:15], a[124:127], a[0:3], v[12:15]
    s_waitcnt vmcnt(21)
    v_mfma_f32_16x16x32_bf16 v[16:19], a[112:115], a[4:7], v[16:19]
    buffer_load_dwordx4 v134, s[16:19], s32 offen offset:2048  lds
    v_mfma_f32_16x16x32_bf16 v[20:23], a[116:119], a[4:7], v[20:23]
    buffer_load_dwordx4 v135, s[16:19], s32 offen offset:3072  lds
    v_mfma_f32_16x16x32_bf16 v[24:27], a[120:123], a[4:7], v[24:27]
    buffer_load_dwordx4 a[68:71], v128, s[12:15], s31 offen offset:1024
    v_mfma_f32_16x16x32_bf16 v[28:31], a[124:127], a[4:7], v[28:31]
    s_waitcnt vmcnt(23)
    v_mfma_f32_16x16x32_bf16 v[32:35], a[112:115], a[8:11], v[32:35]
    buffer_load_dwordx4 a[72:75], v129, s[12:15], s31 offen offset:0
    v_mfma_f32_16x16x32_bf16 v[36:39], a[116:119], a[8:11], v[36:39]
    ds_read_b64_tr_b16 a[96:97], v136 offset:0
    v_mfma_f32_16x16x32_bf16 v[40:43], a[120:123], a[8:11], v[40:43]
    ds_read_b64_tr_b16 a[98:99], v136 offset:2048
    v_mfma_f32_16x16x32_bf16 v[44:47], a[124:127], a[8:11], v[44:47]
    s_waitcnt vmcnt(23)
    v_mfma_f32_16x16x32_bf16 v[48:51], a[112:115], a[12:15], v[48:51]
    buffer_load_dwordx4 a[76:79], v129, s[12:15], s31 offen offset:1024
    v_mfma_f32_16x16x32_bf16 v[52:55], a[116:119], a[12:15], v[52:55]
    ds_read_b64_tr_b16 a[100:101], v137 offset:0
    v_mfma_f32_16x16x32_bf16 v[56:59], a[120:123], a[12:15], v[56:59]
    ds_read_b64_tr_b16 a[102:103], v137 offset:2048
    v_mfma_f32_16x16x32_bf16 v[60:63], a[124:127], a[12:15], v[60:63]
    s_waitcnt vmcnt(23)
    v_mfma_f32_16x16x32_bf16 v[64:67], a[112:115], a[16:19], v[64:67]
    buffer_load_dwordx4 a[80:83], v130, s[12:15], s31 offen offset:0
    v_mfma_f32_16x16x32_bf16 v[68:71], a[116:119], a[16:19], v[68:71]
    ds_read_b64_tr_b16 a[104:105], v138 offset:0
    v_mfma_f32_16x16x32_bf16 v[72:75], a[120:123], a[16:19], v[72:75]
    ds_read_b64_tr_b16 a[106:107], v138 offset:2048
    v_mfma_f32_16x16x32_bf16 v[76:79], a[124:127], a[16:19], v[76:79]
    s_waitcnt vmcnt(23)
    v_mfma_f32_16x16x32_bf16 v[80:83], a[112:115], a[20:23], v[80:83]
    buffer_load_dwordx4 a[84:87], v130, s[12:15], s31 offen offset:1024
    v_mfma_f32_16x16x32_bf16 v[84:87], a[116:119], a[20:23], v[84:87]
    ds_read_b64_tr_b16 a[108:109], v139 offset:0
    v_mfma_f32_16x16x32_bf16 v[88:91], a[120:123], a[20:23], v[88:91]
    ds_read_b64_tr_b16 a[110:111], v139 offset:2048
    v_mfma_f32_16x16x32_bf16 v[92:95], a[124:127], a[20:23], v[92:95]
    s_waitcnt vmcnt(23)
    v_mfma_f32_16x16x32_bf16 v[96:99], a[112:115], a[24:27], v[96:99]
    buffer_load_dwordx4 a[88:91], v131, s[12:15], s31 offen offset:0
    v_mfma_f32_16x16x32_bf16 v[100:103], a[116:119], a[24:27], v[100:103]
    v_mfma_f32_16x16x32_bf16 v[104:107], a[120:123], a[24:27], v[104:107]
    v_mfma_f32_16x16x32_bf16 v[108:111], a[124:127], a[24:27], v[108:111]
    s_waitcnt vmcnt(23)
    v_mfma_f32_16x16x32_bf16 v[112:115], a[112:115], a[28:31], v[112:115]
    buffer_load_dwordx4 a[92:95], v131, s[12:15], s31 offen offset:1024
    s_mov_b32 s31, s36
    v_readlane_b32 s36, v141, 19
    s_nop 2
    s_lshl_b32 s32, s36, 3
    v_mfma_f32_16x16x32_bf16 v[116:119], a[116:119], a[28:31], v[116:119]
    v_mfma_f32_16x16x32_bf16 v[120:123], a[120:123], a[28:31], v[120:123]
    v_mfma_f32_16x16x32_bf16 v[124:127], a[124:127], a[28:31], v[124:127]
    s_waitcnt vmcnt(21) lgkmcnt(0)
    v_mfma_f32_16x16x32_bf16 v[0:3], a[96:99], a[32:35], v[0:3]
    s_add_u32 m0, s34, 12288
    s_nop 0
    buffer_load_dwordx4 v132, s[16:19], s32 offen offset:0  lds
    v_mfma_f32_16x16x32_bf16 v[4:7], a[100:103], a[32:35], v[4:7]
    buffer_load_dwordx4 v133, s[16:19], s32 offen offset:1024  lds
    v_mfma_f32_16x16x32_bf16 v[8:11], a[104:107], a[32:35], v[8:11]
    buffer_load_dwordx4 a[0:3], v128, s[12:15], s31 offen offset:0
    v_mfma_f32_16x16x32_bf16 v[12:15], a[108:111], a[32:35], v[12:15]
    s_waitcnt vmcnt(21)
    v_mfma_f32_16x16x32_bf16 v[16:19], a[96:99], a[36:39], v[16:19]
    buffer_load_dwordx4 v134, s[16:19], s32 offen offset:2048  lds
    v_mfma_f32_16x16x32_bf16 v[20:23], a[100:103], a[36:39], v[20:23]
    buffer_load_dwordx4 v135, s[16:19], s32 offen offset:3072  lds
    v_mfma_f32_16x16x32_bf16 v[24:27], a[104:107], a[36:39], v[24:27]
    buffer_load_dwordx4 a[4:7], v128, s[12:15], s31 offen offset:1024
    v_mfma_f32_16x16x32_bf16 v[28:31], a[108:111], a[36:39], v[28:31]
    s_waitcnt vmcnt(23)
    v_mfma_f32_16x16x32_bf16 v[32:35], a[96:99], a[40:43], v[32:35]
    buffer_load_dwordx4 a[8:11], v129, s[12:15], s31 offen offset:0
    v_mfma_f32_16x16x32_bf16 v[36:39], a[100:103], a[40:43], v[36:39]
    ds_read_b64_tr_b16 a[112:113], v136 offset:4096
    v_mfma_f32_16x16x32_bf16 v[40:43], a[104:107], a[40:43], v[40:43]
    ds_read_b64_tr_b16 a[114:115], v136 offset:6144
    v_mfma_f32_16x16x32_bf16 v[44:47], a[108:111], a[40:43], v[44:47]
    s_waitcnt vmcnt(23)
    v_mfma_f32_16x16x32_bf16 v[48:51], a[96:99], a[44:47], v[48:51]
    buffer_load_dwordx4 a[12:15], v129, s[12:15], s31 offen offset:1024
    v_mfma_f32_16x16x32_bf16 v[52:55], a[100:103], a[44:47], v[52:55]
    ds_read_b64_tr_b16 a[116:117], v137 offset:4096
    v_mfma_f32_16x16x32_bf16 v[56:59], a[104:107], a[44:47], v[56:59]
    ds_read_b64_tr_b16 a[118:119], v137 offset:6144
    v_mfma_f32_16x16x32_bf16 v[60:63], a[108:111], a[44:47], v[60:63]
    s_waitcnt vmcnt(23)
    v_mfma_f32_16x16x32_bf16 v[64:67], a[96:99], a[48:51], v[64:67]
    buffer_load_dwordx4 a[16:19], v130, s[12:15], s31 offen offset:0
    v_mfma_f32_16x16x32_bf16 v[68:71], a[100:103], a[48:51], v[68:71]
    ds_read_b64_tr_b16 a[120:121], v138 offset:4096
    v_mfma_f32_16x16x32_bf16 v[72:75], a[104:107], a[48:51], v[72:75]
    ds_read_b64_tr_b16 a[122:123], v138 offset:6144
    v_mfma_f32_16x16x32_bf16 v[76:79], a[108:111], a[48:51], v[76:79]
    s_waitcnt vmcnt(23)
    v_mfma_f32_16x16x32_bf16 v[80:83], a[96:99], a[52:55], v[80:83]
    buffer_load_dwordx4 a[20:23], v130, s[12:15], s31 offen offset:1024
    v_mfma_f32_16x16x32_bf16 v[84:87], a[100:103], a[52:55], v[84:87]
    ds_read_b64_tr_b16 a[124:125], v139 offset:4096
    v_mfma_f32_16x16x32_bf16 v[88:91], a[104:107], a[52:55], v[88:91]
    ds_read_b64_tr_b16 a[126:127], v139 offset:6144
    v_mfma_f32_16x16x32_bf16 v[92:95], a[108:111], a[52:55], v[92:95]
    s_waitcnt vmcnt(23)
    v_mfma_f32_16x16x32_bf16 v[96:99], a[96:99], a[56:59], v[96:99]
    buffer_load_dwordx4 a[24:27], v131, s[12:15], s31 offen offset:0
    v_mfma_f32_16x16x32_bf16 v[100:103], a[100:103], a[56:59], v[100:103]
    v_mfma_f32_16x16x32_bf16 v[104:107], a[104:107], a[56:59], v[104:107]
    v_mfma_f32_16x16x32_bf16 v[108:111], a[108:111], a[56:59], v[108:111]
    s_waitcnt vmcnt(23)
    v_mfma_f32_16x16x32_bf16 v[112:115], a[96:99], a[60:63], v[112:115]
    buffer_load_dwordx4 a[28:31], v131, s[12:15], s31 offen offset:1024
    s_mov_b32 s31, s36
    v_readlane_b32 s36, v141, 20
    s_nop 2
    s_lshl_b32 s32, s36, 3
    v_mfma_f32_16x16x32_bf16 v[116:119], a[100:103], a[60:63], v[116:119]
    v_mfma_f32_16x16x32_bf16 v[120:123], a[104:107], a[60:63], v[120:123]
    v_mfma_f32_16x16x32_bf16 v[124:127], a[108:111], a[60:63], v[124:127]
    s_waitcnt vmcnt(21) lgkmcnt(0)
    v_mfma_f32_16x16x32_bf16 v[0:3], a[112:115], a[64:67], v[0:3]
    s_add_u32 m0, s34, 0
    s_nop 0
    buffer_load_dwordx4 v132, s[16:19], s32 offen offset:0  lds
    v_mfma_f32_16x16x32_bf16 v[4:7], a[116:119], a[64:67], v[4:7]
    buffer_load_dwordx4 v133, s[16:19], s32 offen offset:1024  lds
    v_mfma_f32_16x16x32_bf16 v[8:11], a[120:123], a[64:67], v[8:11]
    buffer_load_dwordx4 a[32:35], v128, s[12:15], s31 offen offset:0
    v_mfma_f32_16x16x32_bf16 v[12:15], a[124:127], a[64:67], v[12:15]
    s_waitcnt vmcnt(21)
    v_mfma_f32_16x16x32_bf16 v[16:19], a[112:115], a[68:71], v[16:19]
    buffer_load_dwordx4 v134, s[16:19], s32 offen offset:2048  lds
    v_mfma_f32_16x16x32_bf16 v[20:23], a[116:119], a[68:71], v[20:23]
    buffer_load_dwordx4 v135, s[16:19], s32 offen offset:3072  lds
    v_mfma_f32_16x16x32_bf16 v[24:27], a[120:123], a[68:71], v[24:27]
    buffer_load_dwordx4 a[36:39], v128, s[12:15], s31 offen offset:1024
    v_mfma_f32_16x16x32_bf16 v[28:31], a[124:127], a[68:71], v[28:31]
    s_waitcnt vmcnt(23)
    v_mfma_f32_16x16x32_bf16 v[32:35], a[112:115], a[72:75], v[32:35]
    buffer_load_dwordx4 a[40:43], v129, s[12:15], s31 offen offset:0
    v_mfma_f32_16x16x32_bf16 v[36:39], a[116:119], a[72:75], v[36:39]
    ds_read_b64_tr_b16 a[96:97], v136 offset:8192
    v_mfma_f32_16x16x32_bf16 v[40:43], a[120:123], a[72:75], v[40:43]
    ds_read_b64_tr_b16 a[98:99], v136 offset:10240
    v_mfma_f32_16x16x32_bf16 v[44:47], a[124:127], a[72:75], v[44:47]
    s_waitcnt vmcnt(23)
    v_mfma_f32_16x16x32_bf16 v[48:51], a[112:115], a[76:79], v[48:51]
    buffer_load_dwordx4 a[44:47], v129, s[12:15], s31 offen offset:1024
    v_mfma_f32_16x16x32_bf16 v[52:55], a[116:119], a[76:79], v[52:55]
    ds_read_b64_tr_b16 a[100:101], v137 offset:8192
    v_mfma_f32_16x16x32_bf16 v[56:59], a[120:123], a[76:79], v[56:59]
    ds_read_b64_tr_b16 a[102:103], v137 offset:10240
    v_mfma_f32_16x16x32_bf16 v[60:63], a[124:127], a[76:79], v[60:63]
    s_waitcnt vmcnt(23)
    v_mfma_f32_16x16x32_bf16 v[64:67], a[112:115], a[80:83], v[64:67]
    buffer_load_dwordx4 a[48:51], v130, s[12:15], s31 offen offset:0
    v_mfma_f32_16x16x32_bf16 v[68:71], a[116:119], a[80:83], v[68:71]
    ds_read_b64_tr_b16 a[104:105], v138 offset:8192
    v_mfma_f32_16x16x32_bf16 v[72:75], a[120:123], a[80:83], v[72:75]
    ds_read_b64_tr_b16 a[106:107], v138 offset:10240
    v_mfma_f32_16x16x32_bf16 v[76:79], a[124:127], a[80:83], v[76:79]
    s_waitcnt vmcnt(23)
    v_mfma_f32_16x16x32_bf16 v[80:83], a[112:115], a[84:87], v[80:83]
    buffer_load_dwordx4 a[52:55], v130, s[12:15], s31 offen offset:1024
    v_mfma_f32_16x16x32_bf16 v[84:87], a[116:119], a[84:87], v[84:87]
    ds_read_b64_tr_b16 a[108:109], v139 offset:8192
    v_mfma_f32_16x16x32_bf16 v[88:91], a[120:123], a[84:87], v[88:91]
    ds_read_b64_tr_b16 a[110:111], v139 offset:10240
    v_mfma_f32_16x16x32_bf16 v[92:95], a[124:127], a[84:87], v[92:95]
    s_waitcnt vmcnt(23)
    v_mfma_f32_16x16x32_bf16 v[96:99], a[112:115], a[88:91], v[96:99]
    buffer_load_dwordx4 a[56:59], v131, s[12:15], s31 offen offset:0
    v_mfma_f32_16x16x32_bf16 v[100:103], a[116:119], a[88:91], v[100:103]
    v_mfma_f32_16x16x32_bf16 v[104:107], a[120:123], a[88:91], v[104:107]
    v_mfma_f32_16x16x32_bf16 v[108:111], a[124:127], a[88:91], v[108:111]
    s_waitcnt vmcnt(23)
    v_mfma_f32_16x16x32_bf16 v[112:115], a[112:115], a[92:95], v[112:115]
    buffer_load_dwordx4 a[60:63], v131, s[12:15], s31 offen offset:1024
    s_mov_b32 s31, s36
    v_readlane_b32 s36, v141, 21
    s_nop 2
    s_lshl_b32 s32, s36, 3
    v_mfma_f32_16x16x32_bf16 v[116:119], a[116:119], a[92:95], v[116:119]
    v_mfma_f32_16x16x32_bf16 v[120:123], a[120:123], a[92:95], v[120:123]
    v_mfma_f32_16x16x32_bf16 v[124:127], a[124:127], a[92:95], v[124:127]
    s_waitcnt vmcnt(21) lgkmcnt(0)
    v_mfma_f32_16x16x32_bf16 v[0:3], a[96:99], a[0:3], v[0:3]
    s_add_u32 m0, s34, 4096
    s_nop 0
    buffer_load_dwordx4 v132, s[16:19], s32 offen offset:0  lds
    v_mfma_f32_16x16x32_bf16 v[4:7], a[100:103], a[0:3], v[4:7]
    buffer_load_dwordx4 v133, s[16:19], s32 offen offset:1024  lds
    v_mfma_f32_16x16x32_bf16 v[8:11], a[104:107], a[0:3], v[8:11]
    buffer_load_dwordx4 a[64:67], v128, s[12:15], s31 offen offset:0
    v_mfma_f32_16x16x32_bf16 v[12:15], a[108:111], a[0:3], v[12:15]
    s_waitcnt vmcnt(21)
    v_mfma_f32_16x16x32_bf16 v[16:19], a[96:99], a[4:7], v[16:19]
    buffer_load_dwordx4 v134, s[16:19], s32 offen offset:2048  lds
    v_mfma_f32_16x16x32_bf16 v[20:23], a[100:103], a[4:7], v[20:23]
    buffer_load_dwordx4 v135, s[16:19], s32 offen offset:3072  lds
    v_mfma_f32_16x16x32_bf16 v[24:27], a[104:107], a[4:7], v[24:27]
    buffer_load_dwordx4 a[68:71], v128, s[12:15], s31 offen offset:1024
    v_mfma_f32_16x16x32_bf16 v[28:31], a[108:111], a[4:7], v[28:31]
    s_waitcnt vmcnt(23)
    v_mfma_f32_16x16x32_bf16 v[32:35], a[96:99], a[8:11], v[32:35]
    buffer_load_dwordx4 a[72:75], v129, s[12:15], s31 offen offset:0
    v_mfma_f32_16x16x32_bf16 v[36:39], a[100:103], a[8:11], v[36:39]
    ds_read_b64_tr_b16 a[112:113], v136 offset:12288
    v_mfma_f32_16x16x32_bf16 v[40:43], a[104:107], a[8:11], v[40:43]
    ds_read_b64_tr_b16 a[114:115], v136 offset:14336
    v_mfma_f32_16x16x32_bf16 v[44:47], a[108:111], a[8:11], v[44:47]
    s_waitcnt vmcnt(23)
    v_mfma_f32_16x16x32_bf16 v[48:51], a[96:99], a[12:15], v[48:51]
    buffer_load_dwordx4 a[76:79], v129, s[12:15], s31 offen offset:1024
    v_mfma_f32_16x16x32_bf16 v[52:55], a[100:103], a[12:15], v[52:55]
    ds_read_b64_tr_b16 a[116:117], v137 offset:12288
    v_mfma_f32_16x16x32_bf16 v[56:59], a[104:107], a[12:15], v[56:59]
    ds_read_b64_tr_b16 a[118:119], v137 offset:14336
    v_mfma_f32_16x16x32_bf16 v[60:63], a[108:111], a[12:15], v[60:63]
    s_waitcnt vmcnt(23)
    v_mfma_f32_16x16x32_bf16 v[64:67], a[96:99], a[16:19], v[64:67]
    buffer_load_dwordx4 a[80:83], v130, s[12:15], s31 offen offset:0
    v_mfma_f32_16x16x32_bf16 v[68:71], a[100:103], a[16:19], v[68:71]
    ds_read_b64_tr_b16 a[120:121], v138 offset:12288
    v_mfma_f32_16x16x32_bf16 v[72:75], a[104:107], a[16:19], v[72:75]
    ds_read_b64_tr_b16 a[122:123], v138 offset:14336
    v_mfma_f32_16x16x32_bf16 v[76:79], a[108:111], a[16:19], v[76:79]
    s_waitcnt vmcnt(23)
    v_mfma_f32_16x16x32_bf16 v[80:83], a[96:99], a[20:23], v[80:83]
    buffer_load_dwordx4 a[84:87], v130, s[12:15], s31 offen offset:1024
    v_mfma_f32_16x16x32_bf16 v[84:87], a[100:103], a[20:23], v[84:87]
    ds_read_b64_tr_b16 a[124:125], v139 offset:12288
    v_mfma_f32_16x16x32_bf16 v[88:91], a[104:107], a[20:23], v[88:91]
    ds_read_b64_tr_b16 a[126:127], v139 offset:14336
    v_mfma_f32_16x16x32_bf16 v[92:95], a[108:111], a[20:23], v[92:95]
    s_waitcnt vmcnt(23)
    v_mfma_f32_16x16x32_bf16 v[96:99], a[96:99], a[24:27], v[96:99]
    buffer_load_dwordx4 a[88:91], v131, s[12:15], s31 offen offset:0
    v_mfma_f32_16x16x32_bf16 v[100:103], a[100:103], a[24:27], v[100:103]
    v_mfma_f32_16x16x32_bf16 v[104:107], a[104:107], a[24:27], v[104:107]
    v_mfma_f32_16x16x32_bf16 v[108:111], a[108:111], a[24:27], v[108:111]
    s_waitcnt vmcnt(23)
    v_mfma_f32_16x16x32_bf16 v[112:115], a[96:99], a[28:31], v[112:115]
    buffer_load_dwordx4 a[92:95], v131, s[12:15], s31 offen offset:1024
    s_mov_b32 s31, s36
    v_readlane_b32 s36, v141, 22
    s_nop 2
    s_lshl_b32 s32, s36, 3
    v_mfma_f32_16x16x32_bf16 v[116:119], a[100:103], a[28:31], v[116:119]
    v_mfma_f32_16x16x32_bf16 v[120:123], a[104:107], a[28:31], v[120:123]
    v_mfma_f32_16x16x32_bf16 v[124:127], a[108:111], a[28:31], v[124:127]
    s_waitcnt vmcnt(21) lgkmcnt(0)
    v_mfma_f32_16x16x32_bf16 v[0:3], a[112:115], a[32:35], v[0:3]
    s_add_u32 m0, s34, 8192
    s_nop 0
    buffer_load_dwordx4 v132, s[16:19], s32 offen offset:0  lds
    v_mfma_f32_16x16x32_bf16 v[4:7], a[116:119], a[32:35], v[4:7]
    buffer_load_dwordx4 v133, s[16:19], s32 offen offset:1024  lds
    v_mfma_f32_16x16x32_bf16 v[8:11], a[120:123], a[32:35], v[8:11]
    buffer_load_dwordx4 a[0:3], v128, s[12:15], s31 offen offset:0
    v_mfma_f32_16x16x32_bf16 v[12:15], a[124:127], a[32:35], v[12:15]
    s_waitcnt vmcnt(21)
    v_mfma_f32_16x16x32_bf16 v[16:19], a[112:115], a[36:39], v[16:19]
    buffer_load_dwordx4 v134, s[16:19], s32 offen offset:2048  lds
    v_mfma_f32_16x16x32_bf16 v[20:23], a[116:119], a[36:39], v[20:23]
    buffer_load_dwordx4 v135, s[16:19], s32 offen offset:3072  lds
    v_mfma_f32_16x16x32_bf16 v[24:27], a[120:123], a[36:39], v[24:27]
    buffer_load_dwordx4 a[4:7], v128, s[12:15], s31 offen offset:1024
    v_mfma_f32_16x16x32_bf16 v[28:31], a[124:127], a[36:39], v[28:31]
    s_waitcnt vmcnt(23)
    v_mfma_f32_16x16x32_bf16 v[32:35], a[112:115], a[40:43], v[32:35]
    buffer_load_dwordx4 a[8:11], v129, s[12:15], s31 offen offset:0
    v_mfma_f32_16x16x32_bf16 v[36:39], a[116:119], a[40:43], v[36:39]
    ds_read_b64_tr_b16 a[96:97], v136 offset:0
    v_mfma_f32_16x16x32_bf16 v[40:43], a[120:123], a[40:43], v[40:43]
    ds_read_b64_tr_b16 a[98:99], v136 offset:2048
    v_mfma_f32_16x16x32_bf16 v[44:47], a[124:127], a[40:43], v[44:47]
    s_waitcnt vmcnt(23)
    v_mfma_f32_16x16x32_bf16 v[48:51], a[112:115], a[44:47], v[48:51]
    buffer_load_dwordx4 a[12:15], v129, s[12:15], s31 offen offset:1024
    v_mfma_f32_16x16x32_bf16 v[52:55], a[116:119], a[44:47], v[52:55]
    ds_read_b64_tr_b16 a[100:101], v137 offset:0
    v_mfma_f32_16x16x32_bf16 v[56:59], a[120:123], a[44:47], v[56:59]
    ds_read_b64_tr_b16 a[102:103], v137 offset:2048
    v_mfma_f32_16x16x32_bf16 v[60:63], a[124:127], a[44:47], v[60:63]
    s_waitcnt vmcnt(23)
    v_mfma_f32_16x16x32_bf16 v[64:67], a[112:115], a[48:51], v[64:67]
    buffer_load_dwordx4 a[16:19], v130, s[12:15], s31 offen offset:0
    v_mfma_f32_16x16x32_bf16 v[68:71], a[116:119], a[48:51], v[68:71]
    ds_read_b64_tr_b16 a[104:105], v138 offset:0
    v_mfma_f32_16x16x32_bf16 v[72:75], a[120:123], a[48:51], v[72:75]
    ds_read_b64_tr_b16 a[106:107], v138 offset:2048
    v_mfma_f32_16x16x32_bf16 v[76:79], a[124:127], a[48:51], v[76:79]
    s_waitcnt vmcnt(23)
    v_mfma_f32_16x16x32_bf16 v[80:83], a[112:115], a[52:55], v[80:83]
    buffer_load_dwordx4 a[20:23], v130, s[12:15], s31 offen offset:1024
    v_mfma_f32_16x16x32_bf16 v[84:87], a[116:119], a[52:55], v[84:87]
    ds_read_b64_tr_b16 a[108:109], v139 offset:0
    v_mfma_f32_16x16x32_bf16 v[88:91], a[120:123], a[52:55], v[88:91]
    ds_read_b64_tr_b16 a[110:111], v139 offset:2048
    v_mfma_f32_16x16x32_bf16 v[92:95], a[124:127], a[52:55], v[92:95]
    s_waitcnt vmcnt(23)
    v_mfma_f32_16x16x32_bf16 v[96:99], a[112:115], a[56:59], v[96:99]
    buffer_load_dwordx4 a[24:27], v131, s[12:15], s31 offen offset:0
    v_mfma_f32_16x16x32_bf16 v[100:103], a[116:119], a[56:59], v[100:103]
    v_mfma_f32_16x16x32_bf16 v[104:107], a[120:123], a[56:59], v[104:107]
    v_mfma_f32_16x16x32_bf16 v[108:111], a[124:127], a[56:59], v[108:111]
    s_waitcnt vmcnt(23)
    v_mfma_f32_16x16x32_bf16 v[112:115], a[112:115], a[60:63], v[112:115]
    buffer_load_dwordx4 a[28:31], v131, s[12:15], s31 offen offset:1024
    s_mov_b32 s31, s36
    v_readlane_b32 s36, v141, 23
    s_nop 2
    s_lshl_b32 s32, s36, 3
    v_mfma_f32_16x16x32_bf16 v[116:119], a[116:119], a[60:63], v[116:119]
    v_mfma_f32_16x16x32_bf16 v[120:123], a[120:123], a[60:63], v[120:123]
    v_mfma_f32_16x16x32_bf16 v[124:127], a[124:127], a[60:63], v[124:127]
    s_waitcnt vmcnt(21) lgkmcnt(0)
    v_mfma_f32_16x16x32_bf16 v[0:3], a[96:99], a[64:67], v[0:3]
    s_add_u32 m0, s34, 12288
    s_nop 0
    buffer_load_dwordx4 v132, s[16:19], s32 offen offset:0  lds
    v_mfma_f32_16x16x32_bf16 v[4:7], a[100:103], a[64:67], v[4:7]
    buffer_load_dwordx4 v133, s[16:19], s32 offen offset:1024  lds
    v_mfma_f32_16x16x32_bf16 v[8:11], a[104:107], a[64:67], v[8:11]
    buffer_load_dwordx4 a[32:35], v128, s[12:15], s31 offen offset:0
    v_mfma_f32_16x16x32_bf16 v[12:15], a[108:111], a[64:67], v[12:15]
    s_waitcnt vmcnt(21)
    v_mfma_f32_16x16x32_bf16 v[16:19], a[96:99], a[68:71], v[16:19]
    buffer_load_dwordx4 v134, s[16:19], s32 offen offset:2048  lds
    v_mfma_f32_16x16x32_bf16 v[20:23], a[100:103], a[68:71], v[20:23]
    buffer_load_dwordx4 v135, s[16:19], s32 offen offset:3072  lds
    v_mfma_f32_16x16x32_bf16 v[24:27], a[104:107], a[68:71], v[24:27]
    buffer_load_dwordx4 a[36:39], v128, s[12:15], s31 offen offset:1024
    v_mfma_f32_16x16x32_bf16 v[28:31], a[108:111], a[68:71], v[28:31]
    s_waitcnt vmcnt(23)
    v_mfma_f32_16x16x32_bf16 v[32:35], a[96:99], a[72:75], v[32:35]
    buffer_load_dwordx4 a[40:43], v129, s[12:15], s31 offen offset:0
    v_mfma_f32_16x16x32_bf16 v[36:39], a[100:103], a[72:75], v[36:39]
    ds_read_b64_tr_b16 a[112:113], v136 offset:4096
    v_mfma_f32_16x16x32_bf16 v[40:43], a[104:107], a[72:75], v[40:43]
    ds_read_b64_tr_b16 a[114:115], v136 offset:6144
    v_mfma_f32_16x16x32_bf16 v[44:47], a[108:111], a[72:75], v[44:47]
    s_waitcnt vmcnt(23)
    v_mfma_f32_16x16x32_bf16 v[48:51], a[96:99], a[76:79], v[48:51]
    buffer_load_dwordx4 a[44:47], v129, s[12:15], s31 offen offset:1024
    v_mfma_f32_16x16x32_bf16 v[52:55], a[100:103], a[76:79], v[52:55]
    ds_read_b64_tr_b16 a[116:117], v137 offset:4096
    v_mfma_f32_16x16x32_bf16 v[56:59], a[104:107], a[76:79], v[56:59]
    ds_read_b64_tr_b16 a[118:119], v137 offset:6144
    v_mfma_f32_16x16x32_bf16 v[60:63], a[108:111], a[76:79], v[60:63]
    s_waitcnt vmcnt(23)
    v_mfma_f32_16x16x32_bf16 v[64:67], a[96:99], a[80:83], v[64:67]
    buffer_load_dwordx4 a[48:51], v130, s[12:15], s31 offen offset:0
    v_mfma_f32_16x16x32_bf16 v[68:71], a[100:103], a[80:83], v[68:71]
    ds_read_b64_tr_b16 a[120:121], v138 offset:4096
    v_mfma_f32_16x16x32_bf16 v[72:75], a[104:107], a[80:83], v[72:75]
    ds_read_b64_tr_b16 a[122:123], v138 offset:6144
    v_mfma_f32_16x16x32_bf16 v[76:79], a[108:111], a[80:83], v[76:79]
    s_waitcnt vmcnt(23)
    v_mfma_f32_16x16x32_bf16 v[80:83], a[96:99], a[84:87], v[80:83]
    buffer_load_dwordx4 a[52:55], v130, s[12:15], s31 offen offset:1024
    v_mfma_f32_16x16x32_bf16 v[84:87], a[100:103], a[84:87], v[84:87]
    ds_read_b64_tr_b16 a[124:125], v139 offset:4096
    v_mfma_f32_16x16x32_bf16 v[88:91], a[104:107], a[84:87], v[88:91]
    ds_read_b64_tr_b16 a[126:127], v139 offset:6144
    v_mfma_f32_16x16x32_bf16 v[92:95], a[108:111], a[84:87], v[92:95]
    s_waitcnt vmcnt(23)
    v_mfma_f32_16x16x32_bf16 v[96:99], a[96:99], a[88:91], v[96:99]
    buffer_load_dwordx4 a[56:59], v131, s[12:15], s31 offen offset:0
    v_mfma_f32_16x16x32_bf16 v[100:103], a[100:103], a[88:91], v[100:103]
    v_mfma_f32_16x16x32_bf16 v[104:107], a[104:107], a[88:91], v[104:107]
    v_mfma_f32_16x16x32_bf16 v[108:111], a[108:111], a[88:91], v[108:111]
    s_waitcnt vmcnt(23)
    v_mfma_f32_16x16x32_bf16 v[112:115], a[96:99], a[92:95], v[112:115]
    buffer_load_dwordx4 a[60:63], v131, s[12:15], s31 offen offset:1024
    s_mov_b32 s31, s36
    v_readlane_b32 s36, v141, 24
    s_nop 2
    s_lshl_b32 s32, s36, 3
    v_mfma_f32_16x16x32_bf16 v[116:119], a[100:103], a[92:95], v[116:119]
    v_mfma_f32_16x16x32_bf16 v[120:123], a[104:107], a[92:95], v[120:123]
    v_mfma_f32_16x16x32_bf16 v[124:127], a[108:111], a[92:95], v[124:127]
    s_waitcnt vmcnt(21) lgkmcnt(0)
    v_mfma_f32_16x16x32_bf16 v[0:3], a[112:115], a[0:3], v[0:3]
    s_add_u32 m0, s34, 0
    s_nop 0
    buffer_load_dwordx4 v132, s[16:19], s32 offen offset:0  lds
    v_mfma_f32_16x16x32_bf16 v[4:7], a[116:119], a[0:3], v[4:7]
    buffer_load_dwordx4 v133, s[16:19], s32 offen offset:1024  lds
    v_mfma_f32_16x16x32_bf16 v[8:11], a[120:123], a[0:3], v[8:11]
    buffer_load_dwordx4 a[64:67], v128, s[12:15], s31 offen offset:0
    v_mfma_f32_16x16x32_bf16 v[12:15], a[124:127], a[0:3], v[12:15]
    s_waitcnt vmcnt(21)
    v_mfma_f32_16x16x32_bf16 v[16:19], a[112:115], a[4:7], v[16:19]
    buffer_load_dwordx4 v134, s[16:19], s32 offen offset:2048  lds
    v_mfma_f32_16x16x32_bf16 v[20:23], a[116:119], a[4:7], v[20:23]
    buffer_load_dwordx4 v135, s[16:19], s32 offen offset:3072  lds
    v_mfma_f32_16x16x32_bf16 v[24:27], a[120:123], a[4:7], v[24:27]
    buffer_load_dwordx4 a[68:71], v128, s[12:15], s31 offen offset:1024
    v_mfma_f32_16x16x32_bf16 v[28:31], a[124:127], a[4:7], v[28:31]
    s_waitcnt vmcnt(23)
    v_mfma_f32_16x16x32_bf16 v[32:35], a[112:115], a[8:11], v[32:35]
    buffer_load_dwordx4 a[72:75], v129, s[12:15], s31 offen offset:0
    v_mfma_f32_16x16x32_bf16 v[36:39], a[116:119], a[8:11], v[36:39]
    ds_read_b64_tr_b16 a[96:97], v136 offset:8192
    v_mfma_f32_16x16x32_bf16 v[40:43], a[120:123], a[8:11], v[40:43]
    ds_read_b64_tr_b16 a[98:99], v136 offset:10240
    v_mfma_f32_16x16x32_bf16 v[44:47], a[124:127], a[8:11], v[44:47]
    s_waitcnt vmcnt(23)
    v_mfma_f32_16x16x32_bf16 v[48:51], a[112:115], a[12:15], v[48:51]
    buffer_load_dwordx4 a[76:79], v129, s[12:15], s31 offen offset:1024
    v_mfma_f32_16x16x32_bf16 v[52:55], a[116:119], a[12:15], v[52:55]
    ds_read_b64_tr_b16 a[100:101], v137 offset:8192
    v_mfma_f32_16x16x32_bf16 v[56:59], a[120:123], a[12:15], v[56:59]
    ds_read_b64_tr_b16 a[102:103], v137 offset:10240
    v_mfma_f32_16x16x32_bf16 v[60:63], a[124:127], a[12:15], v[60:63]
    s_waitcnt vmcnt(23)
    v_mfma_f32_16x16x32_bf16 v[64:67], a[112:115], a[16:19], v[64:67]
    buffer_load_dwordx4 a[80:83], v130, s[12:15], s31 offen offset:0
    v_mfma_f32_16x16x32_bf16 v[68:71], a[116:119], a[16:19], v[68:71]
    ds_read_b64_tr_b16 a[104:105], v138 offset:8192
    v_mfma_f32_16x16x32_bf16 v[72:75], a[120:123], a[16:19], v[72:75]
    ds_read_b64_tr_b16 a[106:107], v138 offset:10240
    v_mfma_f32_16x16x32_bf16 v[76:79], a[124:127], a[16:19], v[76:79]
    s_waitcnt vmcnt(23)
    v_mfma_f32_16x16x32_bf16 v[80:83], a[112:115], a[20:23], v[80:83]
    buffer_load_dwordx4 a[84:87], v130, s[12:15], s31 offen offset:1024
    v_mfma_f32_16x16x32_bf16 v[84:87], a[116:119], a[20:23], v[84:87]
    ds_read_b64_tr_b16 a[108:109], v139 offset:8192
    v_mfma_f32_16x16x32_bf16 v[88:91], a[120:123], a[20:23], v[88:91]
    ds_read_b64_tr_b16 a[110:111], v139 offset:10240
    v_mfma_f32_16x16x32_bf16 v[92:95], a[124:127], a[20:23], v[92:95]
    s_waitcnt vmcnt(23)
    v_mfma_f32_16x16x32_bf16 v[96:99], a[112:115], a[24:27], v[96:99]
    buffer_load_dwordx4 a[88:91], v131, s[12:15], s31 offen offset:0
    v_mfma_f32_16x16x32_bf16 v[100:103], a[116:119], a[24:27], v[100:103]
    v_mfma_f32_16x16x32_bf16 v[104:107], a[120:123], a[24:27], v[104:107]
    v_mfma_f32_16x16x32_bf16 v[108:111], a[124:127], a[24:27], v[108:111]
    s_waitcnt vmcnt(23)
    v_mfma_f32_16x16x32_bf16 v[112:115], a[112:115], a[28:31], v[112:115]
    buffer_load_dwordx4 a[92:95], v131, s[12:15], s31 offen offset:1024
    s_mov_b32 s31, s36
    v_readlane_b32 s36, v141, 25
    s_nop 2
    s_lshl_b32 s32, s36, 3
    v_mfma_f32_16x16x32_bf16 v[116:119], a[116:119], a[28:31], v[116:119]
    v_mfma_f32_16x16x32_bf16 v[120:123], a[120:123], a[28:31], v[120:123]
    v_mfma_f32_16x16x32_bf16 v[124:127], a[124:127], a[28:31], v[124:127]
    s_waitcnt vmcnt(21) lgkmcnt(0)
    v_mfma_f32_16x16x32_bf16 v[0:3], a[96:99], a[32:35], v[0:3]
    s_add_u32 m0, s34, 4096
    s_nop 0
    buffer_load_dwordx4 v132, s[16:19], s32 offen offset:0  lds
    v_mfma_f32_16x16x32_bf16 v[4:7], a[100:103], a[32:35], v[4:7]
    buffer_load_dwordx4 v133, s[16:19], s32 offen offset:1024  lds
    v_mfma_f32_16x16x32_bf16 v[8:11], a[104:107], a[32:35], v[8:11]
    buffer_load_dwordx4 a[0:3], v128, s[12:15], s31 offen offset:0
    v_mfma_f32_16x16x32_bf16 v[12:15], a[108:111], a[32:35], v[12:15]
    s_waitcnt vmcnt(21)
    v_mfma_f32_16x16x32_bf16 v[16:19], a[96:99], a[36:39], v[16:19]
    buffer_load_dwordx4 v134, s[16:19], s32 offen offset:2048  lds
    v_mfma_f32_16x16x32_bf16 v[20:23], a[100:103], a[36:39], v[20:23]
    buffer_load_dwordx4 v135, s[16:19], s32 offen offset:3072  lds
    v_mfma_f32_16x16x32_bf16 v[24:27], a[104:107], a[36:39], v[24:27]
    buffer_load_dwordx4 a[4:7], v128, s[12:15], s31 offen offset:1024
    v_mfma_f32_16x16x32_bf16 v[28:31], a[108:111], a[36:39], v[28:31]
    s_waitcnt vmcnt(23)
    v_mfma_f32_16x16x32_bf16 v[32:35], a[96:99], a[40:43], v[32:35]
    buffer_load_dwordx4 a[8:11], v129, s[12:15], s31 offen offset:0
    v_mfma_f32_16x16x32_bf16 v[36:39], a[100:103], a[40:43], v[36:39]
    ds_read_b64_tr_b16 a[112:113], v136 offset:12288
    v_mfma_f32_16x16x32_bf16 v[40:43], a[104:107], a[40:43], v[40:43]
    ds_read_b64_tr_b16 a[114:115], v136 offset:14336
    v_mfma_f32_16x16x32_bf16 v[44:47], a[108:111], a[40:43], v[44:47]
    s_waitcnt vmcnt(23)
    v_mfma_f32_16x16x32_bf16 v[48:51], a[96:99], a[44:47], v[48:51]
    buffer_load_dwordx4 a[12:15], v129, s[12:15], s31 offen offset:1024
    v_mfma_f32_16x16x32_bf16 v[52:55], a[100:103], a[44:47], v[52:55]
    ds_read_b64_tr_b16 a[116:117], v137 offset:12288
    v_mfma_f32_16x16x32_bf16 v[56:59], a[104:107], a[44:47], v[56:59]
    ds_read_b64_tr_b16 a[118:119], v137 offset:14336
    v_mfma_f32_16x16x32_bf16 v[60:63], a[108:111], a[44:47], v[60:63]
    s_waitcnt vmcnt(23)
    v_mfma_f32_16x16x32_bf16 v[64:67], a[96:99], a[48:51], v[64:67]
    buffer_load_dwordx4 a[16:19], v130, s[12:15], s31 offen offset:0
    v_mfma_f32_16x16x32_bf16 v[68:71], a[100:103], a[48:51], v[68:71]
    ds_read_b64_tr_b16 a[120:121], v138 offset:12288
    v_mfma_f32_16x16x32_bf16 v[72:75], a[104:107], a[48:51], v[72:75]
    ds_read_b64_tr_b16 a[122:123], v138 offset:14336
    v_mfma_f32_16x16x32_bf16 v[76:79], a[108:111], a[48:51], v[76:79]
    s_waitcnt vmcnt(23)
    v_mfma_f32_16x16x32_bf16 v[80:83], a[96:99], a[52:55], v[80:83]
    buffer_load_dwordx4 a[20:23], v130, s[12:15], s31 offen offset:1024
    v_mfma_f32_16x16x32_bf16 v[84:87], a[100:103], a[52:55], v[84:87]
    ds_read_b64_tr_b16 a[124:125], v139 offset:12288
    v_mfma_f32_16x16x32_bf16 v[88:91], a[104:107], a[52:55], v[88:91]
    ds_read_b64_tr_b16 a[126:127], v139 offset:14336
    v_mfma_f32_16x16x32_bf16 v[92:95], a[108:111], a[52:55], v[92:95]
    s_waitcnt vmcnt(23)
    v_mfma_f32_16x16x32_bf16 v[96:99], a[96:99], a[56:59], v[96:99]
    buffer_load_dwordx4 a[24:27], v131, s[12:15], s31 offen offset:0
    v_mfma_f32_16x16x32_bf16 v[100:103], a[100:103], a[56:59], v[100:103]
    v_mfma_f32_16x16x32_bf16 v[104:107], a[104:107], a[56:59], v[104:107]
    v_mfma_f32_16x16x32_bf16 v[108:111], a[108:111], a[56:59], v[108:111]
    s_waitcnt vmcnt(23)
    v_mfma_f32_16x16x32_bf16 v[112:115], a[96:99], a[60:63], v[112:115]
    buffer_load_dwordx4 a[28:31], v131, s[12:15], s31 offen offset:1024
    s_mov_b32 s31, s36
    v_readlane_b32 s36, v141, 26
    s_nop 2
    s_lshl_b32 s32, s36, 3
    v_mfma_f32_16x16x32_bf16 v[116:119], a[100:103], a[60:63], v[116:119]
    v_mfma_f32_16x16x32_bf16 v[120:123], a[104:107], a[60:63], v[120:123]
    v_mfma_f32_16x16x32_bf16 v[124:127], a[108:111], a[60:63], v[124:127]
    s_waitcnt vmcnt(21) lgkmcnt(0)
    v_mfma_f32_16x16x32_bf16 v[0:3], a[112:115], a[64:67], v[0:3]
    s_add_u32 m0, s34, 8192
    s_nop 0
    buffer_load_dwordx4 v132, s[16:19], s32 offen offset:0  lds
    v_mfma_f32_16x16x32_bf16 v[4:7], a[116:119], a[64:67], v[4:7]
    buffer_load_dwordx4 v133, s[16:19], s32 offen offset:1024  lds
    v_mfma_f32_16x16x32_bf16 v[8:11], a[120:123], a[64:67], v[8:11]
    buffer_load_dwordx4 a[32:35], v128, s[12:15], s31 offen offset:0
    v_mfma_f32_16x16x32_bf16 v[12:15], a[124:127], a[64:67], v[12:15]
    s_waitcnt vmcnt(21)
    v_mfma_f32_16x16x32_bf16 v[16:19], a[112:115], a[68:71], v[16:19]
    buffer_load_dwordx4 v134, s[16:19], s32 offen offset:2048  lds
    v_mfma_f32_16x16x32_bf16 v[20:23], a[116:119], a[68:71], v[20:23]
    buffer_load_dwordx4 v135, s[16:19], s32 offen offset:3072  lds
    v_mfma_f32_16x16x32_bf16 v[24:27], a[120:123], a[68:71], v[24:27]
    buffer_load_dwordx4 a[36:39], v128, s[12:15], s31 offen offset:1024
    v_mfma_f32_16x16x32_bf16 v[28:31], a[124:127], a[68:71], v[28:31]
    s_waitcnt vmcnt(23)
    v_mfma_f32_16x16x32_bf16 v[32:35], a[112:115], a[72:75], v[32:35]
    buffer_load_dwordx4 a[40:43], v129, s[12:15], s31 offen offset:0
    v_mfma_f32_16x16x32_bf16 v[36:39], a[116:119], a[72:75], v[36:39]
    ds_read_b64_tr_b16 a[96:97], v136 offset:0
    v_mfma_f32_16x16x32_bf16 v[40:43], a[120:123], a[72:75], v[40:43]
    ds_read_b64_tr_b16 a[98:99], v136 offset:2048
    v_mfma_f32_16x16x32_bf16 v[44:47], a[124:127], a[72:75], v[44:47]
    s_waitcnt vmcnt(23)
    v_mfma_f32_16x16x32_bf16 v[48:51], a[112:115], a[76:79], v[48:51]
    buffer_load_dwordx4 a[44:47], v129, s[12:15], s31 offen offset:1024
    v_mfma_f32_16x16x32_bf16 v[52:55], a[116:119], a[76:79], v[52:55]
    ds_read_b64_tr_b16 a[100:101], v137 offset:0
    v_mfma_f32_16x16x32_bf16 v[56:59], a[120:123], a[76:79], v[56:59]
    ds_read_b64_tr_b16 a[102:103], v137 offset:2048
    v_mfma_f32_16x16x32_bf16 v[60:63], a[124:127], a[76:79], v[60:63]
    s_waitcnt vmcnt(23)
    v_mfma_f32_16x16x32_bf16 v[64:67], a[112:115], a[80:83], v[64:67]
    buffer_load_dwordx4 a[48:51], v130, s[12:15], s31 offen offset:0
    v_mfma_f32_16x16x32_bf16 v[68:71], a[116:119], a[80:83], v[68:71]
    ds_read_b64_tr_b16 a[104:105], v138 offset:0
    v_mfma_f32_16x16x32_bf16 v[72:75], a[120:123], a[80:83], v[72:75]
    ds_read_b64_tr_b16 a[106:107], v138 offset:2048
    v_mfma_f32_16x16x32_bf16 v[76:79], a[124:127], a[80:83], v[76:79]
    s_waitcnt vmcnt(23)
    v_mfma_f32_16x16x32_bf16 v[80:83], a[112:115], a[84:87], v[80:83]
    buffer_load_dwordx4 a[52:55], v130, s[12:15], s31 offen offset:1024
    v_mfma_f32_16x16x32_bf16 v[84:87], a[116:119], a[84:87], v[84:87]
    ds_read_b64_tr_b16 a[108:109], v139 offset:0
    v_mfma_f32_16x16x32_bf16 v[88:91], a[120:123], a[84:87], v[88:91]
    ds_read_b64_tr_b16 a[110:111], v139 offset:2048
    v_mfma_f32_16x16x32_bf16 v[92:95], a[124:127], a[84:87], v[92:95]
    s_waitcnt vmcnt(23)
    v_mfma_f32_16x16x32_bf16 v[96:99], a[112:115], a[88:91], v[96:99]
    buffer_load_dwordx4 a[56:59], v131, s[12:15], s31 offen offset:0
    v_mfma_f32_16x16x32_bf16 v[100:103], a[116:119], a[88:91], v[100:103]
    v_mfma_f32_16x16x32_bf16 v[104:107], a[120:123], a[88:91], v[104:107]
    v_mfma_f32_16x16x32_bf16 v[108:111], a[124:127], a[88:91], v[108:111]
    s_waitcnt vmcnt(23)
    v_mfma_f32_16x16x32_bf16 v[112:115], a[112:115], a[92:95], v[112:115]
    buffer_load_dwordx4 a[60:63], v131, s[12:15], s31 offen offset:1024
    s_mov_b32 s31, s36
    v_readlane_b32 s36, v141, 27
    s_nop 2
    s_lshl_b32 s32, s36, 3
    v_mfma_f32_16x16x32_bf16 v[116:119], a[116:119], a[92:95], v[116:119]
    v_mfma_f32_16x16x32_bf16 v[120:123], a[120:123], a[92:95], v[120:123]
    v_mfma_f32_16x16x32_bf16 v[124:127], a[124:127], a[92:95], v[124:127]
    s_waitcnt vmcnt(21) lgkmcnt(0)
    v_mfma_f32_16x16x32_bf16 v[0:3], a[96:99], a[0:3], v[0:3]
    s_add_u32 m0, s34, 12288
    s_nop 0
    buffer_load_dwordx4 v132, s[16:19], s32 offen offset:0  lds
    v_mfma_f32_16x16x32_bf16 v[4:7], a[100:103], a[0:3], v[4:7]
    buffer_load_dwordx4 v133, s[16:19], s32 offen offset:1024  lds
    v_mfma_f32_16x16x32_bf16 v[8:11], a[104:107], a[0:3], v[8:11]
    buffer_load_dwordx4 a[64:67], v128, s[12:15], s31 offen offset:0
    v_mfma_f32_16x16x32_bf16 v[12:15], a[108:111], a[0:3], v[12:15]
    s_waitcnt vmcnt(21)
    v_mfma_f32_16x16x32_bf16 v[16:19], a[96:99], a[4:7], v[16:19]
    buffer_load_dwordx4 v134, s[16:19], s32 offen offset:2048  lds
    v_mfma_f32_16x16x32_bf16 v[20:23], a[100:103], a[4:7], v[20:23]
    buffer_load_dwordx4 v135, s[16:19], s32 offen offset:3072  lds
    v_mfma_f32_16x16x32_bf16 v[24:27], a[104:107], a[4:7], v[24:27]
    buffer_load_dwordx4 a[68:71], v128, s[12:15], s31 offen offset:1024
    v_mfma_f32_16x16x32_bf16 v[28:31], a[108:111], a[4:7], v[28:31]
    s_waitcnt vmcnt(23)
    v_mfma_f32_16x16x32_bf16 v[32:35], a[96:99], a[8:11], v[32:35]
    buffer_load_dwordx4 a[72:75], v129, s[12:15], s31 offen offset:0
    v_mfma_f32_16x16x32_bf16 v[36:39], a[100:103], a[8:11], v[36:39]
    ds_read_b64_tr_b16 a[112:113], v136 offset:4096
    v_mfma_f32_16x16x32_bf16 v[40:43], a[104:107], a[8:11], v[40:43]
    ds_read_b64_tr_b16 a[114:115], v136 offset:6144
    v_mfma_f32_16x16x32_bf16 v[44:47], a[108:111], a[8:11], v[44:47]
    s_waitcnt vmcnt(23)
    v_mfma_f32_16x16x32_bf16 v[48:51], a[96:99], a[12:15], v[48:51]
    buffer_load_dwordx4 a[76:79], v129, s[12:15], s31 offen offset:1024
    v_mfma_f32_16x16x32_bf16 v[52:55], a[100:103], a[12:15], v[52:55]
    ds_read_b64_tr_b16 a[116:117], v137 offset:4096
    v_mfma_f32_16x16x32_bf16 v[56:59], a[104:107], a[12:15], v[56:59]
    ds_read_b64_tr_b16 a[118:119], v137 offset:6144
    v_mfma_f32_16x16x32_bf16 v[60:63], a[108:111], a[12:15], v[60:63]
    s_waitcnt vmcnt(23)
    v_mfma_f32_16x16x32_bf16 v[64:67], a[96:99], a[16:19], v[64:67]
    buffer_load_dwordx4 a[80:83], v130, s[12:15], s31 offen offset:0
    v_mfma_f32_16x16x32_bf16 v[68:71], a[100:103], a[16:19], v[68:71]
    ds_read_b64_tr_b16 a[120:121], v138 offset:4096
    v_mfma_f32_16x16x32_bf16 v[72:75], a[104:107], a[16:19], v[72:75]
    ds_read_b64_tr_b16 a[122:123], v138 offset:6144
    v_mfma_f32_16x16x32_bf16 v[76:79], a[108:111], a[16:19], v[76:79]
    s_waitcnt vmcnt(23)
    v_mfma_f32_16x16x32_bf16 v[80:83], a[96:99], a[20:23], v[80:83]
    buffer_load_dwordx4 a[84:87], v130, s[12:15], s31 offen offset:1024
    v_mfma_f32_16x16x32_bf16 v[84:87], a[100:103], a[20:23], v[84:87]
    ds_read_b64_tr_b16 a[124:125], v139 offset:4096
    v_mfma_f32_16x16x32_bf16 v[88:91], a[104:107], a[20:23], v[88:91]
    ds_read_b64_tr_b16 a[126:127], v139 offset:6144
    v_mfma_f32_16x16x32_bf16 v[92:95], a[108:111], a[20:23], v[92:95]
    s_waitcnt vmcnt(23)
    v_mfma_f32_16x16x32_bf16 v[96:99], a[96:99], a[24:27], v[96:99]
    buffer_load_dwordx4 a[88:91], v131, s[12:15], s31 offen offset:0
    v_mfma_f32_16x16x32_bf16 v[100:103], a[100:103], a[24:27], v[100:103]
    buffer_load_dword v176, v177, s[52:55], 0 offen offset:0
    v_mfma_f32_16x16x32_bf16 v[104:107], a[104:107], a[24:27], v[104:107]
    v_mfma_f32_16x16x32_bf16 v[108:111], a[108:111], a[24:27], v[108:111]
    s_waitcnt vmcnt(24)
    v_mfma_f32_16x16x32_bf16 v[112:115], a[96:99], a[28:31], v[112:115]
    buffer_load_dwordx4 a[92:95], v131, s[12:15], s31 offen offset:1024
    s_mov_b32 s31, s36
    v_mfma_f32_16x16x32_bf16 v[116:119], a[100:103], a[28:31], v[116:119]
    buffer_load_dword v178, v177, s[52:55], 0 offen offset:64
    v_mfma_f32_16x16x32_bf16 v[120:123], a[104:107], a[28:31], v[120:123]
    v_mfma_f32_16x16x32_bf16 v[124:127], a[108:111], a[28:31], v[124:127]
    s_waitcnt vmcnt(23) lgkmcnt(0)
    v_mfma_f32_16x16x32_bf16 v[0:3], a[112:115], a[32:35], v[0:3]
    buffer_load_dwordx4 a[0:3], v128, s[12:15], s31 offen offset:0
    v_mfma_f32_16x16x32_bf16 v[4:7], a[116:119], a[32:35], v[4:7]
    v_mfma_f32_16x16x32_bf16 v[8:11], a[120:123], a[32:35], v[8:11]
    v_mfma_f32_16x16x32_bf16 v[12:15], a[124:127], a[32:35], v[12:15]
    s_waitcnt vmcnt(21)
    v_mfma_f32_16x16x32_bf16 v[16:19], a[112:115], a[36:39], v[16:19]
    buffer_load_dwordx4 a[4:7], v128, s[12:15], s31 offen offset:1024
    v_mfma_f32_16x16x32_bf16 v[20:23], a[116:119], a[36:39], v[20:23]
    v_mfma_f32_16x16x32_bf16 v[24:27], a[120:123], a[36:39], v[24:27]
    v_mfma_f32_16x16x32_bf16 v[28:31], a[124:127], a[36:39], v[28:31]
    s_waitcnt vmcnt(21)
    v_mfma_f32_16x16x32_bf16 v[32:35], a[112:115], a[40:43], v[32:35]
    buffer_load_dwordx4 a[8:11], v129, s[12:15], s31 offen offset:0
    v_mfma_f32_16x16x32_bf16 v[36:39], a[116:119], a[40:43], v[36:39]
    ds_read_b64_tr_b16 a[96:97], v136 offset:8192
    v_mfma_f32_16x16x32_bf16 v[40:43], a[120:123], a[40:43], v[40:43]
    ds_read_b64_tr_b16 a[98:99], v136 offset:10240
    v_mfma_f32_16x16x32_bf16 v[44:47], a[124:127], a[40:43], v[44:47]
    s_waitcnt vmcnt(21)
    v_mfma_f32_16x16x32_bf16 v[48:51], a[112:115], a[44:47], v[48:51]
    buffer_load_dwordx4 a[12:15], v129, s[12:15], s31 offen offset:1024
    v_mfma_f32_16x16x32_bf16 v[52:55], a[116:119], a[44:47], v[52:55]
    ds_read_b64_tr_b16 a[100:101], v137 offset:8192
    v_mfma_f32_16x16x32_bf16 v[56:59], a[120:123], a[44:47], v[56:59]
    ds_read_b64_tr_b16 a[102:103], v137 offset:10240
    v_mfma_f32_16x16x32_bf16 v[60:63], a[124:127], a[44:47], v[60:63]
    s_waitcnt vmcnt(21)
    v_mfma_f32_16x16x32_bf16 v[64:67], a[112:115], a[48:51], v[64:67]
    buffer_load_dwordx4 a[16:19], v130, s[12:15], s31 offen offset:0
    v_mfma_f32_16x16x32_bf16 v[68:71], a[116:119], a[48:51], v[68:71]
    ds_read_b64_tr_b16 a[104:105], v138 offset:8192
    v_mfma_f32_16x16x32_bf16 v[72:75], a[120:123], a[48:51], v[72:75]
    ds_read_b64_tr_b16 a[106:107], v138 offset:10240
    v_mfma_f32_16x16x32_bf16 v[76:79], a[124:127], a[48:51], v[76:79]
    s_waitcnt vmcnt(21)
    v_mfma_f32_16x16x32_bf16 v[80:83], a[112:115], a[52:55], v[80:83]
    buffer_load_dwordx4 a[20:23], v130, s[12:15], s31 offen offset:1024
    v_mfma_f32_16x16x32_bf16 v[84:87], a[116:119], a[52:55], v[84:87]
    ds_read_b64_tr_b16 a[108:109], v139 offset:8192
    v_mfma_f32_16x16x32_bf16 v[88:91], a[120:123], a[52:55], v[88:91]
    ds_read_b64_tr_b16 a[110:111], v139 offset:10240
    v_mfma_f32_16x16x32_bf16 v[92:95], a[124:127], a[52:55], v[92:95]
    s_waitcnt vmcnt(21)
    v_mfma_f32_16x16x32_bf16 v[96:99], a[112:115], a[56:59], v[96:99]
    buffer_load_dwordx4 a[24:27], v131, s[12:15], s31 offen offset:0
    v_mfma_f32_16x16x32_bf16 v[100:103], a[116:119], a[56:59], v[100:103]
    buffer_load_dwordx4 v[160:163], v151, s[24:27], s43 offen offset:0
    v_mfma_f32_16x16x32_bf16 v[104:107], a[120:123], a[56:59], v[104:107]
    buffer_load_dwordx4 v[164:167], v151, s[24:27], s44 offen offset:0
    v_mfma_f32_16x16x32_bf16 v[108:111], a[124:127], a[56:59], v[108:111]
    s_waitcnt vmcnt(23)
    v_mfma_f32_16x16x32_bf16 v[112:115], a[112:115], a[60:63], v[112:115]
    buffer_load_dwordx4 a[28:31], v131, s[12:15], s31 offen offset:1024
    v_mfma_f32_16x16x32_bf16 v[116:119], a[116:119], a[60:63], v[116:119]
    buffer_load_dwordx4 v[168:171], v151, s[24:27], s43 offen offset:1024
    v_mfma_f32_16x16x32_bf16 v[120:123], a[120:123], a[60:63], v[120:123]
    buffer_load_dwordx4 v[172:175], v151, s[24:27], s44 offen offset:1024
    v_mfma_f32_16x16x32_bf16 v[124:127], a[124:127], a[60:63], v[124:127]
    s_waitcnt vmcnt(23) lgkmcnt(0)
    v_mfma_f32_16x16x32_bf16 v[0:3], a[96:99], a[64:67], v[0:3]
    v_mfma_f32_16x16x32_bf16 v[4:7], a[100:103], a[64:67], v[4:7]
    v_mfma_f32_16x16x32_bf16 v[8:11], a[104:107], a[64:67], v[8:11]
    v_mfma_f32_16x16x32_bf16 v[12:15], a[108:111], a[64:67], v[12:15]
    s_waitcnt vmcnt(20)
    v_mfma_f32_16x16x32_bf16 v[16:19], a[96:99], a[68:71], v[16:19]
    v_mfma_f32_16x16x32_bf16 v[20:23], a[100:103], a[68:71], v[20:23]
    v_mfma_f32_16x16x32_bf16 v[24:27], a[104:107], a[68:71], v[24:27]
    v_mfma_f32_16x16x32_bf16 v[28:31], a[108:111], a[68:71], v[28:31]
    s_waitcnt vmcnt(19)
    v_mfma_f32_16x16x32_bf16 v[32:35], a[96:99], a[72:75], v[32:35]
    ds_read_b64_tr_b16 a[112:113], v136 offset:12288
    v_mfma_f32_16x16x32_bf16 v[36:39], a[100:103], a[72:75], v[36:39]
    ds_read_b64_tr_b16 a[114:115], v136 offset:14336
    v_mfma_f32_16x16x32_bf16 v[40:43], a[104:107], a[72:75], v[40:43]
    v_mfma_f32_16x16x32_bf16 v[44:47], a[108:111], a[72:75], v[44:47]
    s_waitcnt vmcnt(18)
    v_mfma_f32_16x16x32_bf16 v[48:51], a[96:99], a[76:79], v[48:51]
    ds_read_b64_tr_b16 a[116:117], v137 offset:12288
    v_mfma_f32_16x16x32_bf16 v[52:55], a[100:103], a[76:79], v[52:55]
    ds_read_b64_tr_b16 a[118:119], v137 offset:14336
    v_mfma_f32_16x16x32_bf16 v[56:59], a[104:107], a[76:79], v[56:59]
    v_mfma_f32_16x16x32_bf16 v[60:63], a[108:111], a[76:79], v[60:63]
    s_waitcnt vmcnt(17)
    v_mfma_f32_16x16x32_bf16 v[64:67], a[96:99], a[80:83], v[64:67]
    ds_read_b64_tr_b16 a[120:121], v138 offset:12288
    v_mfma_f32_16x16x32_bf16 v[68:71], a[100:103], a[80:83], v[68:71]
    ds_read_b64_tr_b16 a[122:123], v138 offset:14336
    v_mfma_f32_16x16x32_bf16 v[72:75], a[104:107], a[80:83], v[72:75]
    v_mfma_f32_16x16x32_bf16 v[76:79], a[108:111], a[80:83], v[76:79]
    s_waitcnt vmcnt(16)
    v_mfma_f32_16x16x32_bf16 v[80:83], a[96:99], a[84:87], v[80:83]
    ds_read_b64_tr_b16 a[124:125], v139 offset:12288
    v_mfma_f32_16x16x32_bf16 v[84:87], a[100:103], a[84:87], v[84:87]
    ds_read_b64_tr_b16 a[126:127], v139 offset:14336
    v_mfma_f32_16x16x32_bf16 v[88:91], a[104:107], a[84:87], v[88:91]
    v_mfma_f32_16x16x32_bf16 v[92:95], a[108:111], a[84:87], v[92:95]
    s_waitcnt vmcnt(15)
    v_mfma_f32_16x16x32_bf16 v[96:99], a[96:99], a[88:91], v[96:99]
    v_mfma_f32_16x16x32_bf16 v[100:103], a[100:103], a[88:91], v[100:103]
    v_mfma_f32_16x16x32_bf16 v[104:107], a[104:107], a[88:91], v[104:107]
    v_mfma_f32_16x16x32_bf16 v[108:111], a[108:111], a[88:91], v[108:111]
    s_waitcnt vmcnt(13)
    v_mfma_f32_16x16x32_bf16 v[112:115], a[96:99], a[92:95], v[112:115]
    v_mfma_f32_16x16x32_bf16 v[116:119], a[100:103], a[92:95], v[116:119]
    v_mfma_f32_16x16x32_bf16 v[120:123], a[104:107], a[92:95], v[120:123]
    v_mfma_f32_16x16x32_bf16 v[124:127], a[108:111], a[92:95], v[124:127]
    s_waitcnt vmcnt(11) lgkmcnt(0)
    v_mfma_f32_16x16x32_bf16 v[0:3], a[112:115], a[0:3], v[0:3]
    v_mfma_f32_16x16x32_bf16 v[4:7], a[116:119], a[0:3], v[4:7]
    v_mfma_f32_16x16x32_bf16 v[8:11], a[120:123], a[0:3], v[8:11]
    v_mfma_f32_16x16x32_bf16 v[12:15], a[124:127], a[0:3], v[12:15]
    s_waitcnt vmcnt(10)
    v_mfma_f32_16x16x32_bf16 v[16:19], a[112:115], a[4:7], v[16:19]
    v_mfma_f32_16x16x32_bf16 v[20:23], a[116:119], a[4:7], v[20:23]
    v_mfma_f32_16x16x32_bf16 v[24:27], a[120:123], a[4:7], v[24:27]
    v_mfma_f32_16x16x32_bf16 v[28:31], a[124:127], a[4:7], v[28:31]
    s_waitcnt vmcnt(9)
    v_mfma_f32_16x16x32_bf16 v[32:35], a[112:115], a[8:11], v[32:35]
    ds_write_b128 v142, v[0:3] offset:0
    v_mfma_f32_16x16x32_bf16 v[36:39], a[116:119], a[8:11], v[36:39]
    ds_write_b128 v142, v[4:7] offset:1024
    v_mfma_f32_16x16x32_bf16 v[40:43], a[120:123], a[8:11], v[40:43]
    ds_write_b128 v142, v[8:11] offset:2048
    v_mfma_f32_16x16x32_bf16 v[44:47], a[124:127], a[8:11], v[44:47]
    ds_write_b128 v142, v[12:15] offset:3072
    s_waitcnt vmcnt(8)
    v_mfma_f32_16x16x32_bf16 v[48:51], a[112:115], a[12:15], v[48:51]
    ds_write_b128 v142, v[16:19] offset:4096
    v_mfma_f32_16x16x32_bf16 v[52:55], a[116:119], a[12:15], v[52:55]
    ds_write_b128 v142, v[20:23] offset:5120
    v_mfma_f32_16x16x32_bf16 v[56:59], a[120:123], a[12:15], v[56:59]
    ds_write_b128 v142, v[24:27] offset:6144
    v_mfma_f32_16x16x32_bf16 v[60:63], a[124:127], a[12:15], v[60:63]
    ds_write_b128 v142, v[28:31] offset:7168
    s_waitcnt vmcnt(7)
    v_mfma_f32_16x16x32_bf16 v[64:67], a[112:115], a[16:19], v[64:67]
    ds_write_b128 v143, v[32:35] offset:0
    v_mfma_f32_16x16x32_bf16 v[68:71], a[116:119], a[16:19], v[68:71]
    ds_write_b128 v143, v[36:39] offset:1024
    v_mfma_f32_16x16x32_bf16 v[72:75], a[120:123], a[16:19], v[72:75]
    ds_write_b128 v143, v[40:43] offset:2048
    v_mfma_f32_16x16x32_bf16 v[76:79], a[124:127], a[16:19], v[76:79]
    ds_write_b128 v143, v[44:47] offset:3072
    s_waitcnt vmcnt(6)
    v_mfma_f32_16x16x32_bf16 v[80:83], a[112:115], a[20:23], v[80:83]
    ds_write_b128 v143, v[48:51] offset:4096
    v_mfma_f32_16x16x32_bf16 v[84:87], a[116:119], a[20:23], v[84:87]
    ds_write_b128 v143, v[52:55] offset:5120
    v_mfma_f32_16x16x32_bf16 v[88:91], a[120:123], a[20:23], v[88:91]
    ds_write_b128 v143, v[56:59] offset:6144
    v_mfma_f32_16x16x32_bf16 v[92:95], a[124:127], a[20:23], v[92:95]
    ds_write_b128 v143, v[60:63] offset:7168
    s_waitcnt vmcnt(5)
    v_mfma_f32_16x16x32_bf16 v[96:99], a[112:115], a[24:27], v[96:99]
    ds_write_b128 v144, v[64:67] offset:0
    v_mfma_f32_16x16x32_bf16 v[100:103], a[116:119], a[24:27], v[100:103]
    ds_write_b128 v144, v[68:71] offset:1024
    v_mfma_f32_16x16x32_bf16 v[104:107], a[120:123], a[24:27], v[104:107]
    ds_write_b128 v144, v[72:75] offset:2048
    v_mfma_f32_16x16x32_bf16 v[108:111], a[124:127], a[24:27], v[108:111]
    ds_write_b128 v144, v[76:79] offset:3072
    s_waitcnt vmcnt(2)
    v_mfma_f32_16x16x32_bf16 v[112:115], a[112:115], a[28:31], v[112:115]
    ds_write_b128 v144, v[80:83] offset:4096
    v_mfma_f32_16x16x32_bf16 v[116:119], a[116:119], a[28:31], v[116:119]
    ds_write_b128 v144, v[84:87] offset:5120
    v_mfma_f32_16x16x32_bf16 v[120:123], a[120:123], a[28:31], v[120:123]
    ds_write_b128 v144, v[88:91] offset:6144
    v_mfma_f32_16x16x32_bf16 v[124:127], a[124:127], a[28:31], v[124:127]
    ds_write_b128 v144, v[92:95] offset:7168
    s_waitcnt lgkmcnt(0)
    s_barrier
    ds_read_b128 v[0:3], v145 offset:0
    ds_read_b128 v[4:7], v145 offset:1024
    ds_read_b128 v[8:11], v145 offset:2048
    ds_read_b128 v[12:15], v145 offset:3072
    ds_read_b128 v[16:19], v145 offset:4096
    ds_read_b128 v[20:23], v145 offset:5120
    ds_read_b128 v[24:27], v145 offset:6144
    ds_read_b128 v[28:31], v145 offset:7168
    ds_read_b128 v[32:35], v145 offset:8192
    ds_read_b128 v[36:39], v145 offset:9216
    ds_read_b128 v[40:43], v145 offset:10240
    ds_read_b128 v[44:47], v145 offset:11264
    ds_read_b128 v[48:51], v145 offset:12288
    ds_read_b128 v[52:55], v145 offset:13312
    ds_read_b128 v[56:59], v145 offset:14336
    ds_read_b128 v[60:63], v145 offset:15360
    ds_read_b128 v[64:67], v145 offset:16384
    ds_read_b128 v[68:71], v145 offset:17408
    ds_read_b128 v[72:75], v145 offset:18432
    ds_read_b128 v[76:79], v145 offset:19456
    ds_read_b128 v[80:83], v145 offset:20480
    ds_read_b128 v[84:87], v145 offset:21504
    ds_read_b128 v[88:91], v145 offset:22528
    ds_read_b128 v[92:95], v145 offset:23552
    s_waitcnt lgkmcnt(15)
    v_pk_add_f32 v[96:97], v[96:97], v[0:1]
    v_pk_add_f32 v[98:99], v[98:99], v[2:3]
    v_pk_add_f32 v[100:101], v[100:101], v[4:5]
    v_pk_add_f32 v[102:103], v[102:103], v[6:7]
    v_pk_add_f32 v[104:105], v[104:105], v[8:9]
    v_pk_add_f32 v[106:107], v[106:107], v[10:11]
    v_pk_add_f32 v[108:109], v[108:109], v[12:13]
    v_pk_add_f32 v[110:111], v[110:111], v[14:15]
    v_pk_add_f32 v[112:113], v[112:113], v[16:17]
    v_pk_add_f32 v[114:115], v[114:115], v[18:19]
    v_pk_add_f32 v[116:117], v[116:117], v[20:21]
    v_pk_add_f32 v[118:119], v[118:119], v[22:23]
    v_pk_add_f32 v[120:121], v[120:121], v[24:25]
    v_pk_add_f32 v[122:123], v[122:123], v[26:27]
    v_pk_add_f32 v[124:125], v[124:125], v[28:29]
    v_pk_add_f32 v[126:127], v[126:127], v[30:31]
    s_waitcnt lgkmcnt(8)
    v_pk_add_f32 v[96:97], v[96:97], v[32:33]
    v_pk_add_f32 v[98:99], v[98:99], v[34:35]
    v_pk_add_f32 v[100:101], v[100:101], v[36:37]
    v_pk_add_f32 v[102:103], v[102:103], v[38:39]
    v_pk_add_f32 v[104:105], v[104:105], v[40:41]
    v_pk_add_f32 v[106:107], v[106:107], v[42:43]
    v_pk_add_f32 v[108:109], v[108:109], v[44:45]
    v_pk_add_f32 v[110:111], v[110:111], v[46:47]
    v_pk_add_f32 v[112:113], v[112:113], v[48:49]
    v_pk_add_f32 v[114:115], v[114:115], v[50:51]
    v_pk_add_f32 v[116:117], v[116:117], v[52:53]
    v_pk_add_f32 v[118:119], v[118:119], v[54:55]
    v_pk_add_f32 v[120:121], v[120:121], v[56:57]
    v_pk_add_f32 v[122:123], v[122:123], v[58:59]
    v_pk_add_f32 v[124:125], v[124:125], v[60:61]
    v_pk_add_f32 v[126:127], v[126:127], v[62:63]
    s_waitcnt lgkmcnt(0)
    v_pk_add_f32 v[96:97], v[96:97], v[64:65]
    v_pk_add_f32 v[98:99], v[98:99], v[66:67]
    v_pk_add_f32 v[100:101], v[100:101], v[68:69]
    v_pk_add_f32 v[102:103], v[102:103], v[70:71]
    v_pk_add_f32 v[104:105], v[104:105], v[72:73]
    v_pk_add_f32 v[106:107], v[106:107], v[74:75]
    v_pk_add_f32 v[108:109], v[108:109], v[76:77]
    v_pk_add_f32 v[110:111], v[110:111], v[78:79]
    v_pk_add_f32 v[112:113], v[112:113], v[80:81]
    v_pk_add_f32 v[114:115], v[114:115], v[82:83]
    v_pk_add_f32 v[116:117], v[116:117], v[84:85]
    v_pk_add_f32 v[118:119], v[118:119], v[86:87]
    v_pk_add_f32 v[120:121], v[120:121], v[88:89]
    v_pk_add_f32 v[122:123], v[122:123], v[90:91]
    v_pk_add_f32 v[124:125], v[124:125], v[92:93]
    v_pk_add_f32 v[126:127], v[126:127], v[94:95]
    s_waitcnt vmcnt(0)
    v_mov_b32 v177, v176
    v_mov_b32 v179, v178
    v_permlane16_swap_b32 v96, v100
    v_permlane16_swap_b32 v97, v101
    v_permlane16_swap_b32 v98, v102
    v_permlane16_swap_b32 v99, v103
    v_lshlrev_b32 v154, 16, v160
    v_and_b32 v155, 0xffff0000, v160
    v_pk_add_f32 v[96:97], v[96:97], v[176:177]
    v_pk_add_f32 v[96:97], v[96:97], v[154:155]
    v_cvt_pk_bf16_f32 v160, v96, v97
    v_lshlrev_b32 v154, 16, v161
    v_and_b32 v155, 0xffff0000, v161
    v_pk_add_f32 v[98:99], v[98:99], v[176:177]
    v_pk_add_f32 v[98:99], v[98:99], v[154:155]
    v_cvt_pk_bf16_f32 v161, v98, v99
    v_lshlrev_b32 v154, 16, v162
    v_and_b32 v155, 0xffff0000, v162
    v_pk_add_f32 v[100:101], v[100:101], v[176:177]
    v_pk_add_f32 v[100:101], v[100:101], v[154:155]
    v_cvt_pk_bf16_f32 v162, v100, v101
    v_lshlrev_b32 v154, 16, v163
    v_and_b32 v155, 0xffff0000, v163
    v_pk_add_f32 v[102:103], v[102:103], v[176:177]
    v_pk_add_f32 v[102:103], v[102:103], v[154:155]
    v_cvt_pk_bf16_f32 v163, v102, v103
    ds_write_b128 v156, v[160:163] offset:0
    v_permlane16_swap_b32 v104, v108
    v_permlane16_swap_b32 v105, v109
    v_permlane16_swap_b32 v106, v110
    v_permlane16_swap_b32 v107, v111
    v_lshlrev_b32 v154, 16, v164
    v_and_b32 v155, 0xffff0000, v164
    v_pk_add_f32 v[104:105], v[104:105], v[176:177]
    v_pk_add_f32 v[104:105], v[104:105], v[154:155]
    v_cvt_pk_bf16_f32 v164, v104, v105
    v_lshlrev_b32 v154, 16, v165
    v_and_b32 v155, 0xffff0000, v165
    v_pk_add_f32 v[106:107], v[106:107], v[176:177]
    v_pk_add_f32 v[106:107], v[106:107], v[154:155]
    v_cvt_pk_bf16_f32 v165, v106, v107
    v_lshlrev_b32 v154, 16, v166
    v_and_b32 v155, 0xffff0000, v166
    v_pk_add_f32 v[108:109], v[108:109], v[176:177]
    v_pk_add_f32 v[108:109], v[108:109], v[154:155]
    v_cvt_pk_bf16_f32 v166, v108, v109
    v_lshlrev_b32 v154, 16, v167
    v_and_b32 v155, 0xffff0000, v167
    v_pk_add_f32 v[110:111], v[110:111], v[176:177]
    v_pk_add_f32 v[110:111], v[110:111], v[154:155]
    v_cvt_pk_bf16_f32 v167, v110, v111
    ds_write_b128 v158, v[164:167] offset:0
    v_permlane16_swap_b32 v112, v116
    v_permlane16_swap_b32 v113, v117
    v_permlane16_swap_b32 v114, v118
    v_permlane16_swap_b32 v115, v119
    v_lshlrev_b32 v154, 16, v168
    v_and_b32 v155, 0xffff0000, v168
    v_pk_add_f32 v[112:113], v[112:113], v[178:179]
    v_pk_add_f32 v[112:113], v[112:113], v[154:155]
    v_cvt_pk_bf16_f32 v168, v112, v113
    v_lshlrev_b32 v154, 16, v169
    v_and_b32 v155, 0xffff0000, v169
    v_pk_add_f32 v[114:115], v[114:115], v[178:179]
    v_pk_add_f32 v[114:115], v[114:115], v[154:155]
    v_cvt_pk_bf16_f32 v169, v114, v115
    v_lshlrev_b32 v154, 16, v170
    v_and_b32 v155, 0xffff0000, v170
    v_pk_add_f32 v[116:117], v[116:117], v[178:179]
    v_pk_add_f32 v[116:117], v[116:117], v[154:155]
    v_cvt_pk_bf16_f32 v170, v116, v117
    v_lshlrev_b32 v154, 16, v171
    v_and_b32 v155, 0xffff0000, v171
    v_pk_add_f32 v[118:119], v[118:119], v[178:179]
    v_pk_add_f32 v[118:119], v[118:119], v[154:155]
    v_cvt_pk_bf16_f32 v171, v118, v119
    ds_write_b128 v156, v[168:171] offset:2048
    v_permlane16_swap_b32 v120, v124
    v_permlane16_swap_b32 v121, v125
    v_permlane16_swap_b32 v122, v126
    v_permlane16_swap_b32 v123, v127
    v_lshlrev_b32 v154, 16, v172
    v_and_b32 v155, 0xffff0000, v172
    v_pk_add_f32 v[120:121], v[120:121], v[178:179]
    v_pk_add_f32 v[120:121], v[120:121], v[154:155]
    v_cvt_pk_bf16_f32 v172, v120, v121
    v_lshlrev_b32 v154, 16, v173
    v_and_b32 v155, 0xffff0000, v173
    v_pk_add_f32 v[122:123], v[122:123], v[178:179]
    v_pk_add_f32 v[122:123], v[122:123], v[154:155]
    v_cvt_pk_bf16_f32 v173, v122, v123
    v_lshlrev_b32 v154, 16, v174
    v_and_b32 v155, 0xffff0000, v174
    v_pk_add_f32 v[124:125], v[124:125], v[178:179]
    v_pk_add_f32 v[124:125], v[124:125], v[154:155]
    v_cvt_pk_bf16_f32 v174, v124, v125
    v_lshlrev_b32 v154, 16, v175
    v_and_b32 v155, 0xffff0000, v175
    v_pk_add_f32 v[126:127], v[126:127], v[178:179]
    v_pk_add_f32 v[126:127], v[126:127], v[154:155]
    v_cvt_pk_bf16_f32 v175, v126, v127
    ds_write_b128 v158, v[172:175] offset:2048
    s_waitcnt lgkmcnt(0)
    ds_read_b128 v[32:35], v157 offset:0
    ds_read_b128 v[36:39], v157 offset:1024
    ds_read_b128 v[40:43], v157 offset:2048
    ds_read_b128 v[44:47], v157 offset:3072
    s_waitcnt lgkmcnt(3)
    buffer_store_dwordx4 v[32:35], v146, s[20:23], s45 offen
    s_waitcnt lgkmcnt(2)
    buffer_store_dwordx4 v[36:39], v146, s[20:23], s46 offen
    s_waitcnt lgkmcnt(1)
    buffer_store_dwordx4 v[40:43], v146, s[20:23], s47 offen
    s_waitcnt lgkmcnt(0)
    buffer_store_dwordx4 v[44:47], v146, s[20:23], s48 offen
L_kd_kernel_done_1:
    s_endpgm
.section .rodata,"a"
.p2align 6
.amdhsa_kernel kd_kernel
  .amdhsa_next_free_vgpr 308
  .amdhsa_next_free_sgpr 102
  .amdhsa_accum_offset 180
  .amdhsa_group_segment_fixed_size 0
  .amdhsa_kernarg_size 96
  .amdhsa_user_sgpr_count 2
  .amdhsa_user_sgpr_kernarg_segment_ptr 1
  .amdhsa_system_sgpr_workgroup_id_x 1
  .amdhsa_float_denorm_mode_32 3
  .amdhsa_float_denorm_mode_16_64 3
.end_amdhsa_kernel
.text
L_code_end:
```
